```python
import torch

def _softmax(x, axis=-1):
    return torch.softmax(x, dim=axis)
def _gelu(x):
    return torch.nn.functional.gelu(x, approximate="tanh")
def _silu(x):
    return torch.nn.functional.silu(x)
def _sigmoid(x):
    return torch.sigmoid(x)
def _layernorm(x, axis=-1, eps=1e-5):
    m = x.mean(dim=axis, keepdim=True)
    v = x.var(dim=axis, keepdim=True, unbiased=False)
    return (x - m) / torch.sqrt(v + eps)
def _scatter_add(tgt, idx, src, axis=0):
    return tgt.clone().index_add_(axis, idx, src)
def _segment_sum(src, seg, n):
    out = torch.zeros((n,) + src.shape[1:], dtype=src.dtype)
    return out.index_add_(0, seg, src)
def _pad(x, pw):
    flat = tuple(v for pair in reversed(pw) for v in pair)
    return torch.nn.functional.pad(x, flat)

kernel_name = 'standalone__molecular_angular_gemnet__graph'

def setup_inputs():

    _w = (lambda a: (lambda t: t.to(torch.bfloat16) if t.is_floating_point() else t)(torch.as_tensor(a)))
    N, deg, De, L = 50000, 16, 4, 2
    E = N * deg
    T = E * deg
    NR = 8
    dist = torch.rand(E).to(float)
    angle = (torch.rand(T) * torch.pi).to(float)
    centers = torch.linspace(0.0, 1.0, NR).to(float)
    ang_freq = torch.arange(1, L + 1).to(float)
    return {
        "m": _w((lambda *s: torch.randn(*s, dtype=torch.bfloat16) * 0.05)(E, De)),
        "idx_in": _w((lambda lo, hi, *s: torch.randint(lo, hi, s))(0, E, T).to(torch.int64)),
        "idx_out": _w((lambda lo, hi, *s: torch.randint(lo, hi, s))(0, E, T).to(torch.int64)),
        "dist": _w(dist),
        "angle": _w(angle),
        "centers": _w(centers),
        "ang_freq": _w(ang_freq),
        "w_rbf": _w((lambda *s: torch.randn(*s, dtype=torch.bfloat16) * 0.2)(NR, De)),
        "w_sbf": _w((lambda *s: torch.randn(*s, dtype=torch.bfloat16) * 0.2)(NR * L, De)),
        "w_down": _w((lambda *s: torch.randn(*s, dtype=torch.bfloat16) * 0.2)(De, De)),
        "w_up": _w((lambda *s: torch.randn(*s, dtype=torch.bfloat16) * 0.2)(De, De)),
    }

def reference(m, idx_in, idx_out, dist, angle, centers, ang_freq, w_rbf, w_sbf, w_down, w_up):
    E, De = m.shape[0], m.shape[1]
    NR = centers.shape[0]
    L = ang_freq.shape[0]
    rbf = torch.exp(-10.0 * (dist[:, None] - centers[None, :]) ** 2)
    cbf = torch.cos(ang_freq[None, :] * angle[:, None])
    rbf_t = rbf[idx_out]
    sbf = torch.reshape(rbf_t[:, :, None] * cbf[:, None, :], (-1, NR * L))
    x = (m[idx_in] @ w_down) * (sbf @ w_sbf)
    agg = _segment_sum(x, idx_out, E)
    return m + (agg @ w_up) * (rbf @ w_rbf)
```

```asm
; @launch grid=(256,1,1) block=(1024,1,1) lds=163840
.amdgcn_target "amdgcn-amd-amdhsa--gfx950"
.text
.globl standalone__molecular_angular_gemnet__graph_kernel
.p2align 8
.type standalone__molecular_angular_gemnet__graph_kernel,@function
standalone__molecular_angular_gemnet__graph_kernel:
    s_cmp_ge_u32 s2, 250
    s_cbranch_scc1 .Lidle
    s_load_dwordx2 s[94:95], s[0:1], 96
    s_load_dwordx2 s[84:85], s[0:1], 24
    s_load_dwordx4 s[4:7], s[0:1], 0
    s_load_dwordx2 s[36:37], s[0:1], 16
    s_load_dwordx2 s[38:39], s[0:1], 32
    s_load_dwordx2 s[40:41], s[0:1], 104
    v_lshlrev_b32 v1, 4, v0
    v_lshlrev_b32 v2, 3, v0
    v_lshlrev_b32 v3, 2, v0
    v_mov_b32 v5, 0
    v_lshrrev_b32 v6, 6, v0
    v_mov_b32 v4, 0
    v_readfirstlane_b32 s46, v6
    s_mul_i32 s56, s2, 25600
    s_mul_i32 s57, s2, 147456
    s_mov_b32 s48, 687195
    s_mov_b32 s49, 42949
    s_mov_b32 s50, -6250
    s_mov_b32 s98, -100000
    s_mov_b32 s99, 50331648
    s_movk_i32 s93, 0x1ff
    s_mov_b32 s92, 0x100c0004
    s_lshl_b32 s47, s46, 2
    s_lshl_b32 s53, s2, 13
    s_lshl_b32 s58, s46, 1
    s_and_b32 s97, s58, 12
    s_and_b32 s58, s46, 8
    s_lshl_b32 s58, s58, 8
    s_or_b32 s97, s97, s58
    s_lshl_b32 s54, s2, 14
    s_lshl_b32 s55, s2, 13
    s_mul_i32 s59, s2, 12288
    s_waitcnt lgkmcnt(0)
    s_add_u32 s8, s6, s54
    s_addc_u32 s9, s7, 0
    s_mov_b32 s10, 0
    s_mov_b32 s11, 0x00020000
    s_add_u32 s12, s36, s54
    s_addc_u32 s13, s37, 0
    s_mov_b32 s14, 0
    s_mov_b32 s15, 0x00020000
    s_add_u32 s16, s38, s55
    s_addc_u32 s17, s39, 0
    s_mov_b32 s18, 0
    s_mov_b32 s19, 0x00020000
    s_add_u32 s24, s4, s56
    s_addc_u32 s25, s5, 0
    s_mov_b32 s26, 25600
    s_mov_b32 s27, 0x00020000
    s_sub_u32 s10, 51200000, s54
    s_sub_u32 s14, 51200000, s54
    s_sub_u32 s18, 25600000, s55
    s_mov_b32 s42, 0
    buffer_load_dwordx4 v[12:15], v1, s[8:11], s42 offen nt
    s_mov_b32 s42, 0
    buffer_load_dwordx4 v[36:39], v1, s[12:15], s42 offen nt
    s_mov_b32 s43, 0
    buffer_load_dwordx2 v[114:115], v2, s[16:19], s43 offen nt
    s_and_b32 s88, s2, 6
    s_lshl_b32 s88, s88, 5
    s_lshr_b32 s89, s2, 3
    s_lshl1_add_u32 s88, s89, s88
    s_and_b32 s89, s2, 1
    s_add_u32 s88, s88, s89
    s_mul_i32 s89, s88, 6250
    s_add_u32 s84, s84, s89
    s_addc_u32 s85, s85, 0
    s_and_b32 s84, s84, -4
    v_lshlrev_b32 v63, 2, v1
    v_and_b32 v63, 0x1fff, v63
    v_min_u32 v63, 6244, v63
    s_cmp_ge_u32 s46, 14
    s_cselect_b64 exec, -1, 0
    global_load_dword v63, v63, s[84:85]
    s_mov_b64 exec, -1
    ds_write_b32 v3, v4
    ds_write_b64 v4, v[4:5] offset:8320
    v_mov_b32 v4, 8
    v_mov_b32 v62, 0x200
    buffer_load_dwordx4 v[64:67], v1, s[24:27], 0 offen
    s_movk_i32 s58, 0x4000
    buffer_load_dwordx4 v[68:71], v1, s[24:27], s58 offen
    s_add_u32 s20, s40, s57
    s_addc_u32 s21, s41, 0
    s_mov_b32 s22, 0
    s_mov_b32 s23, 0x00020000
    s_add_u32 s32, s40, s57
    s_addc_u32 s33, s41, 0
    s_add_u32 s32, s32, 37748736
    s_addc_u32 s33, s33, 0
    s_mov_b32 s34, 0
    s_mov_b32 s35, 0x00020000
    s_add_u32 s28, s40, 83886080
    s_addc_u32 s29, s41, 0
    s_mov_b32 s30, 2167808
    s_mov_b32 s31, 0x00020000
    s_waitcnt lgkmcnt(0)
    s_barrier
    s_mov_b32 s44, 4096000
    buffer_load_dwordx4 v[16:19], v1, s[8:11], s44 offen nt
    s_mov_b32 s44, 4096000
    buffer_load_dwordx4 v[40:43], v1, s[12:15], s44 offen nt
    s_mov_b32 s45, 2048000
    buffer_load_dwordx2 v[116:117], v2, s[16:19], s45 offen nt
    s_waitcnt vmcnt(7)
    v_mul_hi_u32_u24 v6, s48, v36
    v_mul_hi_u32_u24 v8, s48, v37
    v_mul_hi_u32_u24 v7, s49, v12
    v_mul_hi_u32_u24 v9, s49, v13
    v_mad_i32_i24 v36, v6, s50, v36
    v_mad_i32_i24 v37, v8, s50, v37
    v_mad_i32_i24 v12, v7, s98, v12
    v_mad_i32_i24 v13, v9, s98, v13
    v_lshl_add_u32 v6, v7, 7, v6
    v_lshl_add_u32 v8, v9, 7, v8
    s_waitcnt vmcnt(6)
    v_lshlrev_b32 v7, 16, v114
    v_and_b32 v9, 0xffff0000, v114
    v_mul_f32_e64 v7, |v7|, s99
    v_mul_f32_e64 v9, |v9|, s99
    v_or3_b32 v5, v5, v7, v9
    v_lshlrev_b32_sdwa v7, 3, v36 dst_sel:WORD_0 dst_unused:UNUSED_PRESERVE src0_sel:DWORD src1_sel:DWORD
    v_lshlrev_b32_sdwa v9, 3, v37 dst_sel:WORD_0 dst_unused:UNUSED_PRESERVE src0_sel:DWORD src1_sel:DWORD
    v_lshlrev_b32 v36, 2, v6
    v_lshlrev_b32 v37, 2, v8
    v_alignbit_b32 v7, v7, v7, 23
    v_alignbit_b32 v9, v9, v9, 23
    ds_add_u32 v36, v4
    ds_add_u32 v37, v4
    v_add_u32 v6, 2048, v12
    v_add_u32 v8, 2048, v13
    v_and_or_b32 v12, v12, s93, v62
    v_and_or_b32 v13, v13, s93, v62
    v_lshrrev_b32_sdwa v36, 9, v6 dst_sel:WORD_1 dst_unused:UNUSED_PRESERVE src0_sel:DWORD src1_sel:DWORD
    v_lshrrev_b32_sdwa v37, 9, v8 dst_sel:WORD_1 dst_unused:UNUSED_PRESERVE src0_sel:DWORD src1_sel:DWORD
    v_lshl_add_u32 v12, v12, 3, v7
    v_lshl_add_u32 v13, v13, 3, v9
    v_mul_hi_u32_u24 v6, s48, v38
    v_mul_hi_u32_u24 v8, s48, v39
    v_mul_hi_u32_u24 v7, s49, v14
    v_mul_hi_u32_u24 v9, s49, v15
    v_mad_i32_i24 v38, v6, s50, v38
    v_mad_i32_i24 v39, v8, s50, v39
    v_mad_i32_i24 v14, v7, s98, v14
    v_mad_i32_i24 v15, v9, s98, v15
    v_lshl_add_u32 v6, v7, 7, v6
    v_lshl_add_u32 v8, v9, 7, v8
    v_lshlrev_b32 v7, 16, v115
    v_and_b32 v9, 0xffff0000, v115
    v_mul_f32_e64 v7, |v7|, s99
    v_mul_f32_e64 v9, |v9|, s99
    v_or3_b32 v5, v5, v7, v9
    v_lshlrev_b32_sdwa v7, 3, v38 dst_sel:WORD_0 dst_unused:UNUSED_PRESERVE src0_sel:DWORD src1_sel:DWORD
    v_lshlrev_b32_sdwa v9, 3, v39 dst_sel:WORD_0 dst_unused:UNUSED_PRESERVE src0_sel:DWORD src1_sel:DWORD
    v_lshlrev_b32 v38, 2, v6
    v_lshlrev_b32 v39, 2, v8
    v_alignbit_b32 v7, v7, v7, 23
    v_alignbit_b32 v9, v9, v9, 23
    ds_add_u32 v38, v4
    ds_add_u32 v39, v4
    v_add_u32 v6, 2048, v14
    v_add_u32 v8, 2048, v15
    v_and_or_b32 v14, v14, s93, v62
    v_and_or_b32 v15, v15, s93, v62
    v_lshrrev_b32_sdwa v38, 9, v6 dst_sel:WORD_1 dst_unused:UNUSED_PRESERVE src0_sel:DWORD src1_sel:DWORD
    v_lshrrev_b32_sdwa v39, 9, v8 dst_sel:WORD_1 dst_unused:UNUSED_PRESERVE src0_sel:DWORD src1_sel:DWORD
    v_lshl_add_u32 v14, v14, 3, v7
    v_lshl_add_u32 v15, v15, 3, v9
    s_waitcnt vmcnt(4)
    v_and_b32 v64, 0x7fff7fff, v64
    v_and_b32 v65, 0x7fff7fff, v65
    v_and_b32 v66, 0x7fff7fff, v66
    v_and_b32 v67, 0x7fff7fff, v67
    s_waitcnt vmcnt(3)
    v_and_b32 v68, 0x7fff7fff, v68
    v_and_b32 v69, 0x7fff7fff, v69
    v_and_b32 v70, 0x7fff7fff, v70
    v_and_b32 v71, 0x7fff7fff, v71
    s_mov_b32 s58, 0x3f803f80
    v_dot2_f32_bf16 v72, v64, s58, 0
    v_dot2_f32_bf16 v73, v65, s58, 0
    v_dot2_f32_bf16 v72, v66, s58, v72
    v_dot2_f32_bf16 v73, v67, s58, v73
    v_dot2_f32_bf16 v72, v68, s58, v72
    v_dot2_f32_bf16 v73, v69, s58, v73
    v_dot2_f32_bf16 v72, v70, s58, v72
    v_dot2_f32_bf16 v73, v71, s58, v73
    v_pk_max_u16 v64, v64, v68
    v_pk_max_u16 v65, v65, v69
    v_pk_max_u16 v66, v66, v70
    v_pk_max_u16 v67, v67, v71
    v_pk_max_u16 v64, v64, v66
    v_pk_max_u16 v65, v65, v67
    v_pk_max_u16 v64, v64, v65
    v_lshrrev_b32 v65, 16, v64
    v_and_b32 v64, 0xffff, v64
    v_max_u32 v64, v64, v65
    s_nop 2
    v_add_f32 v72, v72, v73
    v_max_u32_dpp v64, v64, v64 row_shr:1 row_mask:0xf bank_mask:0xf
    s_nop 0
    v_add_f32_dpp v72, v72, v72 row_shr:1 row_mask:0xf bank_mask:0xf
    v_max_u32_dpp v64, v64, v64 row_shr:2 row_mask:0xf bank_mask:0xf
    s_nop 0
    v_add_f32_dpp v72, v72, v72 row_shr:2 row_mask:0xf bank_mask:0xf
    v_max_u32_dpp v64, v64, v64 row_shr:4 row_mask:0xf bank_mask:0xf
    s_nop 0
    v_add_f32_dpp v72, v72, v72 row_shr:4 row_mask:0xf bank_mask:0xf
    v_max_u32_dpp v64, v64, v64 row_shr:8 row_mask:0xf bank_mask:0xf
    s_nop 0
    v_add_f32_dpp v72, v72, v72 row_shr:8 row_mask:0xf bank_mask:0xf
    v_max_u32_dpp v64, v64, v64 row_bcast:15 row_mask:0xa bank_mask:0xf
    s_nop 0
    v_add_f32_dpp v72, v72, v72 row_bcast:15 row_mask:0xa bank_mask:0xf
    v_max_u32_dpp v64, v64, v64 row_bcast:31 row_mask:0xc bank_mask:0xf
    s_nop 0
    v_add_f32_dpp v72, v72, v72 row_bcast:31 row_mask:0xc bank_mask:0xf
    v_and_b32 v72, 0xffff0000, v72
    v_or_b32 v64, v64, v72
    s_nop 0
    v_readlane_b32 s96, v64, 63
    s_mov_b32 s42, 8192000
    buffer_load_dwordx4 v[20:23], v1, s[8:11], s42 offen nt
    s_mov_b32 s42, 8192000
    buffer_load_dwordx4 v[44:47], v1, s[12:15], s42 offen nt
    s_mov_b32 s43, 4096000
    buffer_load_dwordx2 v[118:119], v2, s[16:19], s43 offen nt
    s_waitcnt vmcnt(4)
    v_mul_hi_u32_u24 v6, s48, v40
    v_mul_hi_u32_u24 v8, s48, v41
    v_mul_hi_u32_u24 v7, s49, v16
    v_mul_hi_u32_u24 v9, s49, v17
    v_mad_i32_i24 v40, v6, s50, v40
    v_mad_i32_i24 v41, v8, s50, v41
    v_mad_i32_i24 v16, v7, s98, v16
    v_mad_i32_i24 v17, v9, s98, v17
    v_lshl_add_u32 v6, v7, 7, v6
    v_lshl_add_u32 v8, v9, 7, v8
    s_waitcnt vmcnt(3)
    v_lshlrev_b32 v7, 16, v116
    v_and_b32 v9, 0xffff0000, v116
    v_mul_f32_e64 v7, |v7|, s99
    v_mul_f32_e64 v9, |v9|, s99
    v_or3_b32 v5, v5, v7, v9
    v_lshlrev_b32_sdwa v7, 3, v40 dst_sel:WORD_0 dst_unused:UNUSED_PRESERVE src0_sel:DWORD src1_sel:DWORD
    v_lshlrev_b32_sdwa v9, 3, v41 dst_sel:WORD_0 dst_unused:UNUSED_PRESERVE src0_sel:DWORD src1_sel:DWORD
    v_lshlrev_b32 v40, 2, v6
    v_lshlrev_b32 v41, 2, v8
    v_alignbit_b32 v7, v7, v7, 23
    v_alignbit_b32 v9, v9, v9, 23
    ds_add_u32 v40, v4
    ds_add_u32 v41, v4
    v_add_u32 v6, 2048, v16
    v_add_u32 v8, 2048, v17
    v_and_or_b32 v16, v16, s93, v62
    v_and_or_b32 v17, v17, s93, v62
    v_lshrrev_b32_sdwa v40, 9, v6 dst_sel:WORD_1 dst_unused:UNUSED_PRESERVE src0_sel:DWORD src1_sel:DWORD
    v_lshrrev_b32_sdwa v41, 9, v8 dst_sel:WORD_1 dst_unused:UNUSED_PRESERVE src0_sel:DWORD src1_sel:DWORD
    v_lshl_add_u32 v16, v16, 3, v7
    v_lshl_add_u32 v17, v17, 3, v9
    v_mul_hi_u32_u24 v6, s48, v42
    v_mul_hi_u32_u24 v8, s48, v43
    v_mul_hi_u32_u24 v7, s49, v18
    v_mul_hi_u32_u24 v9, s49, v19
    v_mad_i32_i24 v42, v6, s50, v42
    v_mad_i32_i24 v43, v8, s50, v43
    v_mad_i32_i24 v18, v7, s98, v18
    v_mad_i32_i24 v19, v9, s98, v19
    v_lshl_add_u32 v6, v7, 7, v6
    v_lshl_add_u32 v8, v9, 7, v8
    v_lshlrev_b32 v7, 16, v117
    v_and_b32 v9, 0xffff0000, v117
    v_mul_f32_e64 v7, |v7|, s99
    v_mul_f32_e64 v9, |v9|, s99
    v_or3_b32 v5, v5, v7, v9
    v_lshlrev_b32_sdwa v7, 3, v42 dst_sel:WORD_0 dst_unused:UNUSED_PRESERVE src0_sel:DWORD src1_sel:DWORD
    v_lshlrev_b32_sdwa v9, 3, v43 dst_sel:WORD_0 dst_unused:UNUSED_PRESERVE src0_sel:DWORD src1_sel:DWORD
    v_lshlrev_b32 v42, 2, v6
    v_lshlrev_b32 v43, 2, v8
    v_alignbit_b32 v7, v7, v7, 23
    v_alignbit_b32 v9, v9, v9, 23
    ds_add_u32 v42, v4
    ds_add_u32 v43, v4
    v_add_u32 v6, 2048, v18
    v_add_u32 v8, 2048, v19
    v_and_or_b32 v18, v18, s93, v62
    v_and_or_b32 v19, v19, s93, v62
    v_lshrrev_b32_sdwa v42, 9, v6 dst_sel:WORD_1 dst_unused:UNUSED_PRESERVE src0_sel:DWORD src1_sel:DWORD
    v_lshrrev_b32_sdwa v43, 9, v8 dst_sel:WORD_1 dst_unused:UNUSED_PRESERVE src0_sel:DWORD src1_sel:DWORD
    v_lshl_add_u32 v18, v18, 3, v7
    v_lshl_add_u32 v19, v19, 3, v9
    s_mov_b32 s44, 12288000
    buffer_load_dwordx4 v[24:27], v1, s[8:11], s44 offen nt
    s_mov_b32 s44, 12288000
    buffer_load_dwordx4 v[48:51], v1, s[12:15], s44 offen nt
    s_mov_b32 s45, 6144000
    buffer_load_dwordx2 v[120:121], v2, s[16:19], s45 offen nt
    s_waitcnt vmcnt(4)
    v_mul_hi_u32_u24 v6, s48, v44
    v_mul_hi_u32_u24 v8, s48, v45
    v_mul_hi_u32_u24 v7, s49, v20
    v_mul_hi_u32_u24 v9, s49, v21
    v_mad_i32_i24 v44, v6, s50, v44
    v_mad_i32_i24 v45, v8, s50, v45
    v_mad_i32_i24 v20, v7, s98, v20
    v_mad_i32_i24 v21, v9, s98, v21
    v_lshl_add_u32 v6, v7, 7, v6
    v_lshl_add_u32 v8, v9, 7, v8
    s_waitcnt vmcnt(3)
    v_lshlrev_b32 v7, 16, v118
    v_and_b32 v9, 0xffff0000, v118
    v_mul_f32_e64 v7, |v7|, s99
    v_mul_f32_e64 v9, |v9|, s99
    v_or3_b32 v5, v5, v7, v9
    v_lshlrev_b32_sdwa v7, 3, v44 dst_sel:WORD_0 dst_unused:UNUSED_PRESERVE src0_sel:DWORD src1_sel:DWORD
    v_lshlrev_b32_sdwa v9, 3, v45 dst_sel:WORD_0 dst_unused:UNUSED_PRESERVE src0_sel:DWORD src1_sel:DWORD
    v_lshlrev_b32 v44, 2, v6
    v_lshlrev_b32 v45, 2, v8
    v_alignbit_b32 v7, v7, v7, 23
    v_alignbit_b32 v9, v9, v9, 23
    ds_add_u32 v44, v4
    ds_add_u32 v45, v4
    v_add_u32 v6, 2048, v20
    v_add_u32 v8, 2048, v21
    v_and_or_b32 v20, v20, s93, v62
    v_and_or_b32 v21, v21, s93, v62
    v_lshrrev_b32_sdwa v44, 9, v6 dst_sel:WORD_1 dst_unused:UNUSED_PRESERVE src0_sel:DWORD src1_sel:DWORD
    v_lshrrev_b32_sdwa v45, 9, v8 dst_sel:WORD_1 dst_unused:UNUSED_PRESERVE src0_sel:DWORD src1_sel:DWORD
    v_lshl_add_u32 v20, v20, 3, v7
    v_lshl_add_u32 v21, v21, 3, v9
    v_mul_hi_u32_u24 v6, s48, v46
    v_mul_hi_u32_u24 v8, s48, v47
    v_mul_hi_u32_u24 v7, s49, v22
    v_mul_hi_u32_u24 v9, s49, v23
    v_mad_i32_i24 v46, v6, s50, v46
    v_mad_i32_i24 v47, v8, s50, v47
    v_mad_i32_i24 v22, v7, s98, v22
    v_mad_i32_i24 v23, v9, s98, v23
    v_lshl_add_u32 v6, v7, 7, v6
    v_lshl_add_u32 v8, v9, 7, v8
    v_lshlrev_b32 v7, 16, v119
    v_and_b32 v9, 0xffff0000, v119
    v_mul_f32_e64 v7, |v7|, s99
    v_mul_f32_e64 v9, |v9|, s99
    v_or3_b32 v5, v5, v7, v9
    v_lshlrev_b32_sdwa v7, 3, v46 dst_sel:WORD_0 dst_unused:UNUSED_PRESERVE src0_sel:DWORD src1_sel:DWORD
    v_lshlrev_b32_sdwa v9, 3, v47 dst_sel:WORD_0 dst_unused:UNUSED_PRESERVE src0_sel:DWORD src1_sel:DWORD
    v_lshlrev_b32 v46, 2, v6
    v_lshlrev_b32 v47, 2, v8
    v_alignbit_b32 v7, v7, v7, 23
    v_alignbit_b32 v9, v9, v9, 23
    ds_add_u32 v46, v4
    ds_add_u32 v47, v4
    v_add_u32 v6, 2048, v22
    v_add_u32 v8, 2048, v23
    v_and_or_b32 v22, v22, s93, v62
    v_and_or_b32 v23, v23, s93, v62
    v_lshrrev_b32_sdwa v46, 9, v6 dst_sel:WORD_1 dst_unused:UNUSED_PRESERVE src0_sel:DWORD src1_sel:DWORD
    v_lshrrev_b32_sdwa v47, 9, v8 dst_sel:WORD_1 dst_unused:UNUSED_PRESERVE src0_sel:DWORD src1_sel:DWORD
    v_lshl_add_u32 v22, v22, 3, v7
    v_lshl_add_u32 v23, v23, 3, v9
    s_mov_b32 s42, 16384000
    buffer_load_dwordx4 v[28:31], v1, s[8:11], s42 offen nt
    s_mov_b32 s42, 16384000
    buffer_load_dwordx4 v[52:55], v1, s[12:15], s42 offen nt
    s_mov_b32 s43, 8192000
    buffer_load_dwordx2 v[122:123], v2, s[16:19], s43 offen nt
    s_waitcnt vmcnt(4)
    v_mul_hi_u32_u24 v6, s48, v48
    v_mul_hi_u32_u24 v8, s48, v49
    v_mul_hi_u32_u24 v7, s49, v24
    v_mul_hi_u32_u24 v9, s49, v25
    v_mad_i32_i24 v48, v6, s50, v48
    v_mad_i32_i24 v49, v8, s50, v49
    v_mad_i32_i24 v24, v7, s98, v24
    v_mad_i32_i24 v25, v9, s98, v25
    v_lshl_add_u32 v6, v7, 7, v6
    v_lshl_add_u32 v8, v9, 7, v8
    s_waitcnt vmcnt(3)
    v_lshlrev_b32 v7, 16, v120
    v_and_b32 v9, 0xffff0000, v120
    v_mul_f32_e64 v7, |v7|, s99
    v_mul_f32_e64 v9, |v9|, s99
    v_or3_b32 v5, v5, v7, v9
    v_lshlrev_b32_sdwa v7, 3, v48 dst_sel:WORD_0 dst_unused:UNUSED_PRESERVE src0_sel:DWORD src1_sel:DWORD
    v_lshlrev_b32_sdwa v9, 3, v49 dst_sel:WORD_0 dst_unused:UNUSED_PRESERVE src0_sel:DWORD src1_sel:DWORD
    v_lshlrev_b32 v48, 2, v6
    v_lshlrev_b32 v49, 2, v8
    v_alignbit_b32 v7, v7, v7, 23
    v_alignbit_b32 v9, v9, v9, 23
    ds_add_u32 v48, v4
    ds_add_u32 v49, v4
    v_add_u32 v6, 2048, v24
    v_add_u32 v8, 2048, v25
    v_and_or_b32 v24, v24, s93, v62
    v_and_or_b32 v25, v25, s93, v62
    v_lshrrev_b32_sdwa v48, 9, v6 dst_sel:WORD_1 dst_unused:UNUSED_PRESERVE src0_sel:DWORD src1_sel:DWORD
    v_lshrrev_b32_sdwa v49, 9, v8 dst_sel:WORD_1 dst_unused:UNUSED_PRESERVE src0_sel:DWORD src1_sel:DWORD
    v_lshl_add_u32 v24, v24, 3, v7
    v_lshl_add_u32 v25, v25, 3, v9
    v_mul_hi_u32_u24 v6, s48, v50
    v_mul_hi_u32_u24 v8, s48, v51
    v_mul_hi_u32_u24 v7, s49, v26
    v_mul_hi_u32_u24 v9, s49, v27
    v_mad_i32_i24 v50, v6, s50, v50
    v_mad_i32_i24 v51, v8, s50, v51
    v_mad_i32_i24 v26, v7, s98, v26
    v_mad_i32_i24 v27, v9, s98, v27
    v_lshl_add_u32 v6, v7, 7, v6
    v_lshl_add_u32 v8, v9, 7, v8
    v_lshlrev_b32 v7, 16, v121
    v_and_b32 v9, 0xffff0000, v121
    v_mul_f32_e64 v7, |v7|, s99
    v_mul_f32_e64 v9, |v9|, s99
    v_or3_b32 v5, v5, v7, v9
    v_lshlrev_b32_sdwa v7, 3, v50 dst_sel:WORD_0 dst_unused:UNUSED_PRESERVE src0_sel:DWORD src1_sel:DWORD
    v_lshlrev_b32_sdwa v9, 3, v51 dst_sel:WORD_0 dst_unused:UNUSED_PRESERVE src0_sel:DWORD src1_sel:DWORD
    v_lshlrev_b32 v50, 2, v6
    v_lshlrev_b32 v51, 2, v8
    v_alignbit_b32 v7, v7, v7, 23
    v_alignbit_b32 v9, v9, v9, 23
    ds_add_u32 v50, v4
    ds_add_u32 v51, v4
    v_add_u32 v6, 2048, v26
    v_add_u32 v8, 2048, v27
    v_and_or_b32 v26, v26, s93, v62
    v_and_or_b32 v27, v27, s93, v62
    v_lshrrev_b32_sdwa v50, 9, v6 dst_sel:WORD_1 dst_unused:UNUSED_PRESERVE src0_sel:DWORD src1_sel:DWORD
    v_lshrrev_b32_sdwa v51, 9, v8 dst_sel:WORD_1 dst_unused:UNUSED_PRESERVE src0_sel:DWORD src1_sel:DWORD
    v_lshl_add_u32 v26, v26, 3, v7
    v_lshl_add_u32 v27, v27, 3, v9
    s_mov_b32 s44, 20480000
    buffer_load_dwordx4 v[32:35], v1, s[8:11], s44 offen nt
    s_mov_b32 s44, 20480000
    buffer_load_dwordx4 v[56:59], v1, s[12:15], s44 offen nt
    s_mov_b32 s45, 10240000
    buffer_load_dwordx2 v[124:125], v2, s[16:19], s45 offen nt
    s_waitcnt vmcnt(4)
    v_mul_hi_u32_u24 v6, s48, v52
    v_mul_hi_u32_u24 v8, s48, v53
    v_mul_hi_u32_u24 v7, s49, v28
    v_mul_hi_u32_u24 v9, s49, v29
    v_mad_i32_i24 v52, v6, s50, v52
    v_mad_i32_i24 v53, v8, s50, v53
    v_mad_i32_i24 v28, v7, s98, v28
    v_mad_i32_i24 v29, v9, s98, v29
    v_lshl_add_u32 v6, v7, 7, v6
    v_lshl_add_u32 v8, v9, 7, v8
    s_waitcnt vmcnt(3)
    v_lshlrev_b32 v7, 16, v122
    v_and_b32 v9, 0xffff0000, v122
    v_mul_f32_e64 v7, |v7|, s99
    v_mul_f32_e64 v9, |v9|, s99
    v_or3_b32 v5, v5, v7, v9
    v_lshlrev_b32_sdwa v7, 3, v52 dst_sel:WORD_0 dst_unused:UNUSED_PRESERVE src0_sel:DWORD src1_sel:DWORD
    v_lshlrev_b32_sdwa v9, 3, v53 dst_sel:WORD_0 dst_unused:UNUSED_PRESERVE src0_sel:DWORD src1_sel:DWORD
    v_lshlrev_b32 v52, 2, v6
    v_lshlrev_b32 v53, 2, v8
    v_alignbit_b32 v7, v7, v7, 23
    v_alignbit_b32 v9, v9, v9, 23
    ds_add_u32 v52, v4
    ds_add_u32 v53, v4
    v_add_u32 v6, 2048, v28
    v_add_u32 v8, 2048, v29
    v_and_or_b32 v28, v28, s93, v62
    v_and_or_b32 v29, v29, s93, v62
    v_lshrrev_b32_sdwa v52, 9, v6 dst_sel:WORD_1 dst_unused:UNUSED_PRESERVE src0_sel:DWORD src1_sel:DWORD
    v_lshrrev_b32_sdwa v53, 9, v8 dst_sel:WORD_1 dst_unused:UNUSED_PRESERVE src0_sel:DWORD src1_sel:DWORD
    v_lshl_add_u32 v28, v28, 3, v7
    v_lshl_add_u32 v29, v29, 3, v9
    v_mul_hi_u32_u24 v6, s48, v54
    v_mul_hi_u32_u24 v8, s48, v55
    v_mul_hi_u32_u24 v7, s49, v30
    v_mul_hi_u32_u24 v9, s49, v31
    v_mad_i32_i24 v54, v6, s50, v54
    v_mad_i32_i24 v55, v8, s50, v55
    v_mad_i32_i24 v30, v7, s98, v30
    v_mad_i32_i24 v31, v9, s98, v31
    v_lshl_add_u32 v6, v7, 7, v6
    v_lshl_add_u32 v8, v9, 7, v8
    v_lshlrev_b32 v7, 16, v123
    v_and_b32 v9, 0xffff0000, v123
    v_mul_f32_e64 v7, |v7|, s99
    v_mul_f32_e64 v9, |v9|, s99
    v_or3_b32 v5, v5, v7, v9
    v_lshlrev_b32_sdwa v7, 3, v54 dst_sel:WORD_0 dst_unused:UNUSED_PRESERVE src0_sel:DWORD src1_sel:DWORD
    v_lshlrev_b32_sdwa v9, 3, v55 dst_sel:WORD_0 dst_unused:UNUSED_PRESERVE src0_sel:DWORD src1_sel:DWORD
    v_lshlrev_b32 v54, 2, v6
    v_lshlrev_b32 v55, 2, v8
    v_alignbit_b32 v7, v7, v7, 23
    v_alignbit_b32 v9, v9, v9, 23
    ds_add_u32 v54, v4
    ds_add_u32 v55, v4
    v_add_u32 v6, 2048, v30
    v_add_u32 v8, 2048, v31
    v_and_or_b32 v30, v30, s93, v62
    v_and_or_b32 v31, v31, s93, v62
    v_lshrrev_b32_sdwa v54, 9, v6 dst_sel:WORD_1 dst_unused:UNUSED_PRESERVE src0_sel:DWORD src1_sel:DWORD
    v_lshrrev_b32_sdwa v55, 9, v8 dst_sel:WORD_1 dst_unused:UNUSED_PRESERVE src0_sel:DWORD src1_sel:DWORD
    v_lshl_add_u32 v30, v30, 3, v7
    v_lshl_add_u32 v31, v31, 3, v9
    v_mov_b32 v63, 0
    s_cmp_eq_u32 s46, 15
    s_cselect_b64 exec, 1, 0
    global_load_dword v63, v63, s[94:95] sc1
    s_mov_b64 exec, -1
    s_sub_u32 s42, 49152000, s59
    buffer_load_dword v60, v3, s[8:11], s42 offen nt
    s_sub_u32 s42, 49152000, s59
    buffer_load_dword v61, v3, s[12:15], s42 offen nt
    s_sub_u32 s43, 49152000, s59
    s_lshr_b32 s43, s43, 1
    v_lshrrev_b32 v126, 1, v3
    buffer_load_ushort v126, v126, s[16:19], s43 offen nt
    s_waitcnt vmcnt(5)
    v_mul_hi_u32_u24 v6, s48, v56
    v_mul_hi_u32_u24 v8, s48, v57
    v_mul_hi_u32_u24 v7, s49, v32
    v_mul_hi_u32_u24 v9, s49, v33
    v_mad_i32_i24 v56, v6, s50, v56
    v_mad_i32_i24 v57, v8, s50, v57
    v_mad_i32_i24 v32, v7, s98, v32
    v_mad_i32_i24 v33, v9, s98, v33
    v_lshl_add_u32 v6, v7, 7, v6
    v_lshl_add_u32 v8, v9, 7, v8
    s_waitcnt vmcnt(4)
    v_lshlrev_b32 v7, 16, v124
    v_and_b32 v9, 0xffff0000, v124
    v_mul_f32_e64 v7, |v7|, s99
    v_mul_f32_e64 v9, |v9|, s99
    v_or3_b32 v5, v5, v7, v9
    v_lshlrev_b32_sdwa v7, 3, v56 dst_sel:WORD_0 dst_unused:UNUSED_PRESERVE src0_sel:DWORD src1_sel:DWORD
    v_lshlrev_b32_sdwa v9, 3, v57 dst_sel:WORD_0 dst_unused:UNUSED_PRESERVE src0_sel:DWORD src1_sel:DWORD
    v_lshlrev_b32 v56, 2, v6
    v_lshlrev_b32 v57, 2, v8
    v_alignbit_b32 v7, v7, v7, 23
    v_alignbit_b32 v9, v9, v9, 23
    ds_add_u32 v56, v4
    ds_add_u32 v57, v4
    v_add_u32 v6, 2048, v32
    v_add_u32 v8, 2048, v33
    v_and_or_b32 v32, v32, s93, v62
    v_and_or_b32 v33, v33, s93, v62
    v_lshrrev_b32_sdwa v56, 9, v6 dst_sel:WORD_1 dst_unused:UNUSED_PRESERVE src0_sel:DWORD src1_sel:DWORD
    v_lshrrev_b32_sdwa v57, 9, v8 dst_sel:WORD_1 dst_unused:UNUSED_PRESERVE src0_sel:DWORD src1_sel:DWORD
    v_lshl_add_u32 v32, v32, 3, v7
    v_lshl_add_u32 v33, v33, 3, v9
    v_mul_hi_u32_u24 v6, s48, v58
    v_mul_hi_u32_u24 v8, s48, v59
    v_mul_hi_u32_u24 v7, s49, v34
    v_mul_hi_u32_u24 v9, s49, v35
    v_mad_i32_i24 v58, v6, s50, v58
    v_mad_i32_i24 v59, v8, s50, v59
    v_mad_i32_i24 v34, v7, s98, v34
    v_mad_i32_i24 v35, v9, s98, v35
    v_lshl_add_u32 v6, v7, 7, v6
    v_lshl_add_u32 v8, v9, 7, v8
    v_lshlrev_b32 v7, 16, v125
    v_and_b32 v9, 0xffff0000, v125
    v_mul_f32_e64 v7, |v7|, s99
    v_mul_f32_e64 v9, |v9|, s99
    v_or3_b32 v5, v5, v7, v9
    v_lshlrev_b32_sdwa v7, 3, v58 dst_sel:WORD_0 dst_unused:UNUSED_PRESERVE src0_sel:DWORD src1_sel:DWORD
    v_lshlrev_b32_sdwa v9, 3, v59 dst_sel:WORD_0 dst_unused:UNUSED_PRESERVE src0_sel:DWORD src1_sel:DWORD
    v_lshlrev_b32 v58, 2, v6
    v_lshlrev_b32 v59, 2, v8
    v_alignbit_b32 v7, v7, v7, 23
    v_alignbit_b32 v9, v9, v9, 23
    ds_add_u32 v58, v4
    ds_add_u32 v59, v4
    v_add_u32 v6, 2048, v34
    v_add_u32 v8, 2048, v35
    v_and_or_b32 v34, v34, s93, v62
    v_and_or_b32 v35, v35, s93, v62
    v_lshrrev_b32_sdwa v58, 9, v6 dst_sel:WORD_1 dst_unused:UNUSED_PRESERVE src0_sel:DWORD src1_sel:DWORD
    v_lshrrev_b32_sdwa v59, 9, v8 dst_sel:WORD_1 dst_unused:UNUSED_PRESERVE src0_sel:DWORD src1_sel:DWORD
    v_lshl_add_u32 v34, v34, 3, v7
    v_lshl_add_u32 v35, v35, 3, v9
    s_mov_b32 s44, 24576000
    buffer_load_dwordx4 v[64:67], v1, s[8:11], s44 offen nt
    s_mov_b32 s44, 24576000
    buffer_load_dwordx4 v[88:91], v1, s[12:15], s44 offen nt
    s_mov_b32 s45, 12288000
    buffer_load_dwordx2 v[114:115], v2, s[16:19], s45 offen nt
    s_waitcnt vmcnt(4)
    v_mul_hi_u32_u24 v6, s48, v61
    v_mul_hi_u32_u24 v7, s49, v60
    v_mad_i32_i24 v61, v6, s50, v61
    v_mad_i32_i24 v60, v7, s98, v60
    v_lshl_add_u32 v6, v7, 7, v6
    s_waitcnt vmcnt(3)
    v_lshlrev_b32 v7, 16, v126
    v_mul_f32_e64 v7, |v7|, s99
    v_or3_b32 v5, v5, v7, v7
    v_lshlrev_b32_sdwa v7, 3, v61 dst_sel:WORD_0 dst_unused:UNUSED_PRESERVE src0_sel:DWORD src1_sel:DWORD
    v_lshlrev_b32 v61, 2, v6
    v_alignbit_b32 v7, v7, v7, 23
    ds_add_u32 v61, v4
    v_add_u32 v6, 2048, v60
    v_and_or_b32 v60, v60, s93, v62
    v_lshrrev_b32_sdwa v61, 9, v6 dst_sel:WORD_1 dst_unused:UNUSED_PRESERVE src0_sel:DWORD src1_sel:DWORD
    v_lshl_add_u32 v60, v60, 3, v7
    v_readfirstlane_b32 s58, v63
    s_cmp_eq_u32 s46, 15
    s_nop 0
    s_cselect_b32 s58, s58, 1
    s_cmp_lg_u32 s58, 1
    s_cbranch_scc1 .Lzw
.Lzwx:
    s_waitcnt lgkmcnt(0)
    s_barrier
    ds_read_b32 v6, v3
    v_mov_b32 v8, s47
    s_waitcnt lgkmcnt(0)
    v_add_u32 v6, 8, v6
    v_lshrrev_b32 v6, 4, v6
    v_mov_b32 v7, v6
    s_nop 1
    v_add_u32_dpp v7, v7, v7 row_shr:1 row_mask:0xf bank_mask:0xf
    s_nop 1
    v_add_u32_dpp v7, v7, v7 row_shr:2 row_mask:0xf bank_mask:0xf
    s_nop 1
    v_add_u32_dpp v7, v7, v7 row_shr:4 row_mask:0xf bank_mask:0xf
    s_nop 1
    v_add_u32_dpp v7, v7, v7 row_shr:8 row_mask:0xf bank_mask:0xf
    s_nop 1
    v_add_u32_dpp v7, v7, v7 row_bcast:15 row_mask:0xa bank_mask:0xf
    s_nop 1
    v_add_u32_dpp v7, v7, v7 row_bcast:31 row_mask:0xc bank_mask:0xf
    s_mov_b32 exec_lo, 0
    s_brev_b32 exec_hi, 1
    ds_write_b32 v8, v7 offset:4096
    v_mov_b32 v10, s96
    ds_write_b32 v8, v10 offset:8256
    s_mov_b64 exec, -1
    v_sub_u32 v9, v7, v6
    v_lshl_or_b32 v9, v7, 16, v9
    v_and_b32 v8, 0x7ff, v1
    v_add_u32 v8, s97, v8
    ds_write_b32 v8, v9 offset:4160
    v_and_b32 v8, 63, v3
    s_mov_b32 s42, 28672000
    buffer_load_dwordx4 v[68:71], v1, s[8:11], s42 offen nt
    s_waitcnt lgkmcnt(0)
    s_barrier
    ds_read_b32 v9, v8 offset:4096
    ds_read_b32 v11, v3 offset:4160
    v_and_b32 v8, 24, v2
    s_and_b32 s58, s47, 32
    s_and_b32 s51, s46, 4
    s_or_b32 s58, s58, s51
    v_or_b32 v8, s58, v8
    s_waitcnt lgkmcnt(1)
    v_mov_b32 v10, v9
    s_nop 1
    v_add_u32_dpp v10, v10, v10 row_shr:1 row_mask:0xf bank_mask:0xf
    s_nop 1
    v_add_u32_dpp v10, v10, v10 row_shr:2 row_mask:0xf bank_mask:0xf
    s_nop 1
    v_add_u32_dpp v10, v10, v10 row_shr:4 row_mask:0xf bank_mask:0xf
    s_nop 1
    v_add_u32_dpp v10, v10, v10 row_shr:8 row_mask:0xf bank_mask:0xf
    v_sub_u32 v9, v10, v9
    ds_bpermute_b32 v8, v8, v9
    v_readlane_b32 s51, v10, 15
    v_readlane_b32 s52, v9, s46
    v_mov_b32 v9, 0
    s_nop 0
    v_add_u32 v7, s52, v7
    v_sub_u32 v6, v7, v6
    v_lshlrev_b32 v6, 4, v6
    v_and_b32 v10, 1, v7
    v_mul_u32_u24 v7, 10, v7
    v_mad_i32_i24 v7, v10, -6, v7
    ds_write_b32 v3, v6
    ds_write_b32 v7, v9 offset:8700
    v_mad_u32_u24 v10, v10, 14, v7
    ds_write_b8 v10, v9 offset:8695
    s_mov_b32 s58, 0x10001
    s_waitcnt lgkmcnt(3)
    v_mad_u32_u24 v63, v8, s58, v11
    s_mul_i32 s51, s51, 10
    s_add_u32 s51, s51, 265
    s_and_b32 s22, s51, -256
    v_and_b32 v8, 63, v3
    ds_read_b32 v6, v8 offset:8256
    s_waitcnt lgkmcnt(0)
    v_and_b32 v7, 0xffff, v6
    v_add_f32_dpp v6, v6, v6 row_shr:1 row_mask:0xf bank_mask:0xf
    s_nop 0
    v_max_u32_dpp v7, v7, v7 row_shr:1 row_mask:0xf bank_mask:0xf
    v_add_f32_dpp v6, v6, v6 row_shr:2 row_mask:0xf bank_mask:0xf
    s_nop 0
    v_max_u32_dpp v7, v7, v7 row_shr:2 row_mask:0xf bank_mask:0xf
    v_add_f32_dpp v6, v6, v6 row_shr:4 row_mask:0xf bank_mask:0xf
    s_nop 0
    v_max_u32_dpp v7, v7, v7 row_shr:4 row_mask:0xf bank_mask:0xf
    v_add_f32_dpp v6, v6, v6 row_shr:8 row_mask:0xf bank_mask:0xf
    s_nop 0
    v_max_u32_dpp v7, v7, v7 row_shr:8 row_mask:0xf bank_mask:0xf
    v_and_b32 v6, 0xffff0000, v6
    v_or_b32 v6, v6, v7
    s_nop 0
    v_readlane_b32 s96, v6, 15
    s_mov_b32 s42, 28672000
    buffer_load_dwordx4 v[92:95], v1, s[12:15], s42 offen nt
    s_waitcnt lgkmcnt(0)
    s_barrier
    v_and_b32 v6, 0xffff, v36
    ds_add_rtn_u32 v6, v6, v4
    v_and_b32 v7, 0xffff, v37
    ds_add_rtn_u32 v7, v7, v4
    s_mov_b32 s43, 14336000
    buffer_load_dwordx2 v[116:117], v2, s[16:19], s43 offen nt
    v_and_b32 v8, 0xffff, v38
    ds_add_rtn_u32 v8, v8, v4
    v_and_b32 v9, 0xffff, v39
    ds_add_rtn_u32 v9, v9, v4
    v_and_b32 v10, 0xffff, v40
    ds_add_rtn_u32 v10, v10, v4
    s_waitcnt lgkmcnt(4)
    v_lshrrev_b32 v127, 5, v6
    v_bfe_u32 v0, s92, v6, 8
    v_bfe_u32 v6, v6, 3, 2
    v_mad_u32_u24 v0, v127, 20, v0
    v_mad_u32_u24 v6, v127, 20, v6
    ds_write_b32 v0, v12 offset:8704
    ds_write_b8_d16_hi v6, v36 offset:8712
    v_and_b32 v11, 0xffff, v41
    ds_add_rtn_u32 v11, v11, v4
    s_mov_b32 s44, 32768000
    buffer_load_dwordx4 v[72:75], v1, s[8:11], s44 offen nt
    s_waitcnt lgkmcnt(6)
    v_lshrrev_b32 v127, 5, v7
    v_bfe_u32 v0, s92, v7, 8
    v_bfe_u32 v7, v7, 3, 2
    v_mad_u32_u24 v0, v127, 20, v0
    v_mad_u32_u24 v7, v127, 20, v7
    ds_write_b32 v0, v13 offset:8704
    ds_write_b8_d16_hi v7, v37 offset:8712
    v_and_b32 v6, 0xffff, v42
    ds_add_rtn_u32 v6, v6, v4
    s_waitcnt lgkmcnt(8)
    v_lshrrev_b32 v127, 5, v8
    v_bfe_u32 v0, s92, v8, 8
    v_bfe_u32 v8, v8, 3, 2
    v_mad_u32_u24 v0, v127, 20, v0
    v_mad_u32_u24 v8, v127, 20, v8
    ds_write_b32 v0, v14 offset:8704
    ds_write_b8_d16_hi v8, v38 offset:8712
    v_and_b32 v7, 0xffff, v43
    ds_add_rtn_u32 v7, v7, v4
    s_waitcnt lgkmcnt(10)
    v_lshrrev_b32 v127, 5, v9
    v_bfe_u32 v0, s92, v9, 8
    v_bfe_u32 v9, v9, 3, 2
    v_mad_u32_u24 v0, v127, 20, v0
    v_mad_u32_u24 v9, v127, 20, v9
    ds_write_b32 v0, v15 offset:8704
    ds_write_b8_d16_hi v9, v39 offset:8712
    v_and_b32 v8, 0xffff, v44
    ds_add_rtn_u32 v8, v8, v4
    s_waitcnt lgkmcnt(12)
    v_lshrrev_b32 v127, 5, v10
    v_bfe_u32 v0, s92, v10, 8
    v_bfe_u32 v10, v10, 3, 2
    v_mad_u32_u24 v0, v127, 20, v0
    v_mad_u32_u24 v10, v127, 20, v10
    ds_write_b32 v0, v16 offset:8704
    ds_write_b8_d16_hi v10, v40 offset:8712
    v_and_b32 v9, 0xffff, v45
    ds_add_rtn_u32 v9, v9, v4
    s_waitcnt lgkmcnt(12)
    v_lshrrev_b32 v127, 5, v11
    v_bfe_u32 v0, s92, v11, 8
    v_bfe_u32 v11, v11, 3, 2
    v_mad_u32_u24 v0, v127, 20, v0
    v_mad_u32_u24 v11, v127, 20, v11
    ds_write_b32 v0, v17 offset:8704
    ds_write_b8_d16_hi v11, v41 offset:8712
    v_and_b32 v10, 0xffff, v46
    ds_add_rtn_u32 v10, v10, v4
    s_mov_b32 s44, 32768000
    buffer_load_dwordx4 v[96:99], v1, s[12:15], s44 offen nt
    s_waitcnt lgkmcnt(12)
    v_lshrrev_b32 v127, 5, v6
    v_bfe_u32 v0, s92, v6, 8
    v_bfe_u32 v6, v6, 3, 2
    v_mad_u32_u24 v0, v127, 20, v0
    v_mad_u32_u24 v6, v127, 20, v6
    ds_write_b32 v0, v18 offset:8704
    ds_write_b8_d16_hi v6, v42 offset:8712
    v_and_b32 v11, 0xffff, v47
    ds_add_rtn_u32 v11, v11, v4
    s_waitcnt lgkmcnt(12)
    v_lshrrev_b32 v127, 5, v7
    v_bfe_u32 v0, s92, v7, 8
    v_bfe_u32 v7, v7, 3, 2
    v_mad_u32_u24 v0, v127, 20, v0
    v_mad_u32_u24 v7, v127, 20, v7
    ds_write_b32 v0, v19 offset:8704
    ds_write_b8_d16_hi v7, v43 offset:8712
    v_and_b32 v6, 0xffff, v48
    ds_add_rtn_u32 v6, v6, v4
    s_waitcnt lgkmcnt(12)
    v_lshrrev_b32 v127, 5, v8
    v_bfe_u32 v0, s92, v8, 8
    v_bfe_u32 v8, v8, 3, 2
    v_mad_u32_u24 v0, v127, 20, v0
    v_mad_u32_u24 v8, v127, 20, v8
    ds_write_b32 v0, v20 offset:8704
    ds_write_b8_d16_hi v8, v44 offset:8712
    v_and_b32 v7, 0xffff, v49
    ds_add_rtn_u32 v7, v7, v4
    s_waitcnt lgkmcnt(12)
    v_lshrrev_b32 v127, 5, v9
    v_bfe_u32 v0, s92, v9, 8
    v_bfe_u32 v9, v9, 3, 2
    v_mad_u32_u24 v0, v127, 20, v0
    v_mad_u32_u24 v9, v127, 20, v9
    ds_write_b32 v0, v21 offset:8704
    ds_write_b8_d16_hi v9, v45 offset:8712
    v_and_b32 v8, 0xffff, v50
    ds_add_rtn_u32 v8, v8, v4
    s_mov_b32 s45, 16384000
    buffer_load_dwordx2 v[118:119], v2, s[16:19], s45 offen nt
    s_waitcnt lgkmcnt(12)
    v_lshrrev_b32 v127, 5, v10
    v_bfe_u32 v0, s92, v10, 8
    v_bfe_u32 v10, v10, 3, 2
    v_mad_u32_u24 v0, v127, 20, v0
    v_mad_u32_u24 v10, v127, 20, v10
    ds_write_b32 v0, v22 offset:8704
    ds_write_b8_d16_hi v10, v46 offset:8712
    v_and_b32 v9, 0xffff, v51
    ds_add_rtn_u32 v9, v9, v4
    s_waitcnt lgkmcnt(12)
    v_lshrrev_b32 v127, 5, v11
    v_bfe_u32 v0, s92, v11, 8
    v_bfe_u32 v11, v11, 3, 2
    v_mad_u32_u24 v0, v127, 20, v0
    v_mad_u32_u24 v11, v127, 20, v11
    ds_write_b32 v0, v23 offset:8704
    ds_write_b8_d16_hi v11, v47 offset:8712
    v_and_b32 v10, 0xffff, v52
    ds_add_rtn_u32 v10, v10, v4
    s_waitcnt lgkmcnt(12)
    v_lshrrev_b32 v127, 5, v6
    v_bfe_u32 v0, s92, v6, 8
    v_bfe_u32 v6, v6, 3, 2
    v_mad_u32_u24 v0, v127, 20, v0
    v_mad_u32_u24 v6, v127, 20, v6
    ds_write_b32 v0, v24 offset:8704
    ds_write_b8_d16_hi v6, v48 offset:8712
    v_and_b32 v11, 0xffff, v53
    ds_add_rtn_u32 v11, v11, v4
    s_waitcnt lgkmcnt(12)
    v_lshrrev_b32 v127, 5, v7
    v_bfe_u32 v0, s92, v7, 8
    v_bfe_u32 v7, v7, 3, 2
    v_mad_u32_u24 v0, v127, 20, v0
    v_mad_u32_u24 v7, v127, 20, v7
    ds_write_b32 v0, v25 offset:8704
    ds_write_b8_d16_hi v7, v49 offset:8712
    v_and_b32 v6, 0xffff, v54
    ds_add_rtn_u32 v6, v6, v4
    s_mov_b32 s42, 36864000
    buffer_load_dwordx4 v[76:79], v1, s[8:11], s42 offen nt
    s_waitcnt lgkmcnt(12)
    v_lshrrev_b32 v127, 5, v8
    v_bfe_u32 v0, s92, v8, 8
    v_bfe_u32 v8, v8, 3, 2
    v_mad_u32_u24 v0, v127, 20, v0
    v_mad_u32_u24 v8, v127, 20, v8
    ds_write_b32 v0, v26 offset:8704
    ds_write_b8_d16_hi v8, v50 offset:8712
    v_and_b32 v7, 0xffff, v55
    ds_add_rtn_u32 v7, v7, v4
    s_waitcnt lgkmcnt(12)
    v_lshrrev_b32 v127, 5, v9
    v_bfe_u32 v0, s92, v9, 8
    v_bfe_u32 v9, v9, 3, 2
    v_mad_u32_u24 v0, v127, 20, v0
    v_mad_u32_u24 v9, v127, 20, v9
    ds_write_b32 v0, v27 offset:8704
    ds_write_b8_d16_hi v9, v51 offset:8712
    v_and_b32 v8, 0xffff, v56
    ds_add_rtn_u32 v8, v8, v4
    s_waitcnt lgkmcnt(12)
    v_lshrrev_b32 v127, 5, v10
    v_bfe_u32 v0, s92, v10, 8
    v_bfe_u32 v10, v10, 3, 2
    v_mad_u32_u24 v0, v127, 20, v0
    v_mad_u32_u24 v10, v127, 20, v10
    ds_write_b32 v0, v28 offset:8704
    ds_write_b8_d16_hi v10, v52 offset:8712
    v_and_b32 v9, 0xffff, v57
    ds_add_rtn_u32 v9, v9, v4
    s_waitcnt lgkmcnt(12)
    v_lshrrev_b32 v127, 5, v11
    v_bfe_u32 v0, s92, v11, 8
    v_bfe_u32 v11, v11, 3, 2
    v_mad_u32_u24 v0, v127, 20, v0
    v_mad_u32_u24 v11, v127, 20, v11
    ds_write_b32 v0, v29 offset:8704
    ds_write_b8_d16_hi v11, v53 offset:8712
    v_and_b32 v10, 0xffff, v58
    ds_add_rtn_u32 v10, v10, v4
    s_waitcnt lgkmcnt(12)
    v_lshrrev_b32 v127, 5, v6
    v_bfe_u32 v0, s92, v6, 8
    v_bfe_u32 v6, v6, 3, 2
    v_mad_u32_u24 v0, v127, 20, v0
    v_mad_u32_u24 v6, v127, 20, v6
    ds_write_b32 v0, v30 offset:8704
    ds_write_b8_d16_hi v6, v54 offset:8712
    v_and_b32 v11, 0xffff, v59
    ds_add_rtn_u32 v11, v11, v4
    s_mov_b32 s42, 36864000
    buffer_load_dwordx4 v[100:103], v1, s[12:15], s42 offen nt
    s_waitcnt lgkmcnt(12)
    v_lshrrev_b32 v127, 5, v7
    v_bfe_u32 v0, s92, v7, 8
    v_bfe_u32 v7, v7, 3, 2
    v_mad_u32_u24 v0, v127, 20, v0
    v_mad_u32_u24 v7, v127, 20, v7
    ds_write_b32 v0, v31 offset:8704
    ds_write_b8_d16_hi v7, v55 offset:8712
    v_and_b32 v6, 0xffff, v61
    ds_add_rtn_u32 v6, v6, v4
    s_waitcnt lgkmcnt(12)
    v_lshrrev_b32 v127, 5, v8
    v_bfe_u32 v0, s92, v8, 8
    v_bfe_u32 v8, v8, 3, 2
    v_mad_u32_u24 v0, v127, 20, v0
    v_mad_u32_u24 v8, v127, 20, v8
    ds_write_b32 v0, v32 offset:8704
    ds_write_b8_d16_hi v8, v56 offset:8712
    s_waitcnt lgkmcnt(11)
    v_lshrrev_b32 v127, 5, v9
    v_bfe_u32 v0, s92, v9, 8
    v_bfe_u32 v9, v9, 3, 2
    v_mad_u32_u24 v0, v127, 20, v0
    v_mad_u32_u24 v9, v127, 20, v9
    ds_write_b32 v0, v33 offset:8704
    ds_write_b8_d16_hi v9, v57 offset:8712
    s_waitcnt lgkmcnt(10)
    v_lshrrev_b32 v127, 5, v10
    v_bfe_u32 v0, s92, v10, 8
    v_bfe_u32 v10, v10, 3, 2
    v_mad_u32_u24 v0, v127, 20, v0
    v_mad_u32_u24 v10, v127, 20, v10
    ds_write_b32 v0, v34 offset:8704
    ds_write_b8_d16_hi v10, v58 offset:8712
    s_mov_b32 s43, 18432000
    buffer_load_dwordx2 v[120:121], v2, s[16:19], s43 offen nt
    s_waitcnt lgkmcnt(9)
    v_lshrrev_b32 v127, 5, v11
    v_bfe_u32 v0, s92, v11, 8
    v_bfe_u32 v11, v11, 3, 2
    v_mad_u32_u24 v0, v127, 20, v0
    v_mad_u32_u24 v11, v127, 20, v11
    ds_write_b32 v0, v35 offset:8704
    ds_write_b8_d16_hi v11, v59 offset:8712
    s_waitcnt lgkmcnt(8)
    v_lshrrev_b32 v127, 5, v6
    v_bfe_u32 v0, s92, v6, 8
    v_bfe_u32 v6, v6, 3, 2
    v_mad_u32_u24 v0, v127, 20, v0
    v_mad_u32_u24 v6, v127, 20, v6
    ds_write_b32 v0, v60 offset:8704
    ds_write_b8_d16_hi v6, v61 offset:8712
    v_add_u32 v127, 65536, v1
    v_add_u32 v0, 131072, v1
    s_waitcnt lgkmcnt(0)
    s_barrier
    v_mov_b32 v6, 0
    ds_write_b32 v3, v6
    ds_read_b128 v[12:15], v1 offset:8704
    ds_read_b128 v[16:19], v1 offset:25088
    s_mov_b32 s44, 40960000
    buffer_load_dwordx4 v[80:83], v1, s[8:11], s44 offen nt
    ds_read_b128 v[20:23], v1 offset:41472
    ds_read_b128 v[24:27], v1 offset:57856
    ds_read_b128 v[28:31], v127 offset:8704
    s_mov_b32 s44, 40960000
    buffer_load_dwordx4 v[104:107], v1, s[12:15], s44 offen nt
    ds_read_b128 v[32:35], v127 offset:25088
    ds_read_b128 v[36:39], v127 offset:41472
    ds_read_b128 v[40:43], v127 offset:57856
    s_mov_b32 s45, 20480000
    buffer_load_dwordx2 v[122:123], v2, s[16:19], s45 offen nt
    ds_read_b128 v[44:47], v0 offset:8704
    s_waitcnt lgkmcnt(0)
    s_barrier
    s_mov_b32 s42, 45056000
    buffer_load_dwordx4 v[84:87], v1, s[8:11], s42 offen nt
    s_mov_b32 s42, 45056000
    buffer_load_dwordx4 v[108:111], v1, s[12:15], s42 offen nt
    s_mov_b32 s43, 22528000
    buffer_load_dwordx2 v[124:125], v2, s[16:19], s43 offen nt
    s_sub_u32 s44, 50176000, s59
    buffer_load_dword v112, v3, s[8:11], s44 offen nt
    s_sub_u32 s44, 50176000, s59
    buffer_load_dword v113, v3, s[12:15], s44 offen nt
    s_sub_u32 s45, 50176000, s59
    s_lshr_b32 s45, s45, 1
    v_lshrrev_b32 v126, 1, v3
    buffer_load_ushort v126, v126, s[16:19], s45 offen nt
    s_waitcnt vmcnt(19)
    v_mul_hi_u32_u24 v6, s48, v88
    v_mul_hi_u32_u24 v8, s48, v89
    v_mul_hi_u32_u24 v7, s49, v64
    v_mul_hi_u32_u24 v9, s49, v65
    v_mad_i32_i24 v88, v6, s50, v88
    v_mad_i32_i24 v89, v8, s50, v89
    v_mad_i32_i24 v64, v7, s98, v64
    v_mad_i32_i24 v65, v9, s98, v65
    v_lshl_add_u32 v6, v7, 7, v6
    v_lshl_add_u32 v8, v9, 7, v8
    s_waitcnt vmcnt(18)
    v_lshlrev_b32 v7, 16, v114
    v_and_b32 v9, 0xffff0000, v114
    v_mul_f32_e64 v7, |v7|, s99
    v_mul_f32_e64 v9, |v9|, s99
    v_or3_b32 v5, v5, v7, v9
    v_lshlrev_b32_sdwa v7, 3, v88 dst_sel:WORD_0 dst_unused:UNUSED_PRESERVE src0_sel:DWORD src1_sel:DWORD
    v_lshlrev_b32_sdwa v9, 3, v89 dst_sel:WORD_0 dst_unused:UNUSED_PRESERVE src0_sel:DWORD src1_sel:DWORD
    v_lshlrev_b32 v88, 2, v6
    v_lshlrev_b32 v89, 2, v8
    v_alignbit_b32 v7, v7, v7, 23
    v_alignbit_b32 v9, v9, v9, 23
    ds_add_u32 v88, v4
    ds_add_u32 v89, v4
    v_add_u32 v6, 2048, v64
    v_add_u32 v8, 2048, v65
    v_and_or_b32 v64, v64, s93, v62
    v_and_or_b32 v65, v65, s93, v62
    v_lshrrev_b32_sdwa v88, 9, v6 dst_sel:WORD_1 dst_unused:UNUSED_PRESERVE src0_sel:DWORD src1_sel:DWORD
    v_lshrrev_b32_sdwa v89, 9, v8 dst_sel:WORD_1 dst_unused:UNUSED_PRESERVE src0_sel:DWORD src1_sel:DWORD
    v_lshl_add_u32 v64, v64, 3, v7
    v_lshl_add_u32 v65, v65, 3, v9
    v_mul_hi_u32_u24 v6, s48, v90
    v_mul_hi_u32_u24 v8, s48, v91
    v_mul_hi_u32_u24 v7, s49, v66
    v_mul_hi_u32_u24 v9, s49, v67
    v_mad_i32_i24 v90, v6, s50, v90
    v_mad_i32_i24 v91, v8, s50, v91
    v_mad_i32_i24 v66, v7, s98, v66
    v_mad_i32_i24 v67, v9, s98, v67
    v_lshl_add_u32 v6, v7, 7, v6
    v_lshl_add_u32 v8, v9, 7, v8
    v_lshlrev_b32 v7, 16, v115
    v_and_b32 v9, 0xffff0000, v115
    v_mul_f32_e64 v7, |v7|, s99
    v_mul_f32_e64 v9, |v9|, s99
    v_or3_b32 v5, v5, v7, v9
    v_lshlrev_b32_sdwa v7, 3, v90 dst_sel:WORD_0 dst_unused:UNUSED_PRESERVE src0_sel:DWORD src1_sel:DWORD
    v_lshlrev_b32_sdwa v9, 3, v91 dst_sel:WORD_0 dst_unused:UNUSED_PRESERVE src0_sel:DWORD src1_sel:DWORD
    v_lshlrev_b32 v90, 2, v6
    v_lshlrev_b32 v91, 2, v8
    v_alignbit_b32 v7, v7, v7, 23
    v_alignbit_b32 v9, v9, v9, 23
    ds_add_u32 v90, v4
    ds_add_u32 v91, v4
    v_add_u32 v6, 2048, v66
    v_add_u32 v8, 2048, v67
    v_and_or_b32 v66, v66, s93, v62
    v_and_or_b32 v67, v67, s93, v62
    v_lshrrev_b32_sdwa v90, 9, v6 dst_sel:WORD_1 dst_unused:UNUSED_PRESERVE src0_sel:DWORD src1_sel:DWORD
    v_lshrrev_b32_sdwa v91, 9, v8 dst_sel:WORD_1 dst_unused:UNUSED_PRESERVE src0_sel:DWORD src1_sel:DWORD
    v_lshl_add_u32 v66, v66, 3, v7
    v_lshl_add_u32 v67, v67, 3, v9
    s_waitcnt vmcnt(16)
    v_mul_hi_u32_u24 v6, s48, v92
    v_mul_hi_u32_u24 v8, s48, v93
    v_mul_hi_u32_u24 v7, s49, v68
    v_mul_hi_u32_u24 v9, s49, v69
    v_mad_i32_i24 v92, v6, s50, v92
    v_mad_i32_i24 v93, v8, s50, v93
    v_mad_i32_i24 v68, v7, s98, v68
    v_mad_i32_i24 v69, v9, s98, v69
    v_lshl_add_u32 v6, v7, 7, v6
    v_lshl_add_u32 v8, v9, 7, v8
    s_waitcnt vmcnt(15)
    v_lshlrev_b32 v7, 16, v116
    v_and_b32 v9, 0xffff0000, v116
    v_mul_f32_e64 v7, |v7|, s99
    v_mul_f32_e64 v9, |v9|, s99
    v_or3_b32 v5, v5, v7, v9
    v_lshlrev_b32_sdwa v7, 3, v92 dst_sel:WORD_0 dst_unused:UNUSED_PRESERVE src0_sel:DWORD src1_sel:DWORD
    v_lshlrev_b32_sdwa v9, 3, v93 dst_sel:WORD_0 dst_unused:UNUSED_PRESERVE src0_sel:DWORD src1_sel:DWORD
    v_lshlrev_b32 v92, 2, v6
    v_lshlrev_b32 v93, 2, v8
    v_alignbit_b32 v7, v7, v7, 23
    v_alignbit_b32 v9, v9, v9, 23
    ds_add_u32 v92, v4
    ds_add_u32 v93, v4
    v_add_u32 v6, 2048, v68
    v_add_u32 v8, 2048, v69
    v_and_or_b32 v68, v68, s93, v62
    v_and_or_b32 v69, v69, s93, v62
    v_lshrrev_b32_sdwa v92, 9, v6 dst_sel:WORD_1 dst_unused:UNUSED_PRESERVE src0_sel:DWORD src1_sel:DWORD
    v_lshrrev_b32_sdwa v93, 9, v8 dst_sel:WORD_1 dst_unused:UNUSED_PRESERVE src0_sel:DWORD src1_sel:DWORD
    v_lshl_add_u32 v68, v68, 3, v7
    v_lshl_add_u32 v69, v69, 3, v9
    v_mul_hi_u32_u24 v6, s48, v94
    v_mul_hi_u32_u24 v8, s48, v95
    v_mul_hi_u32_u24 v7, s49, v70
    v_mul_hi_u32_u24 v9, s49, v71
    v_mad_i32_i24 v94, v6, s50, v94
    v_mad_i32_i24 v95, v8, s50, v95
    v_mad_i32_i24 v70, v7, s98, v70
    v_mad_i32_i24 v71, v9, s98, v71
    v_lshl_add_u32 v6, v7, 7, v6
    v_lshl_add_u32 v8, v9, 7, v8
    v_lshlrev_b32 v7, 16, v117
    v_and_b32 v9, 0xffff0000, v117
    v_mul_f32_e64 v7, |v7|, s99
    v_mul_f32_e64 v9, |v9|, s99
    v_or3_b32 v5, v5, v7, v9
    v_lshlrev_b32_sdwa v7, 3, v94 dst_sel:WORD_0 dst_unused:UNUSED_PRESERVE src0_sel:DWORD src1_sel:DWORD
    v_lshlrev_b32_sdwa v9, 3, v95 dst_sel:WORD_0 dst_unused:UNUSED_PRESERVE src0_sel:DWORD src1_sel:DWORD
    v_lshlrev_b32 v94, 2, v6
    v_lshlrev_b32 v95, 2, v8
    v_alignbit_b32 v7, v7, v7, 23
    v_alignbit_b32 v9, v9, v9, 23
    ds_add_u32 v94, v4
    ds_add_u32 v95, v4
    v_add_u32 v6, 2048, v70
    v_add_u32 v8, 2048, v71
    v_and_or_b32 v70, v70, s93, v62
    v_and_or_b32 v71, v71, s93, v62
    v_lshrrev_b32_sdwa v94, 9, v6 dst_sel:WORD_1 dst_unused:UNUSED_PRESERVE src0_sel:DWORD src1_sel:DWORD
    v_lshrrev_b32_sdwa v95, 9, v8 dst_sel:WORD_1 dst_unused:UNUSED_PRESERVE src0_sel:DWORD src1_sel:DWORD
    v_lshl_add_u32 v70, v70, 3, v7
    v_lshl_add_u32 v71, v71, 3, v9
    s_waitcnt vmcnt(13)
    v_mul_hi_u32_u24 v6, s48, v96
    v_mul_hi_u32_u24 v8, s48, v97
    v_mul_hi_u32_u24 v7, s49, v72
    v_mul_hi_u32_u24 v9, s49, v73
    v_mad_i32_i24 v96, v6, s50, v96
    v_mad_i32_i24 v97, v8, s50, v97
    v_mad_i32_i24 v72, v7, s98, v72
    v_mad_i32_i24 v73, v9, s98, v73
    v_lshl_add_u32 v6, v7, 7, v6
    v_lshl_add_u32 v8, v9, 7, v8
    s_waitcnt vmcnt(12)
    v_lshlrev_b32 v7, 16, v118
    v_and_b32 v9, 0xffff0000, v118
    v_mul_f32_e64 v7, |v7|, s99
    v_mul_f32_e64 v9, |v9|, s99
    v_or3_b32 v5, v5, v7, v9
    v_lshlrev_b32_sdwa v7, 3, v96 dst_sel:WORD_0 dst_unused:UNUSED_PRESERVE src0_sel:DWORD src1_sel:DWORD
    v_lshlrev_b32_sdwa v9, 3, v97 dst_sel:WORD_0 dst_unused:UNUSED_PRESERVE src0_sel:DWORD src1_sel:DWORD
    v_lshlrev_b32 v96, 2, v6
    v_lshlrev_b32 v97, 2, v8
    v_alignbit_b32 v7, v7, v7, 23
    v_alignbit_b32 v9, v9, v9, 23
    ds_add_u32 v96, v4
    ds_add_u32 v97, v4
    v_add_u32 v6, 2048, v72
    v_add_u32 v8, 2048, v73
    v_and_or_b32 v72, v72, s93, v62
    v_and_or_b32 v73, v73, s93, v62
    v_lshrrev_b32_sdwa v96, 9, v6 dst_sel:WORD_1 dst_unused:UNUSED_PRESERVE src0_sel:DWORD src1_sel:DWORD
    v_lshrrev_b32_sdwa v97, 9, v8 dst_sel:WORD_1 dst_unused:UNUSED_PRESERVE src0_sel:DWORD src1_sel:DWORD
    v_lshl_add_u32 v72, v72, 3, v7
    v_lshl_add_u32 v73, v73, 3, v9
    v_mul_hi_u32_u24 v6, s48, v98
    v_mul_hi_u32_u24 v8, s48, v99
    v_mul_hi_u32_u24 v7, s49, v74
    v_mul_hi_u32_u24 v9, s49, v75
    v_mad_i32_i24 v98, v6, s50, v98
    v_mad_i32_i24 v99, v8, s50, v99
    v_mad_i32_i24 v74, v7, s98, v74
    v_mad_i32_i24 v75, v9, s98, v75
    v_lshl_add_u32 v6, v7, 7, v6
    v_lshl_add_u32 v8, v9, 7, v8
    v_lshlrev_b32 v7, 16, v119
    v_and_b32 v9, 0xffff0000, v119
    v_mul_f32_e64 v7, |v7|, s99
    v_mul_f32_e64 v9, |v9|, s99
    v_or3_b32 v5, v5, v7, v9
    v_lshlrev_b32_sdwa v7, 3, v98 dst_sel:WORD_0 dst_unused:UNUSED_PRESERVE src0_sel:DWORD src1_sel:DWORD
    v_lshlrev_b32_sdwa v9, 3, v99 dst_sel:WORD_0 dst_unused:UNUSED_PRESERVE src0_sel:DWORD src1_sel:DWORD
    v_lshlrev_b32 v98, 2, v6
    v_lshlrev_b32 v99, 2, v8
    v_alignbit_b32 v7, v7, v7, 23
    v_alignbit_b32 v9, v9, v9, 23
    ds_add_u32 v98, v4
    ds_add_u32 v99, v4
    v_add_u32 v6, 2048, v74
    v_add_u32 v8, 2048, v75
    v_and_or_b32 v74, v74, s93, v62
    v_and_or_b32 v75, v75, s93, v62
    v_lshrrev_b32_sdwa v98, 9, v6 dst_sel:WORD_1 dst_unused:UNUSED_PRESERVE src0_sel:DWORD src1_sel:DWORD
    v_lshrrev_b32_sdwa v99, 9, v8 dst_sel:WORD_1 dst_unused:UNUSED_PRESERVE src0_sel:DWORD src1_sel:DWORD
    v_lshl_add_u32 v74, v74, 3, v7
    v_lshl_add_u32 v75, v75, 3, v9
    s_waitcnt vmcnt(10)
    v_mul_hi_u32_u24 v6, s48, v100
    v_mul_hi_u32_u24 v8, s48, v101
    v_mul_hi_u32_u24 v7, s49, v76
    v_mul_hi_u32_u24 v9, s49, v77
    v_mad_i32_i24 v100, v6, s50, v100
    v_mad_i32_i24 v101, v8, s50, v101
    v_mad_i32_i24 v76, v7, s98, v76
    v_mad_i32_i24 v77, v9, s98, v77
    v_lshl_add_u32 v6, v7, 7, v6
    v_lshl_add_u32 v8, v9, 7, v8
    s_waitcnt vmcnt(9)
    v_lshlrev_b32 v7, 16, v120
    v_and_b32 v9, 0xffff0000, v120
    v_mul_f32_e64 v7, |v7|, s99
    v_mul_f32_e64 v9, |v9|, s99
    v_or3_b32 v5, v5, v7, v9
    v_lshlrev_b32_sdwa v7, 3, v100 dst_sel:WORD_0 dst_unused:UNUSED_PRESERVE src0_sel:DWORD src1_sel:DWORD
    v_lshlrev_b32_sdwa v9, 3, v101 dst_sel:WORD_0 dst_unused:UNUSED_PRESERVE src0_sel:DWORD src1_sel:DWORD
    v_lshlrev_b32 v100, 2, v6
    v_lshlrev_b32 v101, 2, v8
    v_alignbit_b32 v7, v7, v7, 23
    v_alignbit_b32 v9, v9, v9, 23
    ds_add_u32 v100, v4
    ds_add_u32 v101, v4
    v_add_u32 v6, 2048, v76
    v_add_u32 v8, 2048, v77
    v_and_or_b32 v76, v76, s93, v62
    v_and_or_b32 v77, v77, s93, v62
    v_lshrrev_b32_sdwa v100, 9, v6 dst_sel:WORD_1 dst_unused:UNUSED_PRESERVE src0_sel:DWORD src1_sel:DWORD
    v_lshrrev_b32_sdwa v101, 9, v8 dst_sel:WORD_1 dst_unused:UNUSED_PRESERVE src0_sel:DWORD src1_sel:DWORD
    v_lshl_add_u32 v76, v76, 3, v7
    v_lshl_add_u32 v77, v77, 3, v9
    v_mul_hi_u32_u24 v6, s48, v102
    v_mul_hi_u32_u24 v8, s48, v103
    v_mul_hi_u32_u24 v7, s49, v78
    v_mul_hi_u32_u24 v9, s49, v79
    v_mad_i32_i24 v102, v6, s50, v102
    v_mad_i32_i24 v103, v8, s50, v103
    v_mad_i32_i24 v78, v7, s98, v78
    v_mad_i32_i24 v79, v9, s98, v79
    v_lshl_add_u32 v6, v7, 7, v6
    v_lshl_add_u32 v8, v9, 7, v8
    v_lshlrev_b32 v7, 16, v121
    v_and_b32 v9, 0xffff0000, v121
    v_mul_f32_e64 v7, |v7|, s99
    v_mul_f32_e64 v9, |v9|, s99
    v_or3_b32 v5, v5, v7, v9
    v_lshlrev_b32_sdwa v7, 3, v102 dst_sel:WORD_0 dst_unused:UNUSED_PRESERVE src0_sel:DWORD src1_sel:DWORD
    v_lshlrev_b32_sdwa v9, 3, v103 dst_sel:WORD_0 dst_unused:UNUSED_PRESERVE src0_sel:DWORD src1_sel:DWORD
    v_lshlrev_b32 v102, 2, v6
    v_lshlrev_b32 v103, 2, v8
    v_alignbit_b32 v7, v7, v7, 23
    v_alignbit_b32 v9, v9, v9, 23
    ds_add_u32 v102, v4
    ds_add_u32 v103, v4
    v_add_u32 v6, 2048, v78
    v_add_u32 v8, 2048, v79
    v_and_or_b32 v78, v78, s93, v62
    v_and_or_b32 v79, v79, s93, v62
    v_lshrrev_b32_sdwa v102, 9, v6 dst_sel:WORD_1 dst_unused:UNUSED_PRESERVE src0_sel:DWORD src1_sel:DWORD
    v_lshrrev_b32_sdwa v103, 9, v8 dst_sel:WORD_1 dst_unused:UNUSED_PRESERVE src0_sel:DWORD src1_sel:DWORD
    v_lshl_add_u32 v78, v78, 3, v7
    v_lshl_add_u32 v79, v79, 3, v9
    s_waitcnt vmcnt(7)
    v_mul_hi_u32_u24 v6, s48, v104
    v_mul_hi_u32_u24 v8, s48, v105
    v_mul_hi_u32_u24 v7, s49, v80
    v_mul_hi_u32_u24 v9, s49, v81
    v_mad_i32_i24 v104, v6, s50, v104
    v_mad_i32_i24 v105, v8, s50, v105
    v_mad_i32_i24 v80, v7, s98, v80
    v_mad_i32_i24 v81, v9, s98, v81
    v_lshl_add_u32 v6, v7, 7, v6
    v_lshl_add_u32 v8, v9, 7, v8
    s_waitcnt vmcnt(6)
    v_lshlrev_b32 v7, 16, v122
    v_and_b32 v9, 0xffff0000, v122
    v_mul_f32_e64 v7, |v7|, s99
    v_mul_f32_e64 v9, |v9|, s99
    v_or3_b32 v5, v5, v7, v9
    v_lshlrev_b32_sdwa v7, 3, v104 dst_sel:WORD_0 dst_unused:UNUSED_PRESERVE src0_sel:DWORD src1_sel:DWORD
    v_lshlrev_b32_sdwa v9, 3, v105 dst_sel:WORD_0 dst_unused:UNUSED_PRESERVE src0_sel:DWORD src1_sel:DWORD
    v_lshlrev_b32 v104, 2, v6
    v_lshlrev_b32 v105, 2, v8
    v_alignbit_b32 v7, v7, v7, 23
    v_alignbit_b32 v9, v9, v9, 23
    ds_add_u32 v104, v4
    ds_add_u32 v105, v4
    v_add_u32 v6, 2048, v80
    v_add_u32 v8, 2048, v81
    v_and_or_b32 v80, v80, s93, v62
    v_and_or_b32 v81, v81, s93, v62
    v_lshrrev_b32_sdwa v104, 9, v6 dst_sel:WORD_1 dst_unused:UNUSED_PRESERVE src0_sel:DWORD src1_sel:DWORD
    v_lshrrev_b32_sdwa v105, 9, v8 dst_sel:WORD_1 dst_unused:UNUSED_PRESERVE src0_sel:DWORD src1_sel:DWORD
    v_lshl_add_u32 v80, v80, 3, v7
    v_lshl_add_u32 v81, v81, 3, v9
    v_mul_hi_u32_u24 v6, s48, v106
    v_mul_hi_u32_u24 v8, s48, v107
    v_mul_hi_u32_u24 v7, s49, v82
    v_mul_hi_u32_u24 v9, s49, v83
    v_mad_i32_i24 v106, v6, s50, v106
    v_mad_i32_i24 v107, v8, s50, v107
    v_mad_i32_i24 v82, v7, s98, v82
    v_mad_i32_i24 v83, v9, s98, v83
    v_lshl_add_u32 v6, v7, 7, v6
    v_lshl_add_u32 v8, v9, 7, v8
    v_lshlrev_b32 v7, 16, v123
    v_and_b32 v9, 0xffff0000, v123
    v_mul_f32_e64 v7, |v7|, s99
    v_mul_f32_e64 v9, |v9|, s99
    v_or3_b32 v5, v5, v7, v9
    v_lshlrev_b32_sdwa v7, 3, v106 dst_sel:WORD_0 dst_unused:UNUSED_PRESERVE src0_sel:DWORD src1_sel:DWORD
    v_lshlrev_b32_sdwa v9, 3, v107 dst_sel:WORD_0 dst_unused:UNUSED_PRESERVE src0_sel:DWORD src1_sel:DWORD
    v_lshlrev_b32 v106, 2, v6
    v_lshlrev_b32 v107, 2, v8
    v_alignbit_b32 v7, v7, v7, 23
    v_alignbit_b32 v9, v9, v9, 23
    ds_add_u32 v106, v4
    ds_add_u32 v107, v4
    v_add_u32 v6, 2048, v82
    v_add_u32 v8, 2048, v83
    v_and_or_b32 v82, v82, s93, v62
    v_and_or_b32 v83, v83, s93, v62
    v_lshrrev_b32_sdwa v106, 9, v6 dst_sel:WORD_1 dst_unused:UNUSED_PRESERVE src0_sel:DWORD src1_sel:DWORD
    v_lshrrev_b32_sdwa v107, 9, v8 dst_sel:WORD_1 dst_unused:UNUSED_PRESERVE src0_sel:DWORD src1_sel:DWORD
    v_lshl_add_u32 v82, v82, 3, v7
    v_lshl_add_u32 v83, v83, 3, v9
    s_waitcnt vmcnt(4)
    v_mul_hi_u32_u24 v6, s48, v108
    v_mul_hi_u32_u24 v8, s48, v109
    v_mul_hi_u32_u24 v7, s49, v84
    v_mul_hi_u32_u24 v9, s49, v85
    v_mad_i32_i24 v108, v6, s50, v108
    v_mad_i32_i24 v109, v8, s50, v109
    v_mad_i32_i24 v84, v7, s98, v84
    v_mad_i32_i24 v85, v9, s98, v85
    v_lshl_add_u32 v6, v7, 7, v6
    v_lshl_add_u32 v8, v9, 7, v8
    s_waitcnt vmcnt(3)
    v_lshlrev_b32 v7, 16, v124
    v_and_b32 v9, 0xffff0000, v124
    v_mul_f32_e64 v7, |v7|, s99
    v_mul_f32_e64 v9, |v9|, s99
    v_or3_b32 v5, v5, v7, v9
    v_lshlrev_b32_sdwa v7, 3, v108 dst_sel:WORD_0 dst_unused:UNUSED_PRESERVE src0_sel:DWORD src1_sel:DWORD
    v_lshlrev_b32_sdwa v9, 3, v109 dst_sel:WORD_0 dst_unused:UNUSED_PRESERVE src0_sel:DWORD src1_sel:DWORD
    v_lshlrev_b32 v108, 2, v6
    v_lshlrev_b32 v109, 2, v8
    v_alignbit_b32 v7, v7, v7, 23
    v_alignbit_b32 v9, v9, v9, 23
    ds_add_u32 v108, v4
    ds_add_u32 v109, v4
    v_add_u32 v6, 2048, v84
    v_add_u32 v8, 2048, v85
    v_and_or_b32 v84, v84, s93, v62
    v_and_or_b32 v85, v85, s93, v62
    v_lshrrev_b32_sdwa v108, 9, v6 dst_sel:WORD_1 dst_unused:UNUSED_PRESERVE src0_sel:DWORD src1_sel:DWORD
    v_lshrrev_b32_sdwa v109, 9, v8 dst_sel:WORD_1 dst_unused:UNUSED_PRESERVE src0_sel:DWORD src1_sel:DWORD
    v_lshl_add_u32 v84, v84, 3, v7
    v_lshl_add_u32 v85, v85, 3, v9
    v_mul_hi_u32_u24 v6, s48, v110
    v_mul_hi_u32_u24 v8, s48, v111
    v_mul_hi_u32_u24 v7, s49, v86
    v_mul_hi_u32_u24 v9, s49, v87
    v_mad_i32_i24 v110, v6, s50, v110
    v_mad_i32_i24 v111, v8, s50, v111
    v_mad_i32_i24 v86, v7, s98, v86
    v_mad_i32_i24 v87, v9, s98, v87
    v_lshl_add_u32 v6, v7, 7, v6
    v_lshl_add_u32 v8, v9, 7, v8
    v_lshlrev_b32 v7, 16, v125
    v_and_b32 v9, 0xffff0000, v125
    v_mul_f32_e64 v7, |v7|, s99
    v_mul_f32_e64 v9, |v9|, s99
    v_or3_b32 v5, v5, v7, v9
    v_lshlrev_b32_sdwa v7, 3, v110 dst_sel:WORD_0 dst_unused:UNUSED_PRESERVE src0_sel:DWORD src1_sel:DWORD
    v_lshlrev_b32_sdwa v9, 3, v111 dst_sel:WORD_0 dst_unused:UNUSED_PRESERVE src0_sel:DWORD src1_sel:DWORD
    v_lshlrev_b32 v110, 2, v6
    v_lshlrev_b32 v111, 2, v8
    v_alignbit_b32 v7, v7, v7, 23
    v_alignbit_b32 v9, v9, v9, 23
    ds_add_u32 v110, v4
    ds_add_u32 v111, v4
    v_add_u32 v6, 2048, v86
    v_add_u32 v8, 2048, v87
    v_and_or_b32 v86, v86, s93, v62
    v_and_or_b32 v87, v87, s93, v62
    v_lshrrev_b32_sdwa v110, 9, v6 dst_sel:WORD_1 dst_unused:UNUSED_PRESERVE src0_sel:DWORD src1_sel:DWORD
    v_lshrrev_b32_sdwa v111, 9, v8 dst_sel:WORD_1 dst_unused:UNUSED_PRESERVE src0_sel:DWORD src1_sel:DWORD
    v_lshl_add_u32 v86, v86, 3, v7
    v_lshl_add_u32 v87, v87, 3, v9
    s_waitcnt vmcnt(1)
    v_mul_hi_u32_u24 v6, s48, v113
    v_mul_hi_u32_u24 v7, s49, v112
    v_mad_i32_i24 v113, v6, s50, v113
    v_mad_i32_i24 v112, v7, s98, v112
    v_lshl_add_u32 v6, v7, 7, v6
    s_waitcnt vmcnt(0)
    v_lshlrev_b32 v7, 16, v126
    v_mul_f32_e64 v7, |v7|, s99
    v_or3_b32 v5, v5, v7, v7
    v_lshlrev_b32_sdwa v7, 3, v113 dst_sel:WORD_0 dst_unused:UNUSED_PRESERVE src0_sel:DWORD src1_sel:DWORD
    v_lshlrev_b32 v113, 2, v6
    v_alignbit_b32 v7, v7, v7, 23
    ds_add_u32 v113, v4
    v_add_u32 v6, 2048, v112
    v_and_or_b32 v112, v112, s93, v62
    v_lshrrev_b32_sdwa v113, 9, v6 dst_sel:WORD_1 dst_unused:UNUSED_PRESERVE src0_sel:DWORD src1_sel:DWORD
    v_lshl_add_u32 v112, v112, 3, v7
    s_waitcnt lgkmcnt(0)
    s_barrier
    ds_read_b32 v6, v3
    v_mov_b32 v8, s47
    v_mov_b32 v9, 0
    v_cmpx_lt_u32 vcc, 0x3ffffff, v5
    ds_write_b32 v9, v5 offset:8320
    s_mov_b64 exec, -1
    s_waitcnt lgkmcnt(1)
    v_add_u32 v6, 8, v6
    v_lshrrev_b32 v6, 4, v6
    v_mov_b32 v7, v6
    s_nop 1
    v_add_u32_dpp v7, v7, v7 row_shr:1 row_mask:0xf bank_mask:0xf
    s_nop 1
    v_add_u32_dpp v7, v7, v7 row_shr:2 row_mask:0xf bank_mask:0xf
    s_nop 1
    v_add_u32_dpp v7, v7, v7 row_shr:4 row_mask:0xf bank_mask:0xf
    s_nop 1
    v_add_u32_dpp v7, v7, v7 row_shr:8 row_mask:0xf bank_mask:0xf
    s_nop 1
    v_add_u32_dpp v7, v7, v7 row_bcast:15 row_mask:0xa bank_mask:0xf
    s_nop 1
    v_add_u32_dpp v7, v7, v7 row_bcast:31 row_mask:0xc bank_mask:0xf
    s_mov_b32 exec_lo, 0
    s_brev_b32 exec_hi, 1
    ds_write_b32 v8, v7 offset:4096
    s_mov_b64 exec, -1
    v_sub_u32 v9, v7, v6
    v_lshl_or_b32 v9, v7, 16, v9
    v_and_b32 v8, 0x7ff, v1
    v_add_u32 v8, s97, v8
    ds_write_b32 v8, v9 offset:4160
    v_and_b32 v8, 63, v3
    s_mov_b32 s42, 0
    buffer_store_dwordx4 v[12:15], v1, s[20:23], s42 offen sc1
    s_waitcnt lgkmcnt(0)
    s_barrier
    ds_read_b32 v9, v8 offset:4096
    ds_read_b32 v11, v3 offset:4160
    v_and_b32 v8, 24, v2
    s_and_b32 s58, s47, 32
    s_and_b32 s51, s46, 4
    s_or_b32 s58, s58, s51
    v_or_b32 v8, s58, v8
    s_waitcnt lgkmcnt(1)
    v_mov_b32 v10, v9
    s_nop 1
    v_add_u32_dpp v10, v10, v10 row_shr:1 row_mask:0xf bank_mask:0xf
    s_nop 1
    v_add_u32_dpp v10, v10, v10 row_shr:2 row_mask:0xf bank_mask:0xf
    s_nop 1
    v_add_u32_dpp v10, v10, v10 row_shr:4 row_mask:0xf bank_mask:0xf
    s_nop 1
    v_add_u32_dpp v10, v10, v10 row_shr:8 row_mask:0xf bank_mask:0xf
    v_sub_u32 v9, v10, v9
    ds_bpermute_b32 v8, v8, v9
    v_readlane_b32 s51, v10, 15
    v_readlane_b32 s52, v9, s46
    v_mov_b32 v9, 0
    s_nop 0
    v_add_u32 v7, s52, v7
    v_sub_u32 v6, v7, v6
    v_lshlrev_b32 v6, 4, v6
    v_and_b32 v10, 1, v7
    v_mul_u32_u24 v7, 10, v7
    v_mad_i32_i24 v7, v10, -6, v7
    ds_write_b32 v3, v6
    ds_write_b32 v7, v9 offset:8700
    v_mad_u32_u24 v10, v10, 14, v7
    ds_write_b8 v10, v9 offset:8695
    s_mov_b32 s58, 0x10001
    s_waitcnt lgkmcnt(3)
    v_mad_u32_u24 v11, v8, s58, v11
    s_mul_i32 s51, s51, 10
    s_add_u32 s51, s51, 265
    s_and_b32 s10, s51, -256
    ds_read_b32 v6, v9 offset:8320
    s_lshl_b32 s58, s2, 2
    s_add_u32 s58, s58, 2166784
    v_mov_b32 v10, v63
    s_waitcnt lgkmcnt(0)
    v_min_u32 v6, 0xffff, v6
    v_or_b32 v6, s96, v6
    s_cmp_eq_u32 s46, 0
    s_cselect_b64 exec, 1, 0
    buffer_store_dword v6, off, s[28:31], s58 sc1
    s_mov_b64 exec, -1
    buffer_store_dwordx2 v[10:11], v2, s[28:31], s53 offen sc1
    s_mov_b64 s[8:9], s[32:33]
    s_mov_b32 s43, 16384
    buffer_store_dwordx4 v[16:19], v1, s[20:23], s43 offen sc1
    s_waitcnt lgkmcnt(0)
    s_barrier
    v_and_b32 v6, 0xffff, v88
    ds_add_rtn_u32 v6, v6, v4
    s_mov_b32 s24, s46
    s_and_b32 s25, s2, 6
    s_lshl_b32 s25, s25, 5
    s_lshr_b32 s100, s2, 3
    s_lshl1_add_u32 s25, s100, s25
    s_and_b32 s100, s2, 1
    s_add_u32 s25, s25, s100
    s_add_u32 s4, s40, 0
    s_addc_u32 s5, s41, 0
    s_mov_b32 s6, 75497472
    s_mov_b32 s7, 0x00020000
    s_add_u32 s12, s40, 83886080
    s_addc_u32 s13, s41, 0
    s_mov_b32 s14, 2048000
    s_mov_b32 s15, 0x00020000
    s_add_u32 s16, s40, 86052864
    s_addc_u32 s17, s41, 0
    s_mov_b32 s18, 1000
    s_mov_b32 s19, 0x00020000
    s_and_b32 s28, s25, 1
    s_mul_i32 s28, s28, 255
    s_add_u32 s28, s28, s25
    s_lshl_b32 s28, s28, 4
    v_lshrrev_b32 v115, 4, v3
    v_and_b32 v123, 24, v2
    v_lshl_or_b32 v115, v115, 13, v123
    v_and_b32 v123, 0x3ff, v1
    v_mov_b32 v118, 0
    v_lshlrev_b32 v121, 5, v3
    v_and_b32 v121, 0x7ff, v121
    v_add_u32 v121, 86048768, v121
    s_and_b32 s100, s2, 15
    s_lshl_b32 s100, s100, 7
    s_add_u32 s100, s100, 86048768
    v_mov_b32 v122, s100
    v_and_b32 v7, 0xffff, v89
    ds_add_rtn_u32 v7, v7, v4
    s_mov_b32 s44, 32768
    buffer_store_dwordx4 v[20:23], v1, s[20:23], s44 offen sc1
    v_and_b32 v8, 0xffff, v90
    ds_add_rtn_u32 v8, v8, v4
    v_and_b32 v9, 0xffff, v91
    ds_add_rtn_u32 v9, v9, v4
    v_and_b32 v10, 0xffff, v92
    ds_add_rtn_u32 v10, v10, v4
    s_waitcnt lgkmcnt(4)
    v_lshrrev_b32 v127, 5, v6
    v_bfe_u32 v0, s92, v6, 8
    v_bfe_u32 v6, v6, 3, 2
    v_mad_u32_u24 v0, v127, 20, v0
    v_mad_u32_u24 v6, v127, 20, v6
    ds_write_b32 v0, v64 offset:8704
    ds_write_b8_d16_hi v6, v88 offset:8712
    v_and_b32 v11, 0xffff, v93
    ds_add_rtn_u32 v11, v11, v4
    s_mov_b32 s45, 49152
    buffer_store_dwordx4 v[24:27], v1, s[20:23], s45 offen sc1
    s_waitcnt lgkmcnt(6)
    v_lshrrev_b32 v127, 5, v7
    v_bfe_u32 v0, s92, v7, 8
    v_bfe_u32 v7, v7, 3, 2
    v_mad_u32_u24 v0, v127, 20, v0
    v_mad_u32_u24 v7, v127, 20, v7
    ds_write_b32 v0, v65 offset:8704
    ds_write_b8_d16_hi v7, v89 offset:8712
    v_and_b32 v6, 0xffff, v94
    ds_add_rtn_u32 v6, v6, v4
    s_waitcnt lgkmcnt(8)
    v_lshrrev_b32 v127, 5, v8
    v_bfe_u32 v0, s92, v8, 8
    v_bfe_u32 v8, v8, 3, 2
    v_mad_u32_u24 v0, v127, 20, v0
    v_mad_u32_u24 v8, v127, 20, v8
    ds_write_b32 v0, v66 offset:8704
    ds_write_b8_d16_hi v8, v90 offset:8712
    v_and_b32 v7, 0xffff, v95
    ds_add_rtn_u32 v7, v7, v4
    s_waitcnt lgkmcnt(10)
    v_lshrrev_b32 v127, 5, v9
    v_bfe_u32 v0, s92, v9, 8
    v_bfe_u32 v9, v9, 3, 2
    v_mad_u32_u24 v0, v127, 20, v0
    v_mad_u32_u24 v9, v127, 20, v9
    ds_write_b32 v0, v67 offset:8704
    ds_write_b8_d16_hi v9, v91 offset:8712
    v_and_b32 v8, 0xffff, v96
    ds_add_rtn_u32 v8, v8, v4
    s_waitcnt lgkmcnt(12)
    v_lshrrev_b32 v127, 5, v10
    v_bfe_u32 v0, s92, v10, 8
    v_bfe_u32 v10, v10, 3, 2
    v_mad_u32_u24 v0, v127, 20, v0
    v_mad_u32_u24 v10, v127, 20, v10
    ds_write_b32 v0, v68 offset:8704
    ds_write_b8_d16_hi v10, v92 offset:8712
    v_and_b32 v9, 0xffff, v97
    ds_add_rtn_u32 v9, v9, v4
    s_waitcnt lgkmcnt(12)
    v_lshrrev_b32 v127, 5, v11
    v_bfe_u32 v0, s92, v11, 8
    v_bfe_u32 v11, v11, 3, 2
    v_mad_u32_u24 v0, v127, 20, v0
    v_mad_u32_u24 v11, v127, 20, v11
    ds_write_b32 v0, v69 offset:8704
    ds_write_b8_d16_hi v11, v93 offset:8712
    v_and_b32 v10, 0xffff, v98
    ds_add_rtn_u32 v10, v10, v4
    s_mov_b32 s42, 65536
    buffer_store_dwordx4 v[28:31], v1, s[20:23], s42 offen sc1
    s_waitcnt lgkmcnt(12)
    v_lshrrev_b32 v127, 5, v6
    v_bfe_u32 v0, s92, v6, 8
    v_bfe_u32 v6, v6, 3, 2
    v_mad_u32_u24 v0, v127, 20, v0
    v_mad_u32_u24 v6, v127, 20, v6
    ds_write_b32 v0, v70 offset:8704
    ds_write_b8_d16_hi v6, v94 offset:8712
    v_and_b32 v11, 0xffff, v99
    ds_add_rtn_u32 v11, v11, v4
    s_mov_b64 exec, 1
    s_waitcnt vmcnt(4)
    ds_add_rtn_u32 v119, v118, v4 offset:8324
    s_mov_b64 exec, -1
    s_waitcnt lgkmcnt(13)
    v_lshrrev_b32 v127, 5, v7
    v_bfe_u32 v0, s92, v7, 8
    v_bfe_u32 v7, v7, 3, 2
    v_mad_u32_u24 v0, v127, 20, v0
    v_mad_u32_u24 v7, v127, 20, v7
    ds_write_b32 v0, v71 offset:8704
    ds_write_b8_d16_hi v7, v95 offset:8712
    v_and_b32 v6, 0xffff, v100
    ds_add_rtn_u32 v6, v6, v4
    s_waitcnt lgkmcnt(13)
    v_lshrrev_b32 v127, 5, v8
    v_bfe_u32 v0, s92, v8, 8
    v_bfe_u32 v8, v8, 3, 2
    v_mad_u32_u24 v0, v127, 20, v0
    v_mad_u32_u24 v8, v127, 20, v8
    ds_write_b32 v0, v72 offset:8704
    ds_write_b8_d16_hi v8, v96 offset:8712
    v_and_b32 v7, 0xffff, v101
    ds_add_rtn_u32 v7, v7, v4
    s_waitcnt lgkmcnt(13)
    v_lshrrev_b32 v127, 5, v9
    v_bfe_u32 v0, s92, v9, 8
    v_bfe_u32 v9, v9, 3, 2
    v_mad_u32_u24 v0, v127, 20, v0
    v_mad_u32_u24 v9, v127, 20, v9
    ds_write_b32 v0, v73 offset:8704
    ds_write_b8_d16_hi v9, v97 offset:8712
    v_and_b32 v8, 0xffff, v102
    ds_add_rtn_u32 v8, v8, v4
    s_mov_b32 s43, 81920
    buffer_store_dwordx4 v[32:35], v1, s[20:23], s43 offen sc1
    s_waitcnt lgkmcnt(9)
    v_readfirstlane_b32 s58, v119
    s_nop 1
    s_cmp_eq_u32 s58, 120
    s_cselect_b32 exec_lo, 0xffff, 0
    s_mov_b32 exec_hi, 0
    global_atomic_add v121, v4, s[4:5] offset:2048 sc1
    s_mov_b64 exec, -1
    v_lshrrev_b32 v127, 5, v10
    v_bfe_u32 v0, s92, v10, 8
    v_bfe_u32 v10, v10, 3, 2
    v_mad_u32_u24 v0, v127, 20, v0
    v_mad_u32_u24 v10, v127, 20, v10
    ds_write_b32 v0, v74 offset:8704
    ds_write_b8_d16_hi v10, v98 offset:8712
    v_and_b32 v9, 0xffff, v103
    ds_add_rtn_u32 v9, v9, v4
    v_lshrrev_b32 v127, 5, v11
    v_bfe_u32 v0, s92, v11, 8
    v_bfe_u32 v11, v11, 3, 2
    v_mad_u32_u24 v0, v127, 20, v0
    v_mad_u32_u24 v11, v127, 20, v11
    ds_write_b32 v0, v75 offset:8704
    ds_write_b8_d16_hi v11, v99 offset:8712
    v_and_b32 v10, 0xffff, v104
    ds_add_rtn_u32 v10, v10, v4
    s_waitcnt lgkmcnt(12)
    v_lshrrev_b32 v127, 5, v6
    v_bfe_u32 v0, s92, v6, 8
    v_bfe_u32 v6, v6, 3, 2
    v_mad_u32_u24 v0, v127, 20, v0
    v_mad_u32_u24 v6, v127, 20, v6
    ds_write_b32 v0, v76 offset:8704
    ds_write_b8_d16_hi v6, v100 offset:8712
    v_and_b32 v11, 0xffff, v105
    ds_add_rtn_u32 v11, v11, v4
    s_waitcnt lgkmcnt(12)
    v_lshrrev_b32 v127, 5, v7
    v_bfe_u32 v0, s92, v7, 8
    v_bfe_u32 v7, v7, 3, 2
    v_mad_u32_u24 v0, v127, 20, v0
    v_mad_u32_u24 v7, v127, 20, v7
    ds_write_b32 v0, v77 offset:8704
    ds_write_b8_d16_hi v7, v101 offset:8712
    v_and_b32 v6, 0xffff, v106
    ds_add_rtn_u32 v6, v6, v4
    s_mov_b32 s44, 98304
    buffer_store_dwordx4 v[36:39], v1, s[20:23], s44 offen sc1
    s_waitcnt lgkmcnt(12)
    v_lshrrev_b32 v127, 5, v8
    v_bfe_u32 v0, s92, v8, 8
    v_bfe_u32 v8, v8, 3, 2
    v_mad_u32_u24 v0, v127, 20, v0
    v_mad_u32_u24 v8, v127, 20, v8
    ds_write_b32 v0, v78 offset:8704
    ds_write_b8_d16_hi v8, v102 offset:8712
    v_and_b32 v7, 0xffff, v107
    ds_add_rtn_u32 v7, v7, v4
    s_waitcnt lgkmcnt(12)
    v_lshrrev_b32 v127, 5, v9
    v_bfe_u32 v0, s92, v9, 8
    v_bfe_u32 v9, v9, 3, 2
    v_mad_u32_u24 v0, v127, 20, v0
    v_mad_u32_u24 v9, v127, 20, v9
    ds_write_b32 v0, v79 offset:8704
    ds_write_b8_d16_hi v9, v103 offset:8712
    v_and_b32 v8, 0xffff, v108
    ds_add_rtn_u32 v8, v8, v4
    s_waitcnt lgkmcnt(12)
    v_lshrrev_b32 v127, 5, v10
    v_bfe_u32 v0, s92, v10, 8
    v_bfe_u32 v10, v10, 3, 2
    v_mad_u32_u24 v0, v127, 20, v0
    v_mad_u32_u24 v10, v127, 20, v10
    ds_write_b32 v0, v80 offset:8704
    ds_write_b8_d16_hi v10, v104 offset:8712
    v_and_b32 v9, 0xffff, v109
    ds_add_rtn_u32 v9, v9, v4
    s_waitcnt lgkmcnt(12)
    v_lshrrev_b32 v127, 5, v11
    v_bfe_u32 v0, s92, v11, 8
    v_bfe_u32 v11, v11, 3, 2
    v_mad_u32_u24 v0, v127, 20, v0
    v_mad_u32_u24 v11, v127, 20, v11
    ds_write_b32 v0, v81 offset:8704
    ds_write_b8_d16_hi v11, v105 offset:8712
    v_and_b32 v10, 0xffff, v110
    ds_add_rtn_u32 v10, v10, v4
    s_waitcnt lgkmcnt(12)
    v_lshrrev_b32 v127, 5, v6
    v_bfe_u32 v0, s92, v6, 8
    v_bfe_u32 v6, v6, 3, 2
    v_mad_u32_u24 v0, v127, 20, v0
    v_mad_u32_u24 v6, v127, 20, v6
    ds_write_b32 v0, v82 offset:8704
    ds_write_b8_d16_hi v6, v106 offset:8712
    v_and_b32 v11, 0xffff, v111
    ds_add_rtn_u32 v11, v11, v4
    s_mov_b32 s45, 114688
    buffer_store_dwordx4 v[40:43], v1, s[20:23], s45 offen sc1
    s_waitcnt lgkmcnt(12)
    v_lshrrev_b32 v127, 5, v7
    v_bfe_u32 v0, s92, v7, 8
    v_bfe_u32 v7, v7, 3, 2
    v_mad_u32_u24 v0, v127, 20, v0
    v_mad_u32_u24 v7, v127, 20, v7
    ds_write_b32 v0, v83 offset:8704
    ds_write_b8_d16_hi v7, v107 offset:8712
    v_and_b32 v6, 0xffff, v113
    ds_add_rtn_u32 v6, v6, v4
    s_waitcnt lgkmcnt(12)
    v_lshrrev_b32 v127, 5, v8
    v_bfe_u32 v0, s92, v8, 8
    v_bfe_u32 v8, v8, 3, 2
    v_mad_u32_u24 v0, v127, 20, v0
    v_mad_u32_u24 v8, v127, 20, v8
    ds_write_b32 v0, v84 offset:8704
    ds_write_b8_d16_hi v8, v108 offset:8712
    s_waitcnt lgkmcnt(11)
    v_lshrrev_b32 v127, 5, v9
    v_bfe_u32 v0, s92, v9, 8
    v_bfe_u32 v9, v9, 3, 2
    v_mad_u32_u24 v0, v127, 20, v0
    v_mad_u32_u24 v9, v127, 20, v9
    ds_write_b32 v0, v85 offset:8704
    ds_write_b8_d16_hi v9, v109 offset:8712
    s_waitcnt lgkmcnt(10)
    v_lshrrev_b32 v127, 5, v10
    v_bfe_u32 v0, s92, v10, 8
    v_bfe_u32 v10, v10, 3, 2
    v_mad_u32_u24 v0, v127, 20, v0
    v_mad_u32_u24 v10, v127, 20, v10
    ds_write_b32 v0, v86 offset:8704
    ds_write_b8_d16_hi v10, v110 offset:8712
    s_mov_b32 s42, 131072
    buffer_store_dwordx4 v[44:47], v1, s[20:23], s42 offen sc1
    s_waitcnt lgkmcnt(9)
    v_lshrrev_b32 v127, 5, v11
    v_bfe_u32 v0, s92, v11, 8
    v_bfe_u32 v11, v11, 3, 2
    v_mad_u32_u24 v0, v127, 20, v0
    v_mad_u32_u24 v11, v127, 20, v11
    ds_write_b32 v0, v87 offset:8704
    ds_write_b8_d16_hi v11, v111 offset:8712
    s_waitcnt lgkmcnt(8)
    v_lshrrev_b32 v127, 5, v6
    v_bfe_u32 v0, s92, v6, 8
    v_bfe_u32 v6, v6, 3, 2
    v_mad_u32_u24 v0, v127, 20, v0
    v_mad_u32_u24 v6, v127, 20, v6
    ds_write_b32 v0, v112 offset:8704
    ds_write_b8_d16_hi v6, v113 offset:8712
    v_add_u32 v127, 65536, v1
    v_add_u32 v0, 131072, v1
    s_waitcnt lgkmcnt(0)
    s_barrier
    ds_read_b128 v[64:67], v1 offset:8704
    ds_read_b128 v[68:71], v1 offset:25088
    ds_read_b128 v[72:75], v1 offset:41472
    ds_read_b128 v[76:79], v1 offset:57856
    ds_read_b128 v[80:83], v127 offset:8704
    ds_read_b128 v[84:87], v127 offset:25088
    ds_read_b128 v[88:91], v127 offset:41472
    ds_read_b128 v[92:95], v127 offset:57856
    ds_read_b128 v[96:99], v0 offset:8704
    s_mov_b32 s30, 0
    s_waitcnt lgkmcnt(8)
    buffer_store_dwordx4 v[64:67], v1, s[8:11], s30 offen sc1
    s_mov_b32 s31, 16384
    s_waitcnt lgkmcnt(7)
    buffer_store_dwordx4 v[68:71], v1, s[8:11], s31 offen sc1
    s_mov_b32 s30, 32768
    s_waitcnt lgkmcnt(6)
    buffer_store_dwordx4 v[72:75], v1, s[8:11], s30 offen sc1
    s_mov_b32 s31, 49152
    s_waitcnt lgkmcnt(5)
    buffer_store_dwordx4 v[76:79], v1, s[8:11], s31 offen sc1
    s_mov_b32 s30, 65536
    s_waitcnt lgkmcnt(4)
    buffer_store_dwordx4 v[80:83], v1, s[8:11], s30 offen sc1
    s_mov_b32 s31, 81920
    s_waitcnt lgkmcnt(3)
    buffer_store_dwordx4 v[84:87], v1, s[8:11], s31 offen sc1
    s_mov_b32 s30, 98304
    s_waitcnt lgkmcnt(2)
    buffer_store_dwordx4 v[88:91], v1, s[8:11], s30 offen sc1
    s_mov_b32 s31, 114688
    s_waitcnt lgkmcnt(1)
    buffer_store_dwordx4 v[92:95], v1, s[8:11], s31 offen sc1
    s_mov_b32 s30, 131072
    s_waitcnt lgkmcnt(0)
    buffer_store_dwordx4 v[96:99], v1, s[8:11], s30 offen sc1
.Lp2i:
    s_waitcnt lgkmcnt(0)
    s_barrier
    v_mov_b32 v24, 0
    v_mov_b32 v25, 0
    ds_write_b64 v2, v[24:25]
    v_bfrev_b32 v28, 3
    v_bfrev_b32 v29, 3
    v_bfrev_b32 v30, 3
    v_bfrev_b32 v31, 3
    v_add_u32 v17, 8192, v1
    ds_write_b128 v17, v[28:31] offset:0
    ds_write_b128 v17, v[28:31] offset:16384
    ds_write_b128 v17, v[28:31] offset:32768
    ds_write_b128 v17, v[28:31] offset:49152
    v_mov_b32 v1, v3
    v_lshrrev_b32 v0, 1, v3
    v_add_u32 v2, 107408, v2
    v_mov_b32 v6, 0x20000
    v_bfe_i32 v4, v3, 2, 1
    v_and_b32 v4, 0x00060006, v4
    v_or_b32 v4, 0x0c010c00, v4
    v_mov_b32 v3, 2
    v_mov_b32 v7, 0
    s_waitcnt vmcnt(0)
    s_waitcnt lgkmcnt(0)
    s_barrier
    s_cmp_eq_u32 s24, 15
    s_cselect_b32 exec_lo, 0xffff, 0
    s_mov_b32 exec_hi, 0
    global_atomic_add v121, v3, s[4:5] sc1
    s_mov_b64 exec, -1
    s_cmp_lg_u32 s24, 15
    s_cbranch_scc1 .Lsp1x
    s_mov_b64 exec, 1
    s_mov_b32 s3, 1048576
.Lsp1:
    global_load_dword v119, v122, s[4:5] offset:2048 sc1
    s_waitcnt vmcnt(0)
    v_readfirstlane_b32 s100, v119
    s_sub_u32 s3, s3, 1
    s_cbranch_scc1 .Lsp1y
    s_cmp_eq_u32 s100, 2000
    s_cbranch_scc1 .Lsp1y
    s_cmp_ge_u32 s100, 1968
    s_cbranch_scc1 .Lsp1
    s_sleep 8
    s_cmp_ge_u32 s100, 1872
    s_cbranch_scc1 .Lsp1
    s_sleep 16
    s_cmp_ge_u32 s100, 1488
    s_cbranch_scc1 .Lsp1
    s_sleep 32
    s_branch .Lsp1
.Lsp1y:
    s_mov_b64 exec, -1
.Lsp1x:
    s_barrier
    buffer_load_dwordx2 v[116:117], v115, s[12:15], s28 offen sc1
    buffer_load_dwordx4 v[124:127], v123, s[16:19], 0 offen sc1
    s_waitcnt vmcnt(0)
    v_lshrrev_b32 v16, 4, v1
    s_mov_b32 s100, 147456
    v_mul_u32_u24 v16, s100, v16
    v_and_b32 v20, 12, v1
    v_lshlrev_b32 v32, 31, v116
    v_lshlrev_b32 v33, 31, v117
    v_lshlrev_b32 v34, 14, v116
    v_lshlrev_b32 v35, 14, v117
    v_add_u32 v28, 0x10000, v116
    v_add_u32 v29, 0x10000, v117
    v_and_b32 v34, 2.0, v34
    v_and_b32 v35, 2.0, v35
    v_lshrrev_b32 v28, 17, v28
    v_lshrrev_b32 v29, 17, v29
    v_bfe_u32 v116, v116, 1, 15
    v_bfe_u32 v117, v117, 1, 15
    v_sub_u32 v28, v28, v116
    v_sub_u32 v29, v29, v117
    v_mad_u32_u24 v30, v116, 20, v16
    v_mad_u32_u24 v31, v117, 20, v16
    v_max_u32 v116, v28, v29
    v_min_u32 v28, 32, v28
    v_min_u32 v29, 32, v29
    v_add_u32 v18, v28, v29
    v_add_u32 v31, 37748736, v31
    v_mov_b32 v19, v18
    s_nop 1
    v_add_u32_dpp v19, v19, v19 row_shr:4 row_mask:0xf bank_mask:0xf
    s_nop 1
    v_add_u32_dpp v19, v19, v19 row_shr:8 row_mask:0xf bank_mask:0xf
    s_mov_b32 exec_lo, 0xf000f000
    s_mov_b32 exec_hi, 0xf000f000
    ds_add_rtn_u32 v9, v20, v19 offset:832
    s_mov_b64 exec, -1
    v_cmpx_lt_u32 vcc, 32, v116
    ds_write_b32 v3, v3 offset:846
    s_mov_b64 exec, -1
    v_sub_u32 v19, v19, v18
    v_mul_u32_u24 v20, 3584, v20
    s_waitcnt lgkmcnt(1)
    v_mov_b32_dpp v9, v9 row_shl:4 row_mask:0xf bank_mask:0x4
    s_nop 1
    v_mov_b32_dpp v9, v9 row_shl:8 row_mask:0xf bank_mask:0x3
    v_add_u32 v19, v19, v9
    v_lshl_add_u32 v8, v19, 2, v20
    v_lshl_add_u32 v9, v28, 2, v8
    v_or_b32 v32, v32, v30
    v_cmpx_lt_u32 vcc, 0, v28
    ds_write_b32 v8, v32 offset:8192
    v_add_u32 v30, 20, v30
    v_cmpx_lt_u32 vcc, 1, v28
    ds_write_b32 v8, v30 offset:8196
    v_add_u32 v30, 20, v30
    v_cmpx_lt_u32 vcc, 2, v28
    ds_write_b32 v8, v30 offset:8200
    v_add_u32 v30, 20, v30
    v_cmpx_lt_u32 vcc, 3, v28
    ds_write_b32 v8, v30 offset:8204
    v_add_u32 v30, 20, v30
    v_cmpx_lt_u32 vcc, 4, v28
    ds_write_b32 v8, v30 offset:8208
    v_add_u32 v30, 20, v30
    v_cmpx_lt_u32 vcc, 5, v28
    ds_write_b32 v8, v30 offset:8212
    v_add_u32 v30, 20, v30
    v_cmpx_lt_u32 vcc, 6, v28
    ds_write_b32 v8, v30 offset:8216
    v_add_u32 v30, 20, v30
    v_cmpx_lt_u32 vcc, 7, v28
    ds_write_b32 v8, v30 offset:8220
    v_add_u32 v30, 20, v30
    v_cmpx_lt_u32 vcc, 8, v28
    s_nop 1
    s_cbranch_execz .Lll0
    ds_write_b32 v8, v30 offset:8224
    v_add_u32 v30, 20, v30
    v_cmpx_lt_u32 vcc, 9, v28
    ds_write_b32 v8, v30 offset:8228
    v_add_u32 v30, 20, v30
    v_cmpx_lt_u32 vcc, 10, v28
    s_nop 1
    s_cbranch_execz .Lll0
    ds_write_b32 v8, v30 offset:8232
    v_add_u32 v30, 20, v30
    v_cmpx_lt_u32 vcc, 11, v28
    ds_write_b32 v8, v30 offset:8236
    v_add_u32 v30, 20, v30
    v_cmpx_lt_u32 vcc, 12, v28
    s_nop 1
    s_cbranch_execz .Lll0
    ds_write_b32 v8, v30 offset:8240
    v_add_u32 v30, 20, v30
    v_cmpx_lt_u32 vcc, 13, v28
    ds_write_b32 v8, v30 offset:8244
    v_add_u32 v30, 20, v30
    v_cmpx_lt_u32 vcc, 14, v28
    s_nop 1
    s_cbranch_execz .Lll0
    ds_write_b32 v8, v30 offset:8248
    v_add_u32 v30, 20, v30
    v_cmpx_lt_u32 vcc, 15, v28
    ds_write_b32 v8, v30 offset:8252
    v_add_u32 v30, 20, v30
    v_cmpx_lt_u32 vcc, 16, v28
    s_nop 1
    s_cbranch_execz .Lll0
    ds_write_b32 v8, v30 offset:8256
    v_add_u32 v30, 20, v30
    v_cmpx_lt_u32 vcc, 17, v28
    ds_write_b32 v8, v30 offset:8260
    v_add_u32 v30, 20, v30
    v_cmpx_lt_u32 vcc, 18, v28
    s_nop 1
    s_cbranch_execz .Lll0
    ds_write_b32 v8, v30 offset:8264
    v_add_u32 v30, 20, v30
    v_cmpx_lt_u32 vcc, 19, v28
    ds_write_b32 v8, v30 offset:8268
    v_add_u32 v30, 20, v30
    v_cmpx_lt_u32 vcc, 20, v28
    s_nop 1
    s_cbranch_execz .Lll0
    ds_write_b32 v8, v30 offset:8272
    v_add_u32 v30, 20, v30
    v_cmpx_lt_u32 vcc, 21, v28
    ds_write_b32 v8, v30 offset:8276
    v_add_u32 v30, 20, v30
    v_cmpx_lt_u32 vcc, 22, v28
    s_nop 1
    s_cbranch_execz .Lll0
    ds_write_b32 v8, v30 offset:8280
    v_add_u32 v30, 20, v30
    v_cmpx_lt_u32 vcc, 23, v28
    ds_write_b32 v8, v30 offset:8284
    v_add_u32 v30, 20, v30
    v_cmpx_lt_u32 vcc, 24, v28
    s_nop 1
    s_cbranch_execz .Lll0
    ds_write_b32 v8, v30 offset:8288
    v_add_u32 v30, 20, v30
    v_cmpx_lt_u32 vcc, 25, v28
    ds_write_b32 v8, v30 offset:8292
    v_add_u32 v30, 20, v30
    v_cmpx_lt_u32 vcc, 26, v28
    s_nop 1
    s_cbranch_execz .Lll0
    ds_write_b32 v8, v30 offset:8296
    v_add_u32 v30, 20, v30
    v_cmpx_lt_u32 vcc, 27, v28
    ds_write_b32 v8, v30 offset:8300
    v_add_u32 v30, 20, v30
    v_cmpx_lt_u32 vcc, 28, v28
    s_nop 1
    s_cbranch_execz .Lll0
    ds_write_b32 v8, v30 offset:8304
    v_add_u32 v30, 20, v30
    v_cmpx_lt_u32 vcc, 29, v28
    ds_write_b32 v8, v30 offset:8308
    v_add_u32 v30, 20, v30
    v_cmpx_lt_u32 vcc, 30, v28
    s_nop 1
    s_cbranch_execz .Lll0
    ds_write_b32 v8, v30 offset:8312
    v_add_u32 v30, 20, v30
    v_cmpx_lt_u32 vcc, 31, v28
    ds_write_b32 v8, v30 offset:8316
.Lll0:
    s_mov_b64 exec, -1
    v_lshl_add_u32 v30, v28, 2, v8
    v_cmpx_ne_u32 vcc, 0, v34
    ds_or_b32 v30, v34 offset:8188
    s_mov_b64 exec, -1
    v_or_b32 v33, v33, v31
    v_cmpx_lt_u32 vcc, 0, v29
    ds_write_b32 v9, v33 offset:8192
    v_add_u32 v31, 20, v31
    v_cmpx_lt_u32 vcc, 1, v29
    ds_write_b32 v9, v31 offset:8196
    v_add_u32 v31, 20, v31
    v_cmpx_lt_u32 vcc, 2, v29
    ds_write_b32 v9, v31 offset:8200
    v_add_u32 v31, 20, v31
    v_cmpx_lt_u32 vcc, 3, v29
    ds_write_b32 v9, v31 offset:8204
    v_add_u32 v31, 20, v31
    v_cmpx_lt_u32 vcc, 4, v29
    ds_write_b32 v9, v31 offset:8208
    v_add_u32 v31, 20, v31
    v_cmpx_lt_u32 vcc, 5, v29
    ds_write_b32 v9, v31 offset:8212
    v_add_u32 v31, 20, v31
    v_cmpx_lt_u32 vcc, 6, v29
    ds_write_b32 v9, v31 offset:8216
    v_add_u32 v31, 20, v31
    v_cmpx_lt_u32 vcc, 7, v29
    ds_write_b32 v9, v31 offset:8220
    v_add_u32 v31, 20, v31
    v_cmpx_lt_u32 vcc, 8, v29
    s_nop 1
    s_cbranch_execz .Lll1
    ds_write_b32 v9, v31 offset:8224
    v_add_u32 v31, 20, v31
    v_cmpx_lt_u32 vcc, 9, v29
    ds_write_b32 v9, v31 offset:8228
    v_add_u32 v31, 20, v31
    v_cmpx_lt_u32 vcc, 10, v29
    s_nop 1
    s_cbranch_execz .Lll1
    ds_write_b32 v9, v31 offset:8232
    v_add_u32 v31, 20, v31
    v_cmpx_lt_u32 vcc, 11, v29
    ds_write_b32 v9, v31 offset:8236
    v_add_u32 v31, 20, v31
    v_cmpx_lt_u32 vcc, 12, v29
    s_nop 1
    s_cbranch_execz .Lll1
    ds_write_b32 v9, v31 offset:8240
    v_add_u32 v31, 20, v31
    v_cmpx_lt_u32 vcc, 13, v29
    ds_write_b32 v9, v31 offset:8244
    v_add_u32 v31, 20, v31
    v_cmpx_lt_u32 vcc, 14, v29
    s_nop 1
    s_cbranch_execz .Lll1
    ds_write_b32 v9, v31 offset:8248
    v_add_u32 v31, 20, v31
    v_cmpx_lt_u32 vcc, 15, v29
    ds_write_b32 v9, v31 offset:8252
    v_add_u32 v31, 20, v31
    v_cmpx_lt_u32 vcc, 16, v29
    s_nop 1
    s_cbranch_execz .Lll1
    ds_write_b32 v9, v31 offset:8256
    v_add_u32 v31, 20, v31
    v_cmpx_lt_u32 vcc, 17, v29
    ds_write_b32 v9, v31 offset:8260
    v_add_u32 v31, 20, v31
    v_cmpx_lt_u32 vcc, 18, v29
    s_nop 1
    s_cbranch_execz .Lll1
    ds_write_b32 v9, v31 offset:8264
    v_add_u32 v31, 20, v31
    v_cmpx_lt_u32 vcc, 19, v29
    ds_write_b32 v9, v31 offset:8268
    v_add_u32 v31, 20, v31
    v_cmpx_lt_u32 vcc, 20, v29
    s_nop 1
    s_cbranch_execz .Lll1
    ds_write_b32 v9, v31 offset:8272
    v_add_u32 v31, 20, v31
    v_cmpx_lt_u32 vcc, 21, v29
    ds_write_b32 v9, v31 offset:8276
    v_add_u32 v31, 20, v31
    v_cmpx_lt_u32 vcc, 22, v29
    s_nop 1
    s_cbranch_execz .Lll1
    ds_write_b32 v9, v31 offset:8280
    v_add_u32 v31, 20, v31
    v_cmpx_lt_u32 vcc, 23, v29
    ds_write_b32 v9, v31 offset:8284
    v_add_u32 v31, 20, v31
    v_cmpx_lt_u32 vcc, 24, v29
    s_nop 1
    s_cbranch_execz .Lll1
    ds_write_b32 v9, v31 offset:8288
    v_add_u32 v31, 20, v31
    v_cmpx_lt_u32 vcc, 25, v29
    ds_write_b32 v9, v31 offset:8292
    v_add_u32 v31, 20, v31
    v_cmpx_lt_u32 vcc, 26, v29
    s_nop 1
    s_cbranch_execz .Lll1
    ds_write_b32 v9, v31 offset:8296
    v_add_u32 v31, 20, v31
    v_cmpx_lt_u32 vcc, 27, v29
    ds_write_b32 v9, v31 offset:8300
    v_add_u32 v31, 20, v31
    v_cmpx_lt_u32 vcc, 28, v29
    s_nop 1
    s_cbranch_execz .Lll1
    ds_write_b32 v9, v31 offset:8304
    v_add_u32 v31, 20, v31
    v_cmpx_lt_u32 vcc, 29, v29
    ds_write_b32 v9, v31 offset:8308
    v_add_u32 v31, 20, v31
    v_cmpx_lt_u32 vcc, 30, v29
    s_nop 1
    s_cbranch_execz .Lll1
    ds_write_b32 v9, v31 offset:8312
    v_add_u32 v31, 20, v31
    v_cmpx_lt_u32 vcc, 31, v29
    ds_write_b32 v9, v31 offset:8316
.Lll1:
    s_mov_b64 exec, -1
    v_lshl_add_u32 v31, v29, 2, v9
    v_cmpx_ne_u32 vcc, 0, v35
    ds_or_b32 v31, v35 offset:8188
    s_mov_b64 exec, -1
    v_add_f32 v15, v124, v125
    v_add_f32 v12, v126, v127
    v_pk_max_u16 v124, v124, v125
    v_pk_max_u16 v126, v126, v127
    v_add_f32 v15, v15, v12
    v_pk_max_u16 v124, v124, v126
    v_lshlrev_b32 v14, 16, v124
    v_add_f32_dpp v15, v15, v15 row_shr:1 row_mask:0xf bank_mask:0xf
    s_nop 0
    v_max_u32_dpp v14, v14, v14 row_shr:1 row_mask:0xf bank_mask:0xf
    v_add_f32_dpp v15, v15, v15 row_shr:2 row_mask:0xf bank_mask:0xf
    s_nop 0
    v_max_u32_dpp v14, v14, v14 row_shr:2 row_mask:0xf bank_mask:0xf
    v_add_f32_dpp v15, v15, v15 row_shr:4 row_mask:0xf bank_mask:0xf
    s_nop 0
    v_max_u32_dpp v14, v14, v14 row_shr:4 row_mask:0xf bank_mask:0xf
    v_add_f32_dpp v15, v15, v15 row_shr:8 row_mask:0xf bank_mask:0xf
    s_nop 0
    v_max_u32_dpp v14, v14, v14 row_shr:8 row_mask:0xf bank_mask:0xf
    v_add_f32_dpp v15, v15, v15 row_bcast:15 row_mask:0xa bank_mask:0xf
    s_nop 0
    v_max_u32_dpp v14, v14, v14 row_bcast:15 row_mask:0xa bank_mask:0xf
    v_add_f32_dpp v15, v15, v15 row_bcast:31 row_mask:0xc bank_mask:0xf
    s_nop 0
    v_max_u32_dpp v14, v14, v14 row_bcast:31 row_mask:0xc bank_mask:0xf
    s_load_dwordx2 s[22:23], s[0:1], 0
    s_load_dwordx2 s[30:31], s[0:1], 24
    s_load_dwordx2 s[32:33], s[0:1], 88
    s_load_dwordx8 s[92:99], s[0:1], 56
    v_mul_f32 v15, 0x3008509c, v15
    v_rcp_f32 v5, v15
    s_nop 0
    v_mul_f32 v14, v14, v5
    v_readlane_b32 s21, v15, 63
    v_readlane_b32 s16, v5, 63
    v_readlane_b32 s26, v14, 63
    s_nop 0
    v_mul_f32_e64 v5, -1.0, s16
    v_and_b32 v11, -4, v0
    v_and_b32 v12, 4, v1
    v_lshlrev_b32 v13, 28, v12
    v_lshlrev_b32 v12, 1, v12
    v_sub_u32 v13, 0xbfffffff, v13
    s_mov_b32 s12, 0x4b400000
    s_mov_b32 s13, 0x4b40b4bf
    s_mov_b32 s14, 0x4b40b4c0
    s_mov_b32 s15, 0x4b40b4bf
    s_mov_b32 s17, 2.0
    s_mov_b32 s18, 0x10000
    s_mov_b32 s19, 107408
    s_mov_b32 s20, 0x7aa2f983
    s_cmp_lg_u32 s24, 15
    s_cbranch_scc1 .Lsp2x
    s_mov_b64 exec, 1
    s_mov_b32 s3, 1048576
.Lsp2:
    global_load_dword v119, v122, s[4:5] sc1
    s_waitcnt vmcnt(0)
    v_readfirstlane_b32 s100, v119
    s_sub_u32 s3, s3, 1
    s_cbranch_scc1 .Lsp2y
    s_cmp_eq_u32 s100, 512
    s_cbranch_scc1 .Lsp2y
    s_cmp_ge_u32 s100, 504
    s_cbranch_scc1 .Lsp2
    s_sleep 8
    s_cmp_ge_u32 s100, 480
    s_cbranch_scc1 .Lsp2
    s_sleep 16
    s_cmp_ge_u32 s100, 384
    s_cbranch_scc1 .Lsp2
    s_sleep 32
    s_branch .Lsp2
.Lsp2y:
    s_mov_b64 exec, -1
.Lsp2x:
    s_waitcnt lgkmcnt(0)
    s_barrier
    ds_read_b32 v44, v11 offset:8192
    ds_read_b32 v48, v11 offset:10240
    ds_read_b32 v52, v11 offset:12288
    ds_read_b32 v56, v11 offset:14336
    ds_read_b32 v60, v11 offset:16384
    ds_read_b32 v64, v11 offset:18432
    ds_read_b32 v68, v11 offset:20480
    ds_read_b32 v72, v11 offset:22528
    ds_read_b32 v76, v11 offset:24576
    ds_read_b32 v80, v11 offset:26624
    ds_read_b32 v84, v11 offset:28672
    ds_read_b32 v88, v11 offset:30720
    ds_read_b32 v92, v11 offset:32768
    ds_read_b32 v96, v11 offset:34816
    s_waitcnt lgkmcnt(13)
    v_and_b32 v44, v13, v44
    v_add_u32 v44, v12, v44
    buffer_load_dwordx3 v[44:46], v44, s[4:7], 0 offen sc1
    s_waitcnt lgkmcnt(12)
    v_and_b32 v48, v13, v48
    v_add_u32 v48, v12, v48
    buffer_load_dwordx3 v[48:50], v48, s[4:7], 0 offen sc1
    s_waitcnt lgkmcnt(11)
    v_and_b32 v52, v13, v52
    v_add_u32 v52, v12, v52
    buffer_load_dwordx3 v[52:54], v52, s[4:7], 0 offen sc1
    s_waitcnt lgkmcnt(10)
    v_and_b32 v56, v13, v56
    v_add_u32 v56, v12, v56
    buffer_load_dwordx3 v[56:58], v56, s[4:7], 0 offen sc1
    s_waitcnt lgkmcnt(9)
    v_and_b32 v60, v13, v60
    v_add_u32 v60, v12, v60
    buffer_load_dwordx3 v[60:62], v60, s[4:7], 0 offen sc1
    s_waitcnt lgkmcnt(8)
    v_and_b32 v64, v13, v64
    v_add_u32 v64, v12, v64
    buffer_load_dwordx3 v[64:66], v64, s[4:7], 0 offen sc1
    s_waitcnt lgkmcnt(7)
    v_and_b32 v68, v13, v68
    v_add_u32 v68, v12, v68
    buffer_load_dwordx3 v[68:70], v68, s[4:7], 0 offen sc1
    ds_read_b128 v[16:19], v7 offset:832
    ds_read_b32 v14, v7 offset:848
    ds_read_b32 v100, v11 offset:36864
    ds_read_b32 v104, v11 offset:38912
    ds_read_b32 v108, v11 offset:40960
    ds_read_b32 v112, v11 offset:43008
    ds_read_b32 v116, v11 offset:45056
    ds_read_b32 v120, v11 offset:47104
    ds_read_b32 v124, v11 offset:49152
    ds_read_b32 v103, v11 offset:51200
    ds_read_b32 v107, v11 offset:53248
    ds_read_b32 v111, v11 offset:55296
    ds_read_b32 v115, v11 offset:57344
    ds_read_b32 v119, v11 offset:59392
    ds_read_b32 v123, v11 offset:61440
    ds_read_b32 v127, v11 offset:63488
    s_waitcnt lgkmcnt(15)
    v_and_b32 v72, v13, v72
    v_add_u32 v72, v12, v72
    v_and_b32 v76, v13, v76
    v_add_u32 v76, v12, v76
    v_and_b32 v80, v13, v80
    v_add_u32 v80, v12, v80
    v_and_b32 v84, v13, v84
    v_add_u32 v84, v12, v84
    v_and_b32 v88, v13, v88
    v_add_u32 v88, v12, v88
    v_and_b32 v92, v13, v92
    v_add_u32 v92, v12, v92
    v_and_b32 v96, v13, v96
    v_add_u32 v96, v12, v96
    s_waitcnt lgkmcnt(13)
    v_and_b32 v100, v13, v100
    v_add_u32 v100, v12, v100
    s_waitcnt lgkmcnt(12)
    v_and_b32 v104, v13, v104
    v_add_u32 v104, v12, v104
    s_waitcnt lgkmcnt(11)
    v_and_b32 v108, v13, v108
    v_add_u32 v108, v12, v108
    s_waitcnt lgkmcnt(10)
    v_and_b32 v112, v13, v112
    v_add_u32 v112, v12, v112
    s_waitcnt lgkmcnt(9)
    v_and_b32 v116, v13, v116
    v_add_u32 v116, v12, v116
    s_waitcnt lgkmcnt(8)
    v_and_b32 v120, v13, v120
    v_add_u32 v120, v12, v120
    s_waitcnt lgkmcnt(7)
    v_and_b32 v124, v13, v124
    v_add_u32 v124, v12, v124
    s_waitcnt lgkmcnt(6)
    v_and_b32 v103, v13, v103
    v_add_u32 v103, v12, v103
    s_waitcnt lgkmcnt(5)
    v_and_b32 v107, v13, v107
    v_add_u32 v107, v12, v107
    s_waitcnt lgkmcnt(4)
    v_and_b32 v111, v13, v111
    v_add_u32 v111, v12, v111
    s_waitcnt lgkmcnt(3)
    v_and_b32 v115, v13, v115
    v_add_u32 v115, v12, v115
    s_waitcnt lgkmcnt(2)
    v_and_b32 v119, v13, v119
    v_add_u32 v119, v12, v119
    s_waitcnt lgkmcnt(1)
    v_and_b32 v123, v13, v123
    v_add_u32 v123, v12, v123
    s_waitcnt lgkmcnt(0)
    v_and_b32 v127, v13, v127
    v_add_u32 v127, v12, v127
    s_load_dwordx16 s[36:51], s[92:93], 0
    s_load_dwordx16 s[52:67], s[94:95], 0
    s_load_dwordx16 s[68:83], s[94:95], 64
    s_mov_b32 s84, 0xaaaaaaaa
    s_mov_b32 s85, 0xaaaaaaaa
    s_and_b32 s100, s25, 1
    s_mul_i32 s100, s100, 400000
    s_lshl_b32 s101, s100, 3
    s_add_u32 s8, s22, s101
    s_addc_u32 s9, s23, 0
    s_sub_u32 s10, 6400000, s101
    s_mov_b32 s11, 0x00020000
    s_mul_i32 s100, s25, 25000
    s_mul_i32 s101, s25, 6250
    s_add_u32 s22, s22, s100
    s_addc_u32 s23, s23, 0
    s_add_u32 s32, s32, s100
    s_addc_u32 s33, s33, 0
    s_add_u32 s30, s30, s101
    s_addc_u32 s31, s31, 0
    v_max3_u32 v16, v16, v17, v18
    v_max_u32 v16, v16, v19
    v_readfirstlane_b32 s27, v14
    v_readfirstlane_b32 s28, v16
    s_cmp_gt_u32 s26, 0x46800000
    s_cbranch_scc1 .Lslow0
    s_sub_u32 s100, s21, 226492416
    s_cmp_gt_u32 s100, 1677721600
    s_cbranch_scc1 .Lslow0
    s_cmp_lg_u32 s27, 0
    s_cbranch_scc1 .Lslow0
    s_cmp_gt_u32 s28, 3584
    s_cbranch_scc1 .Lslow0
    s_mov_b32 s101, 0x05040100
    s_mov_b32 s3, 0x0c000c00
    s_waitcnt vmcnt(6)
    v_perm_b32 v22, v44, v46, v4
    v_cndmask_b32_e64 v44, v44, v46, s[84:85]
    v_pk_mad_u16 v22, v22, 4, -16 op_sel_hi:[1,0,0]
    v_perm_b32 v23, v44, v45, s101
    v_and_or_b32 v46, v23, s3, v22
    v_bfe_i32 v23, v46, 0, 16
    v_ashrrev_i32 v22, 16, v46
    ds_add_u32 v23, v3
    ds_add_u32 v22, v3
    s_waitcnt vmcnt(5)
    v_perm_b32 v22, v48, v50, v4
    v_cndmask_b32_e64 v48, v48, v50, s[84:85]
    v_pk_mad_u16 v22, v22, 4, -16 op_sel_hi:[1,0,0]
    v_perm_b32 v23, v48, v49, s101
    v_and_or_b32 v50, v23, s3, v22
    v_bfe_i32 v23, v50, 0, 16
    v_ashrrev_i32 v22, 16, v50
    ds_add_u32 v23, v3
    ds_add_u32 v22, v3
    s_waitcnt vmcnt(4)
    v_perm_b32 v22, v52, v54, v4
    v_cndmask_b32_e64 v52, v52, v54, s[84:85]
    v_pk_mad_u16 v22, v22, 4, -16 op_sel_hi:[1,0,0]
    v_perm_b32 v23, v52, v53, s101
    v_and_or_b32 v54, v23, s3, v22
    v_bfe_i32 v23, v54, 0, 16
    v_ashrrev_i32 v22, 16, v54
    ds_add_u32 v23, v3
    ds_add_u32 v22, v3
    s_waitcnt vmcnt(3)
    v_perm_b32 v22, v56, v58, v4
    v_cndmask_b32_e64 v56, v56, v58, s[84:85]
    v_pk_mad_u16 v22, v22, 4, -16 op_sel_hi:[1,0,0]
    v_perm_b32 v23, v56, v57, s101
    v_and_or_b32 v58, v23, s3, v22
    v_bfe_i32 v23, v58, 0, 16
    v_ashrrev_i32 v22, 16, v58
    ds_add_u32 v23, v3
    ds_add_u32 v22, v3
    s_waitcnt vmcnt(2)
    v_perm_b32 v22, v60, v62, v4
    v_cndmask_b32_e64 v60, v60, v62, s[84:85]
    v_pk_mad_u16 v22, v22, 4, -16 op_sel_hi:[1,0,0]
    v_perm_b32 v23, v60, v61, s101
    v_and_or_b32 v62, v23, s3, v22
    v_bfe_i32 v23, v62, 0, 16
    v_ashrrev_i32 v22, 16, v62
    ds_add_u32 v23, v3
    ds_add_u32 v22, v3
    buffer_load_dwordx3 v[72:74], v72, s[4:7], 0 offen sc1
    s_waitcnt vmcnt(2)
    v_perm_b32 v22, v64, v66, v4
    v_cndmask_b32_e64 v64, v64, v66, s[84:85]
    v_pk_mad_u16 v22, v22, 4, -16 op_sel_hi:[1,0,0]
    v_perm_b32 v23, v64, v65, s101
    v_and_or_b32 v66, v23, s3, v22
    v_bfe_i32 v23, v66, 0, 16
    v_ashrrev_i32 v22, 16, v66
    ds_add_u32 v23, v3
    ds_add_u32 v22, v3
    buffer_load_dwordx3 v[76:78], v76, s[4:7], 0 offen sc1
    s_waitcnt vmcnt(2)
    v_perm_b32 v22, v68, v70, v4
    v_cndmask_b32_e64 v68, v68, v70, s[84:85]
    v_pk_mad_u16 v22, v22, 4, -16 op_sel_hi:[1,0,0]
    v_perm_b32 v23, v68, v69, s101
    v_and_or_b32 v70, v23, s3, v22
    v_bfe_i32 v23, v70, 0, 16
    v_ashrrev_i32 v22, 16, v70
    ds_add_u32 v23, v3
    ds_add_u32 v22, v3
    s_waitcnt lgkmcnt(0)
    s_barrier
    s_pack_ll_b32_b16 s100, s52, s56
    s_pack_hh_b32_b16 s56, s52, s56
    s_mov_b32 s52, s100
    s_pack_ll_b32_b16 s100, s53, s57
    s_pack_hh_b32_b16 s57, s53, s57
    s_mov_b32 s53, s100
    s_pack_ll_b32_b16 s100, s54, s58
    s_pack_hh_b32_b16 s58, s54, s58
    s_mov_b32 s54, s100
    s_pack_ll_b32_b16 s100, s55, s59
    s_pack_hh_b32_b16 s59, s55, s59
    s_mov_b32 s55, s100
    s_pack_ll_b32_b16 s100, s36, s38
    s_pack_hh_b32_b16 s38, s36, s38
    s_mov_b32 s36, s100
    s_pack_ll_b32_b16 s100, s37, s39
    s_pack_hh_b32_b16 s39, s37, s39
    s_mov_b32 s37, s100
    s_pack_ll_b32_b16 s100, s60, s64
    s_pack_hh_b32_b16 s64, s60, s64
    s_mov_b32 s60, s100
    s_pack_ll_b32_b16 s100, s61, s65
    s_pack_hh_b32_b16 s65, s61, s65
    s_mov_b32 s61, s100
    s_pack_ll_b32_b16 s100, s62, s66
    s_pack_hh_b32_b16 s66, s62, s66
    s_mov_b32 s62, s100
    s_pack_ll_b32_b16 s100, s63, s67
    s_pack_hh_b32_b16 s67, s63, s67
    s_mov_b32 s63, s100
    s_pack_ll_b32_b16 s100, s40, s42
    s_pack_hh_b32_b16 s42, s40, s42
    s_mov_b32 s40, s100
    s_pack_ll_b32_b16 s100, s41, s43
    s_pack_hh_b32_b16 s43, s41, s43
    s_mov_b32 s41, s100
    s_pack_ll_b32_b16 s100, s68, s72
    s_pack_hh_b32_b16 s72, s68, s72
    s_mov_b32 s68, s100
    s_pack_ll_b32_b16 s100, s69, s73
    s_pack_hh_b32_b16 s73, s69, s73
    s_mov_b32 s69, s100
    s_pack_ll_b32_b16 s100, s70, s74
    s_pack_hh_b32_b16 s74, s70, s74
    s_mov_b32 s70, s100
    s_pack_ll_b32_b16 s100, s71, s75
    s_pack_hh_b32_b16 s75, s71, s75
    s_mov_b32 s71, s100
    s_pack_ll_b32_b16 s100, s44, s46
    s_pack_hh_b32_b16 s46, s44, s46
    s_mov_b32 s44, s100
    s_pack_ll_b32_b16 s100, s45, s47
    s_pack_hh_b32_b16 s47, s45, s47
    s_mov_b32 s45, s100
    s_pack_ll_b32_b16 s100, s76, s80
    s_pack_hh_b32_b16 s80, s76, s80
    s_mov_b32 s76, s100
    s_pack_ll_b32_b16 s100, s77, s81
    s_pack_hh_b32_b16 s81, s77, s81
    s_mov_b32 s77, s100
    s_pack_ll_b32_b16 s100, s78, s82
    s_pack_hh_b32_b16 s82, s78, s82
    s_mov_b32 s78, s100
    s_pack_ll_b32_b16 s100, s79, s83
    s_pack_hh_b32_b16 s83, s79, s83
    s_mov_b32 s79, s100
    s_pack_ll_b32_b16 s100, s48, s50
    s_pack_hh_b32_b16 s50, s48, s50
    s_mov_b32 s48, s100
    s_pack_ll_b32_b16 s100, s49, s51
    s_pack_hh_b32_b16 s51, s49, s51
    s_mov_b32 s49, s100
    s_waitcnt lgkmcnt(0)
    s_cmp_lg_u32 s24, 0
    s_cbranch_scc1 .Lsc0
    v_and_b32 v22, 0xff, v1
    v_lshlrev_b32 v22, 2, v22
    s_bfm_b64 exec, 50, 0
    ds_read_b128 v[8:11], v22 offset:0
    ds_read_b128 v[12:15], v22 offset:1024
    ds_read_b128 v[16:19], v22 offset:2048
    ds_read_b128 v[36:39], v22 offset:3072
    s_waitcnt lgkmcnt(2)
    v_add_u32_sdwa v12, v12, v8 dst_sel:DWORD dst_unused:UNUSED_PAD src0_sel:WORD_0 src1_sel:WORD_0
    s_waitcnt lgkmcnt(1)
    v_add_u32_sdwa v16, v16, v12 dst_sel:DWORD dst_unused:UNUSED_PAD src0_sel:WORD_0 src1_sel:DWORD
    s_waitcnt lgkmcnt(0)
    v_add_u32_sdwa v36, v36, v16 dst_sel:DWORD dst_unused:UNUSED_PAD src0_sel:WORD_0 src1_sel:DWORD
    v_add_u32_sdwa v9, v9, v36 dst_sel:DWORD dst_unused:UNUSED_PAD src0_sel:WORD_0 src1_sel:DWORD
    v_add_u32_sdwa v13, v13, v9 dst_sel:DWORD dst_unused:UNUSED_PAD src0_sel:WORD_0 src1_sel:DWORD
    v_add_u32_sdwa v17, v17, v13 dst_sel:DWORD dst_unused:UNUSED_PAD src0_sel:WORD_0 src1_sel:DWORD
    v_add_u32_sdwa v37, v37, v17 dst_sel:DWORD dst_unused:UNUSED_PAD src0_sel:WORD_0 src1_sel:DWORD
    v_add_u32_sdwa v10, v10, v37 dst_sel:DWORD dst_unused:UNUSED_PAD src0_sel:WORD_0 src1_sel:DWORD
    v_add_u32_sdwa v14, v14, v10 dst_sel:DWORD dst_unused:UNUSED_PAD src0_sel:WORD_0 src1_sel:DWORD
    v_add_u32_sdwa v18, v18, v14 dst_sel:DWORD dst_unused:UNUSED_PAD src0_sel:WORD_0 src1_sel:DWORD
    v_add_u32_sdwa v38, v38, v18 dst_sel:DWORD dst_unused:UNUSED_PAD src0_sel:WORD_0 src1_sel:DWORD
    v_add_u32_sdwa v11, v11, v38 dst_sel:DWORD dst_unused:UNUSED_PAD src0_sel:WORD_0 src1_sel:DWORD
    v_add_u32_sdwa v15, v15, v11 dst_sel:DWORD dst_unused:UNUSED_PAD src0_sel:WORD_0 src1_sel:DWORD
    v_add_u32_sdwa v19, v19, v15 dst_sel:DWORD dst_unused:UNUSED_PAD src0_sel:WORD_0 src1_sel:DWORD
    v_add_u32_sdwa v39, v39, v19 dst_sel:DWORD dst_unused:UNUSED_PAD src0_sel:WORD_0 src1_sel:DWORD
    v_mov_b32 v23, v39
    s_nop 1
    v_add_u32_dpp v23, v23, v23 row_shr:1 row_mask:0xf bank_mask:0xf
    s_nop 1
    v_add_u32_dpp v23, v23, v23 row_shr:2 row_mask:0xf bank_mask:0xf
    s_nop 1
    v_add_u32_dpp v23, v23, v23 row_shr:4 row_mask:0xf bank_mask:0xf
    s_nop 1
    v_add_u32_dpp v23, v23, v23 row_shr:8 row_mask:0xf bank_mask:0xf
    s_nop 1
    v_add_u32_dpp v23, v23, v23 row_bcast:15 row_mask:0xa bank_mask:0xf
    s_nop 1
    v_add_u32_dpp v23, v23, v23 row_bcast:31 row_mask:0xc bank_mask:0xf
    v_sub_u32 v23, v23, v39
    v_add_u32 v23, 2, v23
    v_add_u32_sdwa v39, v23, v19 dst_sel:DWORD dst_unused:UNUSED_PAD src0_sel:DWORD src1_sel:DWORD
    v_add_u32_sdwa v19, v23, v15 dst_sel:DWORD dst_unused:UNUSED_PAD src0_sel:DWORD src1_sel:DWORD
    v_add_u32_sdwa v15, v23, v11 dst_sel:DWORD dst_unused:UNUSED_PAD src0_sel:DWORD src1_sel:DWORD
    v_add_u32_sdwa v11, v23, v38 dst_sel:DWORD dst_unused:UNUSED_PAD src0_sel:DWORD src1_sel:DWORD
    v_add_u32_sdwa v38, v23, v18 dst_sel:DWORD dst_unused:UNUSED_PAD src0_sel:DWORD src1_sel:DWORD
    v_add_u32_sdwa v18, v23, v14 dst_sel:DWORD dst_unused:UNUSED_PAD src0_sel:DWORD src1_sel:DWORD
    v_add_u32_sdwa v14, v23, v10 dst_sel:DWORD dst_unused:UNUSED_PAD src0_sel:DWORD src1_sel:DWORD
    v_add_u32_sdwa v10, v23, v37 dst_sel:DWORD dst_unused:UNUSED_PAD src0_sel:DWORD src1_sel:DWORD
    v_add_u32_sdwa v37, v23, v17 dst_sel:DWORD dst_unused:UNUSED_PAD src0_sel:DWORD src1_sel:DWORD
    v_add_u32_sdwa v17, v23, v13 dst_sel:DWORD dst_unused:UNUSED_PAD src0_sel:DWORD src1_sel:DWORD
    v_add_u32_sdwa v13, v23, v9 dst_sel:DWORD dst_unused:UNUSED_PAD src0_sel:DWORD src1_sel:DWORD
    v_add_u32_sdwa v9, v23, v36 dst_sel:DWORD dst_unused:UNUSED_PAD src0_sel:DWORD src1_sel:DWORD
    v_add_u32_sdwa v36, v23, v16 dst_sel:DWORD dst_unused:UNUSED_PAD src0_sel:DWORD src1_sel:DWORD
    v_add_u32_sdwa v16, v23, v12 dst_sel:DWORD dst_unused:UNUSED_PAD src0_sel:DWORD src1_sel:DWORD
    v_add_u32_sdwa v12, v23, v8 dst_sel:DWORD dst_unused:UNUSED_PAD src0_sel:DWORD src1_sel:WORD_0
    v_lshlrev_b32 v8, 0, v23
    s_nop 0
    ds_write_b128 v22, v[8:11] offset:0
    ds_write_b128 v22, v[12:15] offset:1024
    ds_write_b128 v22, v[16:19] offset:2048
    ds_write_b128 v22, v[36:39] offset:3072
    ds_write_b128 v22, v[8:11] offset:8192
    ds_write_b128 v22, v[12:15] offset:9216
    ds_write_b128 v22, v[16:19] offset:10240
    ds_write_b128 v22, v[36:39] offset:11264
    s_mov_b64 exec, -1
    s_waitcnt lgkmcnt(0)
.Lsc0:
    buffer_load_dwordx3 v[80:82], v80, s[4:7], 0 offen sc1
    buffer_load_dwordx3 v[84:86], v84, s[4:7], 0 offen sc1
    buffer_load_dwordx3 v[88:90], v88, s[4:7], 0 offen sc1
    s_waitcnt lgkmcnt(0)
    s_barrier
    v_lshrrev_b32 v18, 2, v1
    v_and_b32 v19, 3, v18
    v_and_b32 v14, -4, v18
    v_lshl_or_b32 v14, v19, 10, v14
    v_add_u32 v16, 1, v18
    v_and_b32 v19, 3, v16
    v_and_b32 v16, -4, v16
    v_lshl_or_b32 v16, v19, 10, v16
    ds_read_b32 v17, v3 offset:12058
    ds_read_b32 v15, v14 offset:8196
    ds_read_b32 v14, v14 offset:8192
    ds_read_b32 v16, v16 offset:8192
    v_bfe_i32 v36, v46, 0, 16
    v_ashrrev_i32 v37, 16, v46
    ds_add_rtn_u32 v36, v36, v3
    ds_add_rtn_u32 v37, v37, v3
    buffer_load_dwordx3 v[92:94], v92, s[4:7], 0 offen sc1
    v_bfe_i32 v38, v50, 0, 16
    v_ashrrev_i32 v39, 16, v50
    ds_add_rtn_u32 v38, v38, v3
    ds_add_rtn_u32 v39, v39, v3
    s_waitcnt lgkmcnt(7)
    v_and_b32 v17, 0xffff, v17
    s_nop 0
    v_readfirstlane_b32 s26, v17
    v_lshl_add_u32 v19, v17, 1, s19
    v_mov_b32 v43, 0
    s_cmp_gt_u32 s26, 28160
    s_cbranch_scc1 .Lslow0
    s_mov_b64 exec, 1
    ds_write_b32 v19, v43
    v_mov_b32 v19, s19
    ds_write_b32 v19, v43
    s_mov_b64 exec, -1
    s_lshr_b32 s26, s26, 1
    s_cmp_lt_u32 s26, 12288
    s_cbranch_scc1 .Lfl0
.Lflx0:
    buffer_load_dwordx3 v[96:98], v96, s[4:7], 0 offen sc1
    s_waitcnt lgkmcnt(5)
    v_mad_u32_u16 v36, v36, 2, s19 op_sel:[0,0,0,0]
    s_waitcnt lgkmcnt(4)
    v_mad_u32_u16 v37, v37, 2, s19 op_sel:[0,0,0,0]
    ds_write_b32 v36, v45
    ds_write_b32 v37, v44
    v_bfe_i32 v40, v54, 0, 16
    v_ashrrev_i32 v41, 16, v54
    ds_add_rtn_u32 v40, v40, v3
    ds_add_rtn_u32 v41, v41, v3
    v_and_b32 v15, 0xffff, v15
    v_and_b32 v14, 0xffff, v14
    v_and_b32 v16, 0xffff, v16
    v_cmp_ne_u32 vcc, 0, v18
    s_nop 1
    v_cndmask_b32 v14, 0, v14, vcc
    v_add_u32 v14, 15, v14
    v_sub_u32 v19, v15, v16
    v_and_b32 v14, -16, v14
    v_cmpx_gt_u32 vcc, 796, v18
    v_cmpx_lt_u32 vcc, v14, v16
    v_cmp_ne_u32 vcc, v15, v17
    s_nop 1
    v_cndmask_b32 v19, 14, v19, vcc
    v_subrev_u32 v19, 14, v19
    v_and_b32 v19, 0x80000000, v19
    v_or_b32 v7, v7, v19
.Lbd0:
    v_lshrrev_b32 v19, 3, v14
    v_add_u32 v14, 16, v14
    ds_write_b16 v19, v18 offset:3872
    v_cmpx_lt_u32 vcc, v14, v16
    s_nop 1
    s_cbranch_execnz .Lbd0
    s_mov_b64 exec, -1
    buffer_load_dwordx3 v[100:102], v100, s[4:7], 0 offen sc1
    s_waitcnt lgkmcnt(8)
    v_mad_u32_u16 v38, v38, 2, s19 op_sel:[0,0,0,0]
    s_waitcnt lgkmcnt(7)
    v_mad_u32_u16 v39, v39, 2, s19 op_sel:[0,0,0,0]
    ds_write_b32 v38, v49
    ds_write_b32 v39, v48
    v_bfe_i32 v36, v58, 0, 16
    v_ashrrev_i32 v37, 16, v58
    ds_add_rtn_u32 v36, v36, v3
    ds_add_rtn_u32 v37, v37, v3
    s_waitcnt vmcnt(7)
    v_perm_b32 v22, v72, v74, v4
    v_cndmask_b32_e64 v72, v72, v74, s[84:85]
    v_pk_mad_u16 v22, v22, 4, -16 op_sel_hi:[1,0,0]
    v_perm_b32 v23, v72, v73, s101
    v_and_or_b32 v74, v23, s3, v22
    v_bfe_i32 v23, v74, 0, 16
    v_ashrrev_i32 v22, 16, v74
    ds_add_u32 v23, v6
    ds_add_u32 v22, v6
    buffer_load_dwordx3 v[104:106], v104, s[4:7], 0 offen sc1
    s_waitcnt lgkmcnt(8)
    v_mad_u32_u16 v40, v40, 2, s19 op_sel:[0,0,0,0]
    s_waitcnt lgkmcnt(7)
    v_mad_u32_u16 v41, v41, 2, s19 op_sel:[0,0,0,0]
    ds_write_b32 v40, v53
    ds_write_b32 v41, v52
    v_bfe_i32 v38, v62, 0, 16
    v_ashrrev_i32 v39, 16, v62
    ds_add_rtn_u32 v38, v38, v3
    ds_add_rtn_u32 v39, v39, v3
    buffer_load_dwordx3 v[108:110], v108, s[4:7], 0 offen sc1
    s_waitcnt vmcnt(8)
    v_perm_b32 v22, v76, v78, v4
    v_cndmask_b32_e64 v76, v76, v78, s[84:85]
    v_pk_mad_u16 v22, v22, 4, -16 op_sel_hi:[1,0,0]
    v_perm_b32 v23, v76, v77, s101
    v_and_or_b32 v78, v23, s3, v22
    v_bfe_i32 v23, v78, 0, 16
    v_ashrrev_i32 v22, 16, v78
    ds_add_u32 v23, v6
    ds_add_u32 v22, v6
    s_waitcnt lgkmcnt(9)
    v_mad_u32_u16 v36, v36, 2, s19 op_sel:[0,0,0,0]
    s_waitcnt lgkmcnt(8)
    v_mad_u32_u16 v37, v37, 2, s19 op_sel:[0,0,0,0]
    ds_write_b32 v36, v57
    ds_write_b32 v37, v56
    v_bfe_i32 v40, v66, 0, 16
    v_ashrrev_i32 v41, 16, v66
    ds_add_rtn_u32 v40, v40, v3
    ds_add_rtn_u32 v41, v41, v3
    buffer_load_dwordx3 v[112:114], v112, s[4:7], 0 offen sc1
    s_waitcnt vmcnt(8)
    v_perm_b32 v22, v80, v82, v4
    v_cndmask_b32_e64 v80, v80, v82, s[84:85]
    v_pk_mad_u16 v22, v22, 4, -16 op_sel_hi:[1,0,0]
    v_perm_b32 v23, v80, v81, s101
    v_and_or_b32 v82, v23, s3, v22
    v_bfe_i32 v23, v82, 0, 16
    v_ashrrev_i32 v22, 16, v82
    ds_add_u32 v23, v6
    ds_add_u32 v22, v6
    s_waitcnt lgkmcnt(9)
    v_mad_u32_u16 v38, v38, 2, s19 op_sel:[0,0,0,0]
    s_waitcnt lgkmcnt(8)
    v_mad_u32_u16 v39, v39, 2, s19 op_sel:[0,0,0,0]
    ds_write_b32 v38, v61
    ds_write_b32 v39, v60
    v_bfe_i32 v36, v70, 0, 16
    v_ashrrev_i32 v37, 16, v70
    ds_add_rtn_u32 v36, v36, v3
    ds_add_rtn_u32 v37, v37, v3
    buffer_load_dwordx3 v[116:118], v116, s[4:7], 0 offen sc1
    s_waitcnt vmcnt(8)
    v_perm_b32 v22, v84, v86, v4
    v_cndmask_b32_e64 v84, v84, v86, s[84:85]
    v_pk_mad_u16 v22, v22, 4, -16 op_sel_hi:[1,0,0]
    v_perm_b32 v23, v84, v85, s101
    v_and_or_b32 v86, v23, s3, v22
    v_bfe_i32 v23, v86, 0, 16
    v_ashrrev_i32 v22, 16, v86
    ds_add_u32 v23, v6
    ds_add_u32 v22, v6
    s_waitcnt lgkmcnt(9)
    v_mad_u32_u16 v40, v40, 2, s19 op_sel:[0,0,0,0]
    s_waitcnt lgkmcnt(8)
    v_mad_u32_u16 v41, v41, 2, s19 op_sel:[0,0,0,0]
    ds_write_b32 v40, v65
    ds_write_b32 v41, v64
    buffer_load_dwordx3 v[120:122], v120, s[4:7], 0 offen sc1
    s_waitcnt vmcnt(8)
    v_perm_b32 v22, v88, v90, v4
    v_cndmask_b32_e64 v88, v88, v90, s[84:85]
    v_pk_mad_u16 v22, v22, 4, -16 op_sel_hi:[1,0,0]
    v_perm_b32 v23, v88, v89, s101
    v_and_or_b32 v90, v23, s3, v22
    v_bfe_i32 v23, v90, 0, 16
    v_ashrrev_i32 v22, 16, v90
    ds_add_u32 v23, v6
    ds_add_u32 v22, v6
    s_waitcnt lgkmcnt(7)
    v_mad_u32_u16 v36, v36, 2, s19 op_sel:[0,0,0,0]
    s_waitcnt lgkmcnt(6)
    v_mad_u32_u16 v37, v37, 2, s19 op_sel:[0,0,0,0]
    ds_write_b32 v36, v69
    ds_write_b32 v37, v68
    buffer_load_dwordx3 v[124:126], v124, s[4:7], 0 offen sc1
    s_waitcnt vmcnt(8)
    v_perm_b32 v22, v92, v94, v4
    v_cndmask_b32_e64 v92, v92, v94, s[84:85]
    v_pk_mad_u16 v22, v22, 4, -16 op_sel_hi:[1,0,0]
    v_perm_b32 v23, v92, v93, s101
    v_and_or_b32 v94, v23, s3, v22
    v_bfe_i32 v23, v94, 0, 16
    v_ashrrev_i32 v22, 16, v94
    ds_add_u32 v23, v6
    ds_add_u32 v22, v6
    s_waitcnt vmcnt(7)
    v_perm_b32 v22, v96, v98, v4
    v_cndmask_b32_e64 v96, v96, v98, s[84:85]
    v_pk_mad_u16 v22, v22, 4, -16 op_sel_hi:[1,0,0]
    v_perm_b32 v23, v96, v97, s101
    v_and_or_b32 v98, v23, s3, v22
    v_bfe_i32 v23, v98, 0, 16
    v_ashrrev_i32 v22, 16, v98
    ds_add_u32 v23, v6
    ds_add_u32 v22, v6
    s_waitcnt lgkmcnt(0)
    s_barrier
    v_lshrrev_b32 v43, 3, v1
    v_and_b32 v43, -2, v43
    ds_read_b64 v[44:45], v2 offset:0
    ds_read_u16 v46, v43 offset:3872
    ds_read_b64 v[48:49], v2 offset:8192
    ds_read_u16 v50, v43 offset:4384
    ds_read_b64 v[52:53], v2 offset:16384
    ds_read_u16 v54, v43 offset:4896
    ds_read_b64 v[56:57], v2 offset:24576
    ds_read_u16 v58, v43 offset:5408
    ds_read_b64 v[60:61], v2 offset:32768
    ds_read_u16 v62, v43 offset:5920
    ds_read_b64 v[64:65], v2 offset:40960
    ds_read_u16 v66, v43 offset:6432
    ds_read_b64 v[68:69], v2 offset:49152
    ds_read_u16 v70, v43 offset:6944
    s_waitcnt lgkmcnt(12)
    v_lshlrev_b32 v46, 10, v46
    v_sub_u32 v24, v44, v46
    v_sub_u32 v26, v45, v46
    v_and_b32 v24, 0xff8, v24
    v_and_b32 v26, 0xff8, v26
    v_add_u32 v24, v24, v46
    v_add_u32 v26, v26, v46
    buffer_load_dwordx2 v[24:25], v24, s[8:11], 0 offen
    buffer_load_dwordx2 v[26:27], v26, s[8:11], 0 offen
    s_waitcnt lgkmcnt(10)
    v_lshlrev_b32 v50, 10, v50
    v_sub_u32 v28, v48, v50
    v_sub_u32 v30, v49, v50
    v_and_b32 v28, 0xff8, v28
    v_and_b32 v30, 0xff8, v30
    v_add_u32 v28, v28, v50
    v_add_u32 v30, v30, v50
    buffer_load_dwordx2 v[28:29], v28, s[8:11], 0 offen
    buffer_load_dwordx2 v[30:31], v30, s[8:11], 0 offen
    s_waitcnt lgkmcnt(0)
    s_cmp_lg_u32 s24, 5
    s_cbranch_scc1 .Lsc1
    v_and_b32 v22, 0xff, v1
    v_lshlrev_b32 v22, 2, v22
    s_bfm_b64 exec, 50, 0
    ds_read_b128 v[8:11], v22 offset:0
    ds_read_b128 v[12:15], v22 offset:1024
    ds_read_b128 v[16:19], v22 offset:2048
    ds_read_b128 v[36:39], v22 offset:3072
    s_waitcnt lgkmcnt(2)
    v_add_u32_sdwa v12, v12, v8 dst_sel:DWORD dst_unused:UNUSED_PAD src0_sel:WORD_1 src1_sel:WORD_1
    s_waitcnt lgkmcnt(1)
    v_add_u32_sdwa v16, v16, v12 dst_sel:DWORD dst_unused:UNUSED_PAD src0_sel:WORD_1 src1_sel:DWORD
    s_waitcnt lgkmcnt(0)
    v_add_u32_sdwa v36, v36, v16 dst_sel:DWORD dst_unused:UNUSED_PAD src0_sel:WORD_1 src1_sel:DWORD
    v_add_u32_sdwa v9, v9, v36 dst_sel:DWORD dst_unused:UNUSED_PAD src0_sel:WORD_1 src1_sel:DWORD
    v_add_u32_sdwa v13, v13, v9 dst_sel:DWORD dst_unused:UNUSED_PAD src0_sel:WORD_1 src1_sel:DWORD
    v_add_u32_sdwa v17, v17, v13 dst_sel:DWORD dst_unused:UNUSED_PAD src0_sel:WORD_1 src1_sel:DWORD
    v_add_u32_sdwa v37, v37, v17 dst_sel:DWORD dst_unused:UNUSED_PAD src0_sel:WORD_1 src1_sel:DWORD
    v_add_u32_sdwa v10, v10, v37 dst_sel:DWORD dst_unused:UNUSED_PAD src0_sel:WORD_1 src1_sel:DWORD
    v_add_u32_sdwa v14, v14, v10 dst_sel:DWORD dst_unused:UNUSED_PAD src0_sel:WORD_1 src1_sel:DWORD
    v_add_u32_sdwa v18, v18, v14 dst_sel:DWORD dst_unused:UNUSED_PAD src0_sel:WORD_1 src1_sel:DWORD
    v_add_u32_sdwa v38, v38, v18 dst_sel:DWORD dst_unused:UNUSED_PAD src0_sel:WORD_1 src1_sel:DWORD
    v_add_u32_sdwa v11, v11, v38 dst_sel:DWORD dst_unused:UNUSED_PAD src0_sel:WORD_1 src1_sel:DWORD
    v_add_u32_sdwa v15, v15, v11 dst_sel:DWORD dst_unused:UNUSED_PAD src0_sel:WORD_1 src1_sel:DWORD
    v_add_u32_sdwa v19, v19, v15 dst_sel:DWORD dst_unused:UNUSED_PAD src0_sel:WORD_1 src1_sel:DWORD
    v_add_u32_sdwa v39, v39, v19 dst_sel:DWORD dst_unused:UNUSED_PAD src0_sel:WORD_1 src1_sel:DWORD
    v_mov_b32 v23, v39
    s_nop 1
    v_add_u32_dpp v23, v23, v23 row_shr:1 row_mask:0xf bank_mask:0xf
    s_nop 1
    v_add_u32_dpp v23, v23, v23 row_shr:2 row_mask:0xf bank_mask:0xf
    s_nop 1
    v_add_u32_dpp v23, v23, v23 row_shr:4 row_mask:0xf bank_mask:0xf
    s_nop 1
    v_add_u32_dpp v23, v23, v23 row_shr:8 row_mask:0xf bank_mask:0xf
    s_nop 1
    v_add_u32_dpp v23, v23, v23 row_bcast:15 row_mask:0xa bank_mask:0xf
    s_nop 1
    v_add_u32_dpp v23, v23, v23 row_bcast:31 row_mask:0xc bank_mask:0xf
    v_sub_u32 v23, v23, v39
    v_add_u32 v23, 2, v23
    v_add_u32_sdwa v39, v23, v19 dst_sel:WORD_1 dst_unused:UNUSED_PAD src0_sel:DWORD src1_sel:DWORD
    v_add_u32_sdwa v19, v23, v15 dst_sel:WORD_1 dst_unused:UNUSED_PAD src0_sel:DWORD src1_sel:DWORD
    v_add_u32_sdwa v15, v23, v11 dst_sel:WORD_1 dst_unused:UNUSED_PAD src0_sel:DWORD src1_sel:DWORD
    v_add_u32_sdwa v11, v23, v38 dst_sel:WORD_1 dst_unused:UNUSED_PAD src0_sel:DWORD src1_sel:DWORD
    v_add_u32_sdwa v38, v23, v18 dst_sel:WORD_1 dst_unused:UNUSED_PAD src0_sel:DWORD src1_sel:DWORD
    v_add_u32_sdwa v18, v23, v14 dst_sel:WORD_1 dst_unused:UNUSED_PAD src0_sel:DWORD src1_sel:DWORD
    v_add_u32_sdwa v14, v23, v10 dst_sel:WORD_1 dst_unused:UNUSED_PAD src0_sel:DWORD src1_sel:DWORD
    v_add_u32_sdwa v10, v23, v37 dst_sel:WORD_1 dst_unused:UNUSED_PAD src0_sel:DWORD src1_sel:DWORD
    v_add_u32_sdwa v37, v23, v17 dst_sel:WORD_1 dst_unused:UNUSED_PAD src0_sel:DWORD src1_sel:DWORD
    v_add_u32_sdwa v17, v23, v13 dst_sel:WORD_1 dst_unused:UNUSED_PAD src0_sel:DWORD src1_sel:DWORD
    v_add_u32_sdwa v13, v23, v9 dst_sel:WORD_1 dst_unused:UNUSED_PAD src0_sel:DWORD src1_sel:DWORD
    v_add_u32_sdwa v9, v23, v36 dst_sel:WORD_1 dst_unused:UNUSED_PAD src0_sel:DWORD src1_sel:DWORD
    v_add_u32_sdwa v36, v23, v16 dst_sel:WORD_1 dst_unused:UNUSED_PAD src0_sel:DWORD src1_sel:DWORD
    v_add_u32_sdwa v16, v23, v12 dst_sel:WORD_1 dst_unused:UNUSED_PAD src0_sel:DWORD src1_sel:DWORD
    v_add_u32_sdwa v12, v23, v8 dst_sel:WORD_1 dst_unused:UNUSED_PAD src0_sel:DWORD src1_sel:WORD_1
    v_lshlrev_b32 v8, 16, v23
    s_nop 0
    ds_write_b128 v22, v[8:11] offset:0
    ds_write_b128 v22, v[12:15] offset:1024
    ds_write_b128 v22, v[16:19] offset:2048
    ds_write_b128 v22, v[36:39] offset:3072
    s_mov_b64 exec, -1
    s_waitcnt lgkmcnt(0)
.Lsc1:
    v_mov_b32 v14, 0x40004000
    v_mov_b32 v15, 0x40004000
    v_mov_b32 v16, 0x40004000
    v_mov_b32 v17, 0x40004000
    v_lshlrev_b32 v22, 3, v0
    v_mov_b32 v23, 0
    ds_write_b128 v22, v[14:17] offset:7392
    ds_write_b128 v22, v[14:17] offset:23776
    ds_write_b128 v22, v[14:17] offset:40160
    v_add_u32 v22, 49152, v22
    ds_write_b128 v22, v[14:17] offset:7392
    ds_write_b128 v22, v[14:17] offset:23776
    ds_write_b128 v22, v[14:17] offset:40160
    v_cmpx_gt_u32 vcc, 214, v0
    ds_write_b128 v22, v[14:17] offset:56544
    ds_write_b32 v23, v23 offset:832
    s_mov_b64 exec, -1
    s_waitcnt lgkmcnt(0)
    s_barrier
    v_lshlrev_b32 v54, 10, v54
    v_sub_u32 v32, v52, v54
    v_sub_u32 v34, v53, v54
    v_and_b32 v32, 0xff8, v32
    v_and_b32 v34, 0xff8, v34
    v_add_u32 v32, v32, v54
    v_add_u32 v34, v34, v54
    buffer_load_dwordx2 v[32:33], v32, s[8:11], 0 offen
    buffer_load_dwordx2 v[34:35], v34, s[8:11], 0 offen
    v_lshrrev_b32 v40, 2, v1
    v_and_b32 v41, 3, v40
    v_and_b32 v36, -4, v40
    v_lshl_or_b32 v36, v41, 10, v36
    v_add_u32 v38, 1, v40
    v_and_b32 v41, 3, v38
    v_and_b32 v38, -4, v38
    v_lshl_or_b32 v38, v41, 10, v38
    ds_read_b32 v39, v3 offset:3866
    ds_read_b32 v37, v36 offset:4
    ds_read_b32 v36, v36 offset:0
    ds_read_b32 v38, v38 offset:0
    s_waitcnt lgkmcnt(3)
    v_lshrrev_b32 v39, 16, v39
    s_nop 0
    v_readfirstlane_b32 s27, v39
    v_lshl_add_u32 v41, v39, 1, s19
    v_mov_b32 v43, 0
    s_cmp_gt_u32 s27, 28160
    s_cbranch_scc1 .Lslow0
    s_mov_b64 exec, 1
    ds_write_b32 v41, v43
    v_mov_b32 v41, s19
    ds_write_b32 v41, v43
    s_mov_b64 exec, -1
    s_lshr_b32 s27, s27, 1
    s_cmp_lt_u32 s27, 12288
    s_cbranch_scc1 .Lfl1
.Lflx1:
    s_waitcnt lgkmcnt(4)
    v_lshrrev_b32 v37, 16, v37
    s_waitcnt lgkmcnt(3)
    v_lshrrev_b32 v36, 16, v36
    s_waitcnt lgkmcnt(2)
    v_lshrrev_b32 v38, 16, v38
    v_cmp_ne_u32 vcc, 0, v40
    s_nop 1
    v_cndmask_b32 v36, 0, v36, vcc
    v_add_u32 v36, 15, v36
    v_sub_u32 v41, v37, v38
    v_and_b32 v36, -16, v36
    v_cmpx_gt_u32 vcc, 796, v40
    v_cmpx_lt_u32 vcc, v36, v38
    v_cmp_ne_u32 vcc, v37, v39
    s_nop 1
    v_cndmask_b32 v41, 14, v41, vcc
    v_subrev_u32 v41, 14, v41
    v_and_b32 v41, 0x80000000, v41
    v_or_b32 v7, v7, v41
.Lbd1:
    v_lshrrev_b32 v41, 3, v36
    v_add_u32 v36, 16, v36
    ds_write_b16 v41, v40 offset:3872
    v_cmpx_lt_u32 vcc, v36, v38
    s_nop 1
    s_cbranch_execnz .Lbd1
    s_mov_b64 exec, -1
    s_waitcnt vmcnt(12)
    v_perm_b32 v22, v100, v102, v4
    v_cndmask_b32_e64 v100, v100, v102, s[84:85]
    v_pk_mad_u16 v22, v22, 4, -16 op_sel_hi:[1,0,0]
    v_perm_b32 v23, v100, v101, s101
    v_and_or_b32 v102, v23, s3, v22
    v_bfe_i32 v23, v102, 0, 16
    v_ashrrev_i32 v22, 16, v102
    ds_add_u32 v23, v3
    ds_add_u32 v22, v3
    s_waitcnt vmcnt(11)
    v_perm_b32 v22, v104, v106, v4
    v_cndmask_b32_e64 v104, v104, v106, s[84:85]
    v_pk_mad_u16 v22, v22, 4, -16 op_sel_hi:[1,0,0]
    v_perm_b32 v23, v104, v105, s101
    v_and_or_b32 v106, v23, s3, v22
    v_bfe_i32 v23, v106, 0, 16
    v_ashrrev_i32 v22, 16, v106
    ds_add_u32 v23, v3
    ds_add_u32 v22, v3
    s_waitcnt vmcnt(10)
    v_perm_b32 v22, v108, v110, v4
    v_cndmask_b32_e64 v108, v108, v110, s[84:85]
    v_pk_mad_u16 v22, v22, 4, -16 op_sel_hi:[1,0,0]
    v_perm_b32 v23, v108, v109, s101
    v_and_or_b32 v110, v23, s3, v22
    v_bfe_i32 v23, v110, 0, 16
    v_ashrrev_i32 v22, 16, v110
    ds_add_u32 v23, v3
    ds_add_u32 v22, v3
    s_waitcnt vmcnt(9)
    v_perm_b32 v22, v112, v114, v4
    v_cndmask_b32_e64 v112, v112, v114, s[84:85]
    v_pk_mad_u16 v22, v22, 4, -16 op_sel_hi:[1,0,0]
    v_perm_b32 v23, v112, v113, s101
    v_and_or_b32 v114, v23, s3, v22
    v_bfe_i32 v23, v114, 0, 16
    v_ashrrev_i32 v22, 16, v114
    ds_add_u32 v23, v3
    ds_add_u32 v22, v3
    s_waitcnt vmcnt(8)
    v_perm_b32 v22, v116, v118, v4
    v_cndmask_b32_e64 v116, v116, v118, s[84:85]
    v_pk_mad_u16 v22, v22, 4, -16 op_sel_hi:[1,0,0]
    v_perm_b32 v23, v116, v117, s101
    v_and_or_b32 v118, v23, s3, v22
    v_bfe_i32 v23, v118, 0, 16
    v_ashrrev_i32 v22, 16, v118
    ds_add_u32 v23, v3
    ds_add_u32 v22, v3
    s_waitcnt vmcnt(7)
    v_perm_b32 v22, v120, v122, v4
    v_cndmask_b32_e64 v120, v120, v122, s[84:85]
    v_pk_mad_u16 v22, v22, 4, -16 op_sel_hi:[1,0,0]
    v_perm_b32 v23, v120, v121, s101
    v_and_or_b32 v122, v23, s3, v22
    v_bfe_i32 v23, v122, 0, 16
    v_ashrrev_i32 v22, 16, v122
    ds_add_u32 v23, v3
    ds_add_u32 v22, v3
    s_waitcnt vmcnt(6)
    v_perm_b32 v22, v124, v126, v4
    v_cndmask_b32_e64 v124, v124, v126, s[84:85]
    v_pk_mad_u16 v22, v22, 4, -16 op_sel_hi:[1,0,0]
    v_perm_b32 v23, v124, v125, s101
    v_and_or_b32 v126, v23, s3, v22
    v_bfe_i32 v23, v126, 0, 16
    v_ashrrev_i32 v22, 16, v126
    ds_add_u32 v23, v3
    ds_add_u32 v22, v3
    v_alignbit_b32 v44, v44, v44, 9
    v_alignbit_b32 v45, v45, v45, 9
    v_and_b32 v8, 0x3ff0000, v44
    v_and_b32 v9, 0x3ff0000, v45
    v_pk_mul_f32 v[8:9], v[8:9], s[20:21] op_sel_hi:[1,0]
    v_cos_f32 v8, v8
    v_cos_f32 v23, v9
    s_nop 0
    v_pk_mul_f32 v[8:9], v[8:9], s[16:17] op_sel_hi:[0,1]
    v_and_b32 v22, 0xfff8, v44
    v_fma_f32 v9, v8, v9, v5
    s_waitcnt vmcnt(5)
    v_lshlrev_b32 v10, 16, v24
    v_and_b32 v11, 0xffff0000, v24
    v_lshlrev_b32 v12, 16, v25
    v_and_b32 v13, 0xffff0000, v25
    v_pk_fma_f32 v[14:15], v[8:9], v[10:11], s[12:13] op_sel_hi:[1,0,1]
    v_pk_fma_f32 v[16:17], v[8:9], v[10:11], s[14:15] op_sel:[0,1,0]
    v_pk_fma_f32 v[18:19], v[8:9], v[12:13], s[12:13] op_sel_hi:[1,0,1]
    v_pk_fma_f32 v[20:21], v[8:9], v[12:13], s[14:15] op_sel:[0,1,0]
    v_lshl_add_u32 v15, v17, 16, v15
    v_lshl_add_u32 v19, v21, 16, v19
    v_mad_u64_u32 v[14:15], vcc, v16, s18, v[14:15]
    v_mad_u64_u32 v[18:19], vcc, v20, s18, v[18:19]
    ds_add_rtn_u64 v[24:25], v22, v[14:15] offset:7392
    ds_add_rtn_u64 v[46:47], v22, v[18:19] offset:57400
    v_pk_mul_f32 v[8:9], v[22:23], s[16:17] op_sel:[1,0] op_sel_hi:[1,1]
    v_and_b32 v22, 0xfff8, v45
    v_fma_f32 v9, v8, v9, v5
    s_waitcnt vmcnt(4)
    v_lshlrev_b32 v10, 16, v26
    v_and_b32 v11, 0xffff0000, v26
    v_lshlrev_b32 v12, 16, v27
    v_and_b32 v13, 0xffff0000, v27
    v_pk_fma_f32 v[14:15], v[8:9], v[10:11], s[12:13] op_sel_hi:[1,0,1]
    v_pk_fma_f32 v[16:17], v[8:9], v[10:11], s[14:15] op_sel:[0,1,0]
    v_pk_fma_f32 v[18:19], v[8:9], v[12:13], s[12:13] op_sel_hi:[1,0,1]
    v_pk_fma_f32 v[20:21], v[8:9], v[12:13], s[14:15] op_sel:[0,1,0]
    v_lshl_add_u32 v15, v17, 16, v15
    v_lshl_add_u32 v19, v21, 16, v19
    v_mad_u64_u32 v[14:15], vcc, v16, s18, v[14:15]
    v_mad_u64_u32 v[18:19], vcc, v20, s18, v[18:19]
    ds_add_rtn_u64 v[26:27], v22, v[14:15] offset:7392
    ds_add_rtn_u64 v[44:45], v22, v[18:19] offset:57400
    s_waitcnt lgkmcnt(3)
    v_or3_b32 v7, v7, v24, v25
    s_waitcnt lgkmcnt(2)
    v_or3_b32 v7, v7, v46, v47
    s_waitcnt lgkmcnt(1)
    v_or3_b32 v7, v7, v26, v27
    s_waitcnt lgkmcnt(0)
    v_or3_b32 v7, v7, v44, v45
    v_lshlrev_b32 v58, 10, v58
    v_sub_u32 v24, v56, v58
    v_sub_u32 v26, v57, v58
    v_and_b32 v24, 0xff8, v24
    v_and_b32 v26, 0xff8, v26
    v_add_u32 v24, v24, v58
    v_add_u32 v26, v26, v58
    buffer_load_dwordx2 v[24:25], v24, s[8:11], 0 offen
    buffer_load_dwordx2 v[26:27], v26, s[8:11], 0 offen
    buffer_load_dwordx3 v[44:46], v103, s[4:7], 0 offen sc1
    s_waitcnt lgkmcnt(0)
    s_barrier
    v_bfe_i32 v36, v74, 0, 16
    v_ashrrev_i32 v37, 16, v74
    ds_add_rtn_u32 v36, v36, v6
    ds_add_rtn_u32 v37, v37, v6
    v_bfe_i32 v38, v78, 0, 16
    v_ashrrev_i32 v39, 16, v78
    ds_add_rtn_u32 v38, v38, v6
    ds_add_rtn_u32 v39, v39, v6
    v_alignbit_b32 v48, v48, v48, 9
    v_alignbit_b32 v49, v49, v49, 9
    v_and_b32 v8, 0x3ff0000, v48
    v_and_b32 v9, 0x3ff0000, v49
    v_pk_mul_f32 v[8:9], v[8:9], s[20:21] op_sel_hi:[1,0]
    v_cos_f32 v8, v8
    v_cos_f32 v23, v9
    s_nop 0
    v_pk_mul_f32 v[8:9], v[8:9], s[16:17] op_sel_hi:[0,1]
    v_and_b32 v22, 0xfff8, v48
    v_fma_f32 v9, v8, v9, v5
    s_waitcnt vmcnt(6)
    v_lshlrev_b32 v10, 16, v28
    v_and_b32 v11, 0xffff0000, v28
    v_lshlrev_b32 v12, 16, v29
    v_and_b32 v13, 0xffff0000, v29
    v_pk_fma_f32 v[14:15], v[8:9], v[10:11], s[12:13] op_sel_hi:[1,0,1]
    v_pk_fma_f32 v[16:17], v[8:9], v[10:11], s[14:15] op_sel:[0,1,0]
    v_pk_fma_f32 v[18:19], v[8:9], v[12:13], s[12:13] op_sel_hi:[1,0,1]
    v_pk_fma_f32 v[20:21], v[8:9], v[12:13], s[14:15] op_sel:[0,1,0]
    v_lshl_add_u32 v15, v17, 16, v15
    v_lshl_add_u32 v19, v21, 16, v19
    v_mad_u64_u32 v[14:15], vcc, v16, s18, v[14:15]
    v_mad_u64_u32 v[18:19], vcc, v20, s18, v[18:19]
    ds_add_rtn_u64 v[28:29], v22, v[14:15] offset:7392
    ds_add_rtn_u64 v[50:51], v22, v[18:19] offset:57400
    v_pk_mul_f32 v[8:9], v[22:23], s[16:17] op_sel:[1,0] op_sel_hi:[1,1]
    v_and_b32 v22, 0xfff8, v49
    v_fma_f32 v9, v8, v9, v5
    s_waitcnt vmcnt(5)
    v_lshlrev_b32 v10, 16, v30
    v_and_b32 v11, 0xffff0000, v30
    v_lshlrev_b32 v12, 16, v31
    v_and_b32 v13, 0xffff0000, v31
    v_pk_fma_f32 v[14:15], v[8:9], v[10:11], s[12:13] op_sel_hi:[1,0,1]
    v_pk_fma_f32 v[16:17], v[8:9], v[10:11], s[14:15] op_sel:[0,1,0]
    v_pk_fma_f32 v[18:19], v[8:9], v[12:13], s[12:13] op_sel_hi:[1,0,1]
    v_pk_fma_f32 v[20:21], v[8:9], v[12:13], s[14:15] op_sel:[0,1,0]
    v_lshl_add_u32 v15, v17, 16, v15
    v_lshl_add_u32 v19, v21, 16, v19
    v_mad_u64_u32 v[14:15], vcc, v16, s18, v[14:15]
    v_mad_u64_u32 v[18:19], vcc, v20, s18, v[18:19]
    ds_add_rtn_u64 v[30:31], v22, v[14:15] offset:7392
    ds_add_rtn_u64 v[48:49], v22, v[18:19] offset:57400
    s_waitcnt lgkmcnt(3)
    v_or3_b32 v7, v7, v28, v29
    s_waitcnt lgkmcnt(2)
    v_or3_b32 v7, v7, v50, v51
    s_waitcnt lgkmcnt(1)
    v_or3_b32 v7, v7, v30, v31
    s_waitcnt lgkmcnt(0)
    v_or3_b32 v7, v7, v48, v49
    v_lshlrev_b32 v62, 10, v62
    v_sub_u32 v28, v60, v62
    v_sub_u32 v30, v61, v62
    v_and_b32 v28, 0xff8, v28
    v_and_b32 v30, 0xff8, v30
    v_add_u32 v28, v28, v62
    v_add_u32 v30, v30, v62
    buffer_load_dwordx2 v[28:29], v28, s[8:11], 0 offen
    buffer_load_dwordx2 v[30:31], v30, s[8:11], 0 offen
    buffer_load_dwordx3 v[48:50], v107, s[4:7], 0 offen sc1
    v_mad_u32_u16 v36, v36, 2, s19 op_sel:[1,0,0,0]
    v_mad_u32_u16 v37, v37, 2, s19 op_sel:[1,0,0,0]
    ds_write_b32 v36, v73
    ds_write_b32 v37, v72
    v_bfe_i32 v40, v82, 0, 16
    v_ashrrev_i32 v41, 16, v82
    ds_add_rtn_u32 v40, v40, v6
    ds_add_rtn_u32 v41, v41, v6
    v_mad_u32_u16 v38, v38, 2, s19 op_sel:[1,0,0,0]
    v_mad_u32_u16 v39, v39, 2, s19 op_sel:[1,0,0,0]
    ds_write_b32 v38, v77
    ds_write_b32 v39, v76
    v_bfe_i32 v36, v86, 0, 16
    v_ashrrev_i32 v37, 16, v86
    ds_add_rtn_u32 v36, v36, v6
    ds_add_rtn_u32 v37, v37, v6
    s_waitcnt lgkmcnt(5)
    v_mad_u32_u16 v40, v40, 2, s19 op_sel:[1,0,0,0]
    s_waitcnt lgkmcnt(4)
    v_mad_u32_u16 v41, v41, 2, s19 op_sel:[1,0,0,0]
    ds_write_b32 v40, v81
    ds_write_b32 v41, v80
    v_bfe_i32 v38, v90, 0, 16
    v_ashrrev_i32 v39, 16, v90
    ds_add_rtn_u32 v38, v38, v6
    ds_add_rtn_u32 v39, v39, v6
    s_waitcnt lgkmcnt(5)
    v_mad_u32_u16 v36, v36, 2, s19 op_sel:[1,0,0,0]
    s_waitcnt lgkmcnt(4)
    v_mad_u32_u16 v37, v37, 2, s19 op_sel:[1,0,0,0]
    ds_write_b32 v36, v85
    ds_write_b32 v37, v84
    v_bfe_i32 v40, v94, 0, 16
    v_ashrrev_i32 v41, 16, v94
    ds_add_rtn_u32 v40, v40, v6
    ds_add_rtn_u32 v41, v41, v6
    v_alignbit_b32 v52, v52, v52, 9
    v_alignbit_b32 v53, v53, v53, 9
    v_and_b32 v8, 0x3ff0000, v52
    v_and_b32 v9, 0x3ff0000, v53
    v_pk_mul_f32 v[8:9], v[8:9], s[20:21] op_sel_hi:[1,0]
    v_cos_f32 v8, v8
    v_cos_f32 v23, v9
    s_nop 0
    v_pk_mul_f32 v[8:9], v[8:9], s[16:17] op_sel_hi:[0,1]
    v_and_b32 v22, 0xfff8, v52
    v_fma_f32 v9, v8, v9, v5
    s_waitcnt vmcnt(7)
    v_lshlrev_b32 v10, 16, v32
    v_and_b32 v11, 0xffff0000, v32
    v_lshlrev_b32 v12, 16, v33
    v_and_b32 v13, 0xffff0000, v33
    v_pk_fma_f32 v[14:15], v[8:9], v[10:11], s[12:13] op_sel_hi:[1,0,1]
    v_pk_fma_f32 v[16:17], v[8:9], v[10:11], s[14:15] op_sel:[0,1,0]
    v_pk_fma_f32 v[18:19], v[8:9], v[12:13], s[12:13] op_sel_hi:[1,0,1]
    v_pk_fma_f32 v[20:21], v[8:9], v[12:13], s[14:15] op_sel:[0,1,0]
    v_lshl_add_u32 v15, v17, 16, v15
    v_lshl_add_u32 v19, v21, 16, v19
    v_mad_u64_u32 v[14:15], vcc, v16, s18, v[14:15]
    v_mad_u64_u32 v[18:19], vcc, v20, s18, v[18:19]
    ds_add_rtn_u64 v[32:33], v22, v[14:15] offset:7392
    ds_add_rtn_u64 v[54:55], v22, v[18:19] offset:57400
    v_pk_mul_f32 v[8:9], v[22:23], s[16:17] op_sel:[1,0] op_sel_hi:[1,1]
    v_and_b32 v22, 0xfff8, v53
    v_fma_f32 v9, v8, v9, v5
    s_waitcnt vmcnt(6)
    v_lshlrev_b32 v10, 16, v34
    v_and_b32 v11, 0xffff0000, v34
    v_lshlrev_b32 v12, 16, v35
    v_and_b32 v13, 0xffff0000, v35
    v_pk_fma_f32 v[14:15], v[8:9], v[10:11], s[12:13] op_sel_hi:[1,0,1]
    v_pk_fma_f32 v[16:17], v[8:9], v[10:11], s[14:15] op_sel:[0,1,0]
    v_pk_fma_f32 v[18:19], v[8:9], v[12:13], s[12:13] op_sel_hi:[1,0,1]
    v_pk_fma_f32 v[20:21], v[8:9], v[12:13], s[14:15] op_sel:[0,1,0]
    v_lshl_add_u32 v15, v17, 16, v15
    v_lshl_add_u32 v19, v21, 16, v19
    v_mad_u64_u32 v[14:15], vcc, v16, s18, v[14:15]
    v_mad_u64_u32 v[18:19], vcc, v20, s18, v[18:19]
    ds_add_rtn_u64 v[34:35], v22, v[14:15] offset:7392
    ds_add_rtn_u64 v[52:53], v22, v[18:19] offset:57400
    s_waitcnt lgkmcnt(3)
    v_or3_b32 v7, v7, v32, v33
    s_waitcnt lgkmcnt(2)
    v_or3_b32 v7, v7, v54, v55
    s_waitcnt lgkmcnt(1)
    v_or3_b32 v7, v7, v34, v35
    s_waitcnt lgkmcnt(0)
    v_or3_b32 v7, v7, v52, v53
    v_lshlrev_b32 v66, 10, v66
    v_sub_u32 v32, v64, v66
    v_sub_u32 v34, v65, v66
    v_and_b32 v32, 0xff8, v32
    v_and_b32 v34, 0xff8, v34
    v_add_u32 v32, v32, v66
    v_add_u32 v34, v34, v66
    buffer_load_dwordx2 v[32:33], v32, s[8:11], 0 offen
    buffer_load_dwordx2 v[34:35], v34, s[8:11], 0 offen
    buffer_load_dwordx3 v[52:54], v111, s[4:7], 0 offen sc1
    v_mad_u32_u16 v38, v38, 2, s19 op_sel:[1,0,0,0]
    v_mad_u32_u16 v39, v39, 2, s19 op_sel:[1,0,0,0]
    ds_write_b32 v38, v89
    ds_write_b32 v39, v88
    v_bfe_i32 v36, v98, 0, 16
    v_ashrrev_i32 v37, 16, v98
    ds_add_rtn_u32 v36, v36, v6
    ds_add_rtn_u32 v37, v37, v6
    v_mad_u32_u16 v40, v40, 2, s19 op_sel:[1,0,0,0]
    v_mad_u32_u16 v41, v41, 2, s19 op_sel:[1,0,0,0]
    ds_write_b32 v40, v93
    ds_write_b32 v41, v92
    s_waitcnt lgkmcnt(3)
    v_mad_u32_u16 v36, v36, 2, s19 op_sel:[1,0,0,0]
    s_waitcnt lgkmcnt(2)
    v_mad_u32_u16 v37, v37, 2, s19 op_sel:[1,0,0,0]
    ds_write_b32 v36, v97
    ds_write_b32 v37, v96
    s_waitcnt lgkmcnt(0)
    s_barrier
    v_lshrrev_b32 v43, 3, v1
    v_and_b32 v43, -2, v43
    ds_read_b64 v[72:73], v2 offset:0
    ds_read_u16 v74, v43 offset:3872
    ds_read_b64 v[76:77], v2 offset:8192
    ds_read_u16 v78, v43 offset:4384
    ds_read_b64 v[80:81], v2 offset:16384
    ds_read_u16 v82, v43 offset:4896
    ds_read_b64 v[84:85], v2 offset:24576
    ds_read_u16 v86, v43 offset:5408
    ds_read_b64 v[88:89], v2 offset:32768
    ds_read_u16 v90, v43 offset:5920
    ds_read_b64 v[92:93], v2 offset:40960
    ds_read_u16 v94, v43 offset:6432
    ds_read_b64 v[96:97], v2 offset:49152
    ds_read_u16 v98, v43 offset:6944
    v_alignbit_b32 v56, v56, v56, 9
    v_alignbit_b32 v57, v57, v57, 9
    v_and_b32 v8, 0x3ff0000, v56
    v_and_b32 v9, 0x3ff0000, v57
    v_pk_mul_f32 v[8:9], v[8:9], s[20:21] op_sel_hi:[1,0]
    v_cos_f32 v8, v8
    v_cos_f32 v23, v9
    s_nop 0
    v_pk_mul_f32 v[8:9], v[8:9], s[16:17] op_sel_hi:[0,1]
    v_and_b32 v22, 0xfff8, v56
    v_fma_f32 v9, v8, v9, v5
    s_waitcnt vmcnt(8)
    v_lshlrev_b32 v10, 16, v24
    v_and_b32 v11, 0xffff0000, v24
    v_lshlrev_b32 v12, 16, v25
    v_and_b32 v13, 0xffff0000, v25
    v_pk_fma_f32 v[14:15], v[8:9], v[10:11], s[12:13] op_sel_hi:[1,0,1]
    v_pk_fma_f32 v[16:17], v[8:9], v[10:11], s[14:15] op_sel:[0,1,0]
    v_pk_fma_f32 v[18:19], v[8:9], v[12:13], s[12:13] op_sel_hi:[1,0,1]
    v_pk_fma_f32 v[20:21], v[8:9], v[12:13], s[14:15] op_sel:[0,1,0]
    v_lshl_add_u32 v15, v17, 16, v15
    v_lshl_add_u32 v19, v21, 16, v19
    v_mad_u64_u32 v[14:15], vcc, v16, s18, v[14:15]
    v_mad_u64_u32 v[18:19], vcc, v20, s18, v[18:19]
    ds_add_rtn_u64 v[24:25], v22, v[14:15] offset:7392
    ds_add_rtn_u64 v[58:59], v22, v[18:19] offset:57400
    v_pk_mul_f32 v[8:9], v[22:23], s[16:17] op_sel:[1,0] op_sel_hi:[1,1]
    v_and_b32 v22, 0xfff8, v57
    v_fma_f32 v9, v8, v9, v5
    s_waitcnt vmcnt(7)
    v_lshlrev_b32 v10, 16, v26
    v_and_b32 v11, 0xffff0000, v26
    v_lshlrev_b32 v12, 16, v27
    v_and_b32 v13, 0xffff0000, v27
    v_pk_fma_f32 v[14:15], v[8:9], v[10:11], s[12:13] op_sel_hi:[1,0,1]
    v_pk_fma_f32 v[16:17], v[8:9], v[10:11], s[14:15] op_sel:[0,1,0]
    v_pk_fma_f32 v[18:19], v[8:9], v[12:13], s[12:13] op_sel_hi:[1,0,1]
    v_pk_fma_f32 v[20:21], v[8:9], v[12:13], s[14:15] op_sel:[0,1,0]
    v_lshl_add_u32 v15, v17, 16, v15
    v_lshl_add_u32 v19, v21, 16, v19
    v_mad_u64_u32 v[14:15], vcc, v16, s18, v[14:15]
    v_mad_u64_u32 v[18:19], vcc, v20, s18, v[18:19]
    ds_add_rtn_u64 v[26:27], v22, v[14:15] offset:7392
    ds_add_rtn_u64 v[56:57], v22, v[18:19] offset:57400
    s_waitcnt lgkmcnt(3)
    v_or3_b32 v7, v7, v24, v25
    s_waitcnt lgkmcnt(2)
    v_or3_b32 v7, v7, v58, v59
    s_waitcnt lgkmcnt(1)
    v_or3_b32 v7, v7, v26, v27
    s_waitcnt lgkmcnt(0)
    v_or3_b32 v7, v7, v56, v57
    s_sub_u32 s100, s26, 12288
    v_lshlrev_b32 v70, 10, v70
    v_sub_u32 v24, v68, v70
    v_sub_u32 v26, v69, v70
    v_and_b32 v24, 0xff8, v24
    v_and_b32 v26, 0xff8, v26
    v_add_u32 v24, v24, v70
    v_add_u32 v26, v26, v70
    v_cmpx_gt_i32 vcc, s100, v0
    buffer_load_dwordx2 v[24:25], v24, s[8:11], 0 offen
    buffer_load_dwordx2 v[26:27], v26, s[8:11], 0 offen
    s_mov_b64 exec, -1
    buffer_load_dwordx3 v[56:58], v115, s[4:7], 0 offen sc1
    s_waitcnt lgkmcnt(0)
    s_cmp_lg_u32 s24, 10
    s_cbranch_scc1 .Lsc2
    v_and_b32 v22, 0xff, v1
    v_lshlrev_b32 v22, 2, v22
    s_bfm_b64 exec, 50, 0
    ds_read_b128 v[8:11], v22 offset:0
    ds_read_b128 v[12:15], v22 offset:1024
    ds_read_b128 v[16:19], v22 offset:2048
    ds_read_b128 v[36:39], v22 offset:3072
    s_waitcnt lgkmcnt(2)
    v_add_u32_sdwa v12, v12, v8 dst_sel:DWORD dst_unused:UNUSED_PAD src0_sel:WORD_0 src1_sel:WORD_0
    s_waitcnt lgkmcnt(1)
    v_add_u32_sdwa v16, v16, v12 dst_sel:DWORD dst_unused:UNUSED_PAD src0_sel:WORD_0 src1_sel:DWORD
    s_waitcnt lgkmcnt(0)
    v_add_u32_sdwa v36, v36, v16 dst_sel:DWORD dst_unused:UNUSED_PAD src0_sel:WORD_0 src1_sel:DWORD
    v_add_u32_sdwa v9, v9, v36 dst_sel:DWORD dst_unused:UNUSED_PAD src0_sel:WORD_0 src1_sel:DWORD
    v_add_u32_sdwa v13, v13, v9 dst_sel:DWORD dst_unused:UNUSED_PAD src0_sel:WORD_0 src1_sel:DWORD
    v_add_u32_sdwa v17, v17, v13 dst_sel:DWORD dst_unused:UNUSED_PAD src0_sel:WORD_0 src1_sel:DWORD
    v_add_u32_sdwa v37, v37, v17 dst_sel:DWORD dst_unused:UNUSED_PAD src0_sel:WORD_0 src1_sel:DWORD
    v_add_u32_sdwa v10, v10, v37 dst_sel:DWORD dst_unused:UNUSED_PAD src0_sel:WORD_0 src1_sel:DWORD
    v_add_u32_sdwa v14, v14, v10 dst_sel:DWORD dst_unused:UNUSED_PAD src0_sel:WORD_0 src1_sel:DWORD
    v_add_u32_sdwa v18, v18, v14 dst_sel:DWORD dst_unused:UNUSED_PAD src0_sel:WORD_0 src1_sel:DWORD
    v_add_u32_sdwa v38, v38, v18 dst_sel:DWORD dst_unused:UNUSED_PAD src0_sel:WORD_0 src1_sel:DWORD
    v_add_u32_sdwa v11, v11, v38 dst_sel:DWORD dst_unused:UNUSED_PAD src0_sel:WORD_0 src1_sel:DWORD
    v_add_u32_sdwa v15, v15, v11 dst_sel:DWORD dst_unused:UNUSED_PAD src0_sel:WORD_0 src1_sel:DWORD
    v_add_u32_sdwa v19, v19, v15 dst_sel:DWORD dst_unused:UNUSED_PAD src0_sel:WORD_0 src1_sel:DWORD
    v_add_u32_sdwa v39, v39, v19 dst_sel:DWORD dst_unused:UNUSED_PAD src0_sel:WORD_0 src1_sel:DWORD
    v_mov_b32 v23, v39
    s_nop 1
    v_add_u32_dpp v23, v23, v23 row_shr:1 row_mask:0xf bank_mask:0xf
    s_nop 1
    v_add_u32_dpp v23, v23, v23 row_shr:2 row_mask:0xf bank_mask:0xf
    s_nop 1
    v_add_u32_dpp v23, v23, v23 row_shr:4 row_mask:0xf bank_mask:0xf
    s_nop 1
    v_add_u32_dpp v23, v23, v23 row_shr:8 row_mask:0xf bank_mask:0xf
    s_nop 1
    v_add_u32_dpp v23, v23, v23 row_bcast:15 row_mask:0xa bank_mask:0xf
    s_nop 1
    v_add_u32_dpp v23, v23, v23 row_bcast:31 row_mask:0xc bank_mask:0xf
    v_sub_u32 v23, v23, v39
    v_add_u32 v23, 2, v23
    v_add_u32_sdwa v39, v23, v19 dst_sel:DWORD dst_unused:UNUSED_PAD src0_sel:DWORD src1_sel:DWORD
    v_add_u32_sdwa v19, v23, v15 dst_sel:DWORD dst_unused:UNUSED_PAD src0_sel:DWORD src1_sel:DWORD
    v_add_u32_sdwa v15, v23, v11 dst_sel:DWORD dst_unused:UNUSED_PAD src0_sel:DWORD src1_sel:DWORD
    v_add_u32_sdwa v11, v23, v38 dst_sel:DWORD dst_unused:UNUSED_PAD src0_sel:DWORD src1_sel:DWORD
    v_add_u32_sdwa v38, v23, v18 dst_sel:DWORD dst_unused:UNUSED_PAD src0_sel:DWORD src1_sel:DWORD
    v_add_u32_sdwa v18, v23, v14 dst_sel:DWORD dst_unused:UNUSED_PAD src0_sel:DWORD src1_sel:DWORD
    v_add_u32_sdwa v14, v23, v10 dst_sel:DWORD dst_unused:UNUSED_PAD src0_sel:DWORD src1_sel:DWORD
    v_add_u32_sdwa v10, v23, v37 dst_sel:DWORD dst_unused:UNUSED_PAD src0_sel:DWORD src1_sel:DWORD
    v_add_u32_sdwa v37, v23, v17 dst_sel:DWORD dst_unused:UNUSED_PAD src0_sel:DWORD src1_sel:DWORD
    v_add_u32_sdwa v17, v23, v13 dst_sel:DWORD dst_unused:UNUSED_PAD src0_sel:DWORD src1_sel:DWORD
    v_add_u32_sdwa v13, v23, v9 dst_sel:DWORD dst_unused:UNUSED_PAD src0_sel:DWORD src1_sel:DWORD
    v_add_u32_sdwa v9, v23, v36 dst_sel:DWORD dst_unused:UNUSED_PAD src0_sel:DWORD src1_sel:DWORD
    v_add_u32_sdwa v36, v23, v16 dst_sel:DWORD dst_unused:UNUSED_PAD src0_sel:DWORD src1_sel:DWORD
    v_add_u32_sdwa v16, v23, v12 dst_sel:DWORD dst_unused:UNUSED_PAD src0_sel:DWORD src1_sel:DWORD
    v_add_u32_sdwa v12, v23, v8 dst_sel:DWORD dst_unused:UNUSED_PAD src0_sel:DWORD src1_sel:WORD_0
    v_lshlrev_b32 v8, 0, v23
    s_nop 0
    ds_write_b128 v22, v[8:11] offset:0
    ds_write_b128 v22, v[12:15] offset:1024
    ds_write_b128 v22, v[16:19] offset:2048
    ds_write_b128 v22, v[36:39] offset:3072
    s_mov_b64 exec, -1
    s_waitcnt lgkmcnt(0)
.Lsc2:
    v_alignbit_b32 v60, v60, v60, 9
    v_alignbit_b32 v61, v61, v61, 9
    v_and_b32 v8, 0x3ff0000, v60
    v_and_b32 v9, 0x3ff0000, v61
    v_pk_mul_f32 v[8:9], v[8:9], s[20:21] op_sel_hi:[1,0]
    v_cos_f32 v8, v8
    v_cos_f32 v23, v9
    s_nop 0
    v_pk_mul_f32 v[8:9], v[8:9], s[16:17] op_sel_hi:[0,1]
    v_and_b32 v22, 0xfff8, v60
    v_fma_f32 v9, v8, v9, v5
    s_waitcnt vmcnt(8)
    v_lshlrev_b32 v10, 16, v28
    v_and_b32 v11, 0xffff0000, v28
    v_lshlrev_b32 v12, 16, v29
    v_and_b32 v13, 0xffff0000, v29
    v_pk_fma_f32 v[14:15], v[8:9], v[10:11], s[12:13] op_sel_hi:[1,0,1]
    v_pk_fma_f32 v[16:17], v[8:9], v[10:11], s[14:15] op_sel:[0,1,0]
    v_pk_fma_f32 v[18:19], v[8:9], v[12:13], s[12:13] op_sel_hi:[1,0,1]
    v_pk_fma_f32 v[20:21], v[8:9], v[12:13], s[14:15] op_sel:[0,1,0]
    v_lshl_add_u32 v15, v17, 16, v15
    v_lshl_add_u32 v19, v21, 16, v19
    v_mad_u64_u32 v[14:15], vcc, v16, s18, v[14:15]
    v_mad_u64_u32 v[18:19], vcc, v20, s18, v[18:19]
    ds_add_rtn_u64 v[28:29], v22, v[14:15] offset:7392
    ds_add_rtn_u64 v[62:63], v22, v[18:19] offset:57400
    v_pk_mul_f32 v[8:9], v[22:23], s[16:17] op_sel:[1,0] op_sel_hi:[1,1]
    v_and_b32 v22, 0xfff8, v61
    v_fma_f32 v9, v8, v9, v5
    s_waitcnt vmcnt(7)
    v_lshlrev_b32 v10, 16, v30
    v_and_b32 v11, 0xffff0000, v30
    v_lshlrev_b32 v12, 16, v31
    v_and_b32 v13, 0xffff0000, v31
    v_pk_fma_f32 v[14:15], v[8:9], v[10:11], s[12:13] op_sel_hi:[1,0,1]
    v_pk_fma_f32 v[16:17], v[8:9], v[10:11], s[14:15] op_sel:[0,1,0]
    v_pk_fma_f32 v[18:19], v[8:9], v[12:13], s[12:13] op_sel_hi:[1,0,1]
    v_pk_fma_f32 v[20:21], v[8:9], v[12:13], s[14:15] op_sel:[0,1,0]
    v_lshl_add_u32 v15, v17, 16, v15
    v_lshl_add_u32 v19, v21, 16, v19
    v_mad_u64_u32 v[14:15], vcc, v16, s18, v[14:15]
    v_mad_u64_u32 v[18:19], vcc, v20, s18, v[18:19]
    ds_add_rtn_u64 v[30:31], v22, v[14:15] offset:7392
    ds_add_rtn_u64 v[60:61], v22, v[18:19] offset:57400
    s_waitcnt lgkmcnt(3)
    v_or3_b32 v7, v7, v28, v29
    s_waitcnt lgkmcnt(2)
    v_or3_b32 v7, v7, v62, v63
    s_waitcnt lgkmcnt(1)
    v_or3_b32 v7, v7, v30, v31
    s_waitcnt lgkmcnt(0)
    v_or3_b32 v7, v7, v60, v61
    s_add_u32 s8, s8, 800000
    s_addc_u32 s9, s9, 0
    s_sub_u32 s10, s10, 800000
    v_lshlrev_b32 v74, 10, v74
    v_sub_u32 v28, v72, v74
    v_sub_u32 v30, v73, v74
    v_and_b32 v28, 0xff8, v28
    v_and_b32 v30, 0xff8, v30
    v_add_u32 v28, v28, v74
    v_add_u32 v30, v30, v74
    buffer_load_dwordx2 v[28:29], v28, s[8:11], 0 offen
    buffer_load_dwordx2 v[30:31], v30, s[8:11], 0 offen
    buffer_load_dwordx3 v[60:62], v119, s[4:7], 0 offen sc1
    s_waitcnt lgkmcnt(0)
    s_barrier
    v_lshrrev_b32 v40, 2, v1
    v_and_b32 v41, 3, v40
    v_and_b32 v36, -4, v40
    v_lshl_or_b32 v36, v41, 10, v36
    v_add_u32 v38, 1, v40
    v_and_b32 v41, 3, v38
    v_and_b32 v38, -4, v38
    v_lshl_or_b32 v38, v41, 10, v38
    ds_read_b32 v39, v3 offset:3866
    ds_read_b32 v37, v36 offset:4
    ds_read_b32 v36, v36 offset:0
    ds_read_b32 v38, v38 offset:0
    v_alignbit_b32 v64, v64, v64, 9
    v_alignbit_b32 v65, v65, v65, 9
    v_and_b32 v8, 0x3ff0000, v64
    v_and_b32 v9, 0x3ff0000, v65
    v_pk_mul_f32 v[8:9], v[8:9], s[20:21] op_sel_hi:[1,0]
    v_cos_f32 v8, v8
    v_cos_f32 v23, v9
    s_nop 0
    v_pk_mul_f32 v[8:9], v[8:9], s[16:17] op_sel_hi:[0,1]
    v_and_b32 v22, 0xfff8, v64
    v_fma_f32 v9, v8, v9, v5
    s_waitcnt vmcnt(8)
    v_lshlrev_b32 v10, 16, v32
    v_and_b32 v11, 0xffff0000, v32
    v_lshlrev_b32 v12, 16, v33
    v_and_b32 v13, 0xffff0000, v33
    v_pk_fma_f32 v[14:15], v[8:9], v[10:11], s[12:13] op_sel_hi:[1,0,1]
    v_pk_fma_f32 v[16:17], v[8:9], v[10:11], s[14:15] op_sel:[0,1,0]
    v_pk_fma_f32 v[18:19], v[8:9], v[12:13], s[12:13] op_sel_hi:[1,0,1]
    v_pk_fma_f32 v[20:21], v[8:9], v[12:13], s[14:15] op_sel:[0,1,0]
    v_lshl_add_u32 v15, v17, 16, v15
    v_lshl_add_u32 v19, v21, 16, v19
    v_mad_u64_u32 v[14:15], vcc, v16, s18, v[14:15]
    v_mad_u64_u32 v[18:19], vcc, v20, s18, v[18:19]
    ds_add_rtn_u64 v[32:33], v22, v[14:15] offset:7392
    ds_add_rtn_u64 v[66:67], v22, v[18:19] offset:57400
    v_pk_mul_f32 v[8:9], v[22:23], s[16:17] op_sel:[1,0] op_sel_hi:[1,1]
    v_and_b32 v22, 0xfff8, v65
    v_fma_f32 v9, v8, v9, v5
    s_waitcnt vmcnt(7)
    v_lshlrev_b32 v10, 16, v34
    v_and_b32 v11, 0xffff0000, v34
    v_lshlrev_b32 v12, 16, v35
    v_and_b32 v13, 0xffff0000, v35
    v_pk_fma_f32 v[14:15], v[8:9], v[10:11], s[12:13] op_sel_hi:[1,0,1]
    v_pk_fma_f32 v[16:17], v[8:9], v[10:11], s[14:15] op_sel:[0,1,0]
    v_pk_fma_f32 v[18:19], v[8:9], v[12:13], s[12:13] op_sel_hi:[1,0,1]
    v_pk_fma_f32 v[20:21], v[8:9], v[12:13], s[14:15] op_sel:[0,1,0]
    v_lshl_add_u32 v15, v17, 16, v15
    v_lshl_add_u32 v19, v21, 16, v19
    v_mad_u64_u32 v[14:15], vcc, v16, s18, v[14:15]
    v_mad_u64_u32 v[18:19], vcc, v20, s18, v[18:19]
    ds_add_rtn_u64 v[34:35], v22, v[14:15] offset:7392
    ds_add_rtn_u64 v[64:65], v22, v[18:19] offset:57400
    s_waitcnt lgkmcnt(3)
    v_or3_b32 v7, v7, v32, v33
    s_waitcnt lgkmcnt(2)
    v_or3_b32 v7, v7, v66, v67
    s_waitcnt lgkmcnt(1)
    v_or3_b32 v7, v7, v34, v35
    s_waitcnt lgkmcnt(0)
    v_or3_b32 v7, v7, v64, v65
    v_lshlrev_b32 v78, 10, v78
    v_sub_u32 v32, v76, v78
    v_sub_u32 v34, v77, v78
    v_and_b32 v32, 0xff8, v32
    v_and_b32 v34, 0xff8, v34
    v_add_u32 v32, v32, v78
    v_add_u32 v34, v34, v78
    buffer_load_dwordx2 v[32:33], v32, s[8:11], 0 offen
    buffer_load_dwordx2 v[34:35], v34, s[8:11], 0 offen
    buffer_load_dwordx3 v[64:66], v123, s[4:7], 0 offen sc1
    v_and_b32 v39, 0xffff, v39
    s_nop 0
    v_readfirstlane_b32 s28, v39
    v_lshl_add_u32 v41, v39, 1, s19
    v_mov_b32 v43, 0
    s_cmp_gt_u32 s28, 28160
    s_cbranch_scc1 .Lslow0
    s_mov_b64 exec, 1
    ds_write_b32 v41, v43
    v_mov_b32 v41, s19
    ds_write_b32 v41, v43
    s_mov_b64 exec, -1
    s_lshr_b32 s28, s28, 1
    s_cmp_lt_u32 s28, 12288
    s_cbranch_scc1 .Lfl2
.Lflx2:
    v_and_b32 v37, 0xffff, v37
    v_and_b32 v36, 0xffff, v36
    v_and_b32 v38, 0xffff, v38
    v_cmp_ne_u32 vcc, 0, v40
    s_nop 1
    v_cndmask_b32 v36, 0, v36, vcc
    v_add_u32 v36, 15, v36
    v_sub_u32 v41, v37, v38
    v_and_b32 v36, -16, v36
    v_cmpx_gt_u32 vcc, 796, v40
    v_cmpx_lt_u32 vcc, v36, v38
    v_cmp_ne_u32 vcc, v37, v39
    s_nop 1
    v_cndmask_b32 v41, 14, v41, vcc
    v_subrev_u32 v41, 14, v41
    v_and_b32 v41, 0x80000000, v41
    v_or_b32 v7, v7, v41
.Lbd2:
    v_lshrrev_b32 v41, 3, v36
    v_add_u32 v36, 16, v36
    ds_write_b16 v41, v40 offset:3872
    v_cmpx_lt_u32 vcc, v36, v38
    s_nop 1
    s_cbranch_execnz .Lbd2
    s_mov_b64 exec, -1
    v_perm_b32 v22, v44, v46, v4
    v_cndmask_b32_e64 v44, v44, v46, s[84:85]
    v_pk_mad_u16 v22, v22, 4, -16 op_sel_hi:[1,0,0]
    v_perm_b32 v23, v44, v45, s101
    v_and_or_b32 v46, v23, s3, v22
    v_bfe_i32 v23, v46, 0, 16
    v_ashrrev_i32 v22, 16, v46
    ds_add_u32 v23, v6
    ds_add_u32 v22, v6
    v_perm_b32 v22, v48, v50, v4
    v_cndmask_b32_e64 v48, v48, v50, s[84:85]
    v_pk_mad_u16 v22, v22, 4, -16 op_sel_hi:[1,0,0]
    v_perm_b32 v23, v48, v49, s101
    v_and_or_b32 v50, v23, s3, v22
    v_bfe_i32 v23, v50, 0, 16
    v_ashrrev_i32 v22, 16, v50
    ds_add_u32 v23, v6
    ds_add_u32 v22, v6
    s_waitcnt vmcnt(9)
    v_perm_b32 v22, v52, v54, v4
    v_cndmask_b32_e64 v52, v52, v54, s[84:85]
    v_pk_mad_u16 v22, v22, 4, -16 op_sel_hi:[1,0,0]
    v_perm_b32 v23, v52, v53, s101
    v_and_or_b32 v54, v23, s3, v22
    v_bfe_i32 v23, v54, 0, 16
    v_ashrrev_i32 v22, 16, v54
    ds_add_u32 v23, v6
    ds_add_u32 v22, v6
    s_sub_u32 s100, s26, 12288
    v_cmpx_gt_i32 vcc, s100, v0
    s_waitcnt vmcnt(7)
    v_and_b32 v22, v69, v27
    s_cbranch_execz .Lk0a
    v_alignbit_b32 v68, v68, v68, 9
    v_alignbit_b32 v69, v69, v69, 9
    v_and_b32 v8, 0x3ff0000, v68
    v_and_b32 v9, 0x3ff0000, v69
    v_pk_mul_f32 v[8:9], v[8:9], s[20:21] op_sel_hi:[1,0]
    v_cos_f32 v8, v8
    v_cos_f32 v23, v9
    v_pk_mul_f32 v[8:9], v[8:9], s[16:17] op_sel_hi:[0,1]
    v_and_b32 v22, 0xfff8, v68
    v_fma_f32 v9, v8, v9, v5
    v_lshlrev_b32 v10, 16, v24
    v_and_b32 v11, 0xffff0000, v24
    v_lshlrev_b32 v12, 16, v25
    v_and_b32 v13, 0xffff0000, v25
    v_pk_fma_f32 v[14:15], v[8:9], v[10:11], s[12:13] op_sel_hi:[1,0,1]
    v_pk_fma_f32 v[16:17], v[8:9], v[10:11], s[14:15] op_sel:[0,1,0]
    v_pk_fma_f32 v[18:19], v[8:9], v[12:13], s[12:13] op_sel_hi:[1,0,1]
    v_pk_fma_f32 v[20:21], v[8:9], v[12:13], s[14:15] op_sel:[0,1,0]
    v_lshl_add_u32 v15, v17, 16, v15
    v_lshl_add_u32 v19, v21, 16, v19
    v_mad_u64_u32 v[14:15], vcc, v16, s18, v[14:15]
    v_mad_u64_u32 v[18:19], vcc, v20, s18, v[18:19]
.Lk0a:
    ds_add_rtn_u64 v[24:25], v22, v[14:15] offset:7392
    ds_add_rtn_u64 v[70:71], v22, v[18:19] offset:57400
    s_cbranch_execz .Lk0b
    v_pk_mul_f32 v[8:9], v[22:23], s[16:17] op_sel:[1,0] op_sel_hi:[1,1]
    v_and_b32 v22, 0xfff8, v69
    v_fma_f32 v9, v8, v9, v5
    v_lshlrev_b32 v10, 16, v26
    v_and_b32 v11, 0xffff0000, v26
    v_lshlrev_b32 v12, 16, v27
    v_and_b32 v13, 0xffff0000, v27
    v_pk_fma_f32 v[14:15], v[8:9], v[10:11], s[12:13] op_sel_hi:[1,0,1]
    v_pk_fma_f32 v[16:17], v[8:9], v[10:11], s[14:15] op_sel:[0,1,0]
    v_pk_fma_f32 v[18:19], v[8:9], v[12:13], s[12:13] op_sel_hi:[1,0,1]
    v_pk_fma_f32 v[20:21], v[8:9], v[12:13], s[14:15] op_sel:[0,1,0]
    v_lshl_add_u32 v15, v17, 16, v15
    v_lshl_add_u32 v19, v21, 16, v19
    v_mad_u64_u32 v[14:15], vcc, v16, s18, v[14:15]
    v_mad_u64_u32 v[18:19], vcc, v20, s18, v[18:19]
.Lk0b:
    ds_add_rtn_u64 v[26:27], v22, v[14:15] offset:7392
    ds_add_rtn_u64 v[68:69], v22, v[18:19] offset:57400
    s_mov_b64 exec, -1
    s_sub_u32 s100, s26, 12288
    v_cmpx_gt_i32 vcc, s100, v0
    s_waitcnt lgkmcnt(3)
    v_or3_b32 v7, v7, v24, v25
    s_waitcnt lgkmcnt(2)
    v_or3_b32 v7, v7, v70, v71
    s_waitcnt lgkmcnt(1)
    v_or3_b32 v7, v7, v26, v27
    s_waitcnt lgkmcnt(0)
    v_or3_b32 v7, v7, v68, v69
    s_mov_b64 exec, -1
    v_lshlrev_b32 v82, 10, v82
    v_sub_u32 v24, v80, v82
    v_sub_u32 v26, v81, v82
    v_and_b32 v24, 0xff8, v24
    v_and_b32 v26, 0xff8, v26
    v_add_u32 v24, v24, v82
    v_add_u32 v26, v26, v82
    buffer_load_dwordx2 v[24:25], v24, s[8:11], 0 offen
    buffer_load_dwordx2 v[26:27], v26, s[8:11], 0 offen
    buffer_load_dwordx3 v[68:70], v127, s[4:7], 0 offen sc1
    s_waitcnt lgkmcnt(0)
    s_barrier
    v_bfe_i32 v36, v102, 0, 16
    v_ashrrev_i32 v37, 16, v102
    ds_add_rtn_u32 v36, v36, v3
    ds_add_rtn_u32 v37, v37, v3
    v_bfe_i32 v38, v106, 0, 16
    v_ashrrev_i32 v39, 16, v106
    ds_add_rtn_u32 v38, v38, v3
    ds_add_rtn_u32 v39, v39, v3
    v_alignbit_b32 v72, v72, v72, 9
    v_alignbit_b32 v73, v73, v73, 9
    v_and_b32 v8, 0x3ff0000, v72
    v_and_b32 v9, 0x3ff0000, v73
    v_pk_mul_f32 v[8:9], v[8:9], s[20:21] op_sel_hi:[1,0]
    v_cos_f32 v8, v8
    v_cos_f32 v23, v9
    s_nop 0
    v_pk_mul_f32 v[8:9], v[8:9], s[16:17] op_sel_hi:[0,1]
    v_and_b32 v22, 0xfff8, v72
    v_fma_f32 v9, v8, v9, v5
    s_waitcnt vmcnt(8)
    v_lshlrev_b32 v10, 16, v28
    v_and_b32 v11, 0xffff0000, v28
    v_lshlrev_b32 v12, 16, v29
    v_and_b32 v13, 0xffff0000, v29
    v_pk_fma_f32 v[14:15], v[8:9], v[10:11], s[12:13] op_sel_hi:[1,0,1]
    v_pk_fma_f32 v[16:17], v[8:9], v[10:11], s[14:15] op_sel:[0,1,0]
    v_pk_fma_f32 v[18:19], v[8:9], v[12:13], s[12:13] op_sel_hi:[1,0,1]
    v_pk_fma_f32 v[20:21], v[8:9], v[12:13], s[14:15] op_sel:[0,1,0]
    v_lshl_add_u32 v15, v17, 16, v15
    v_lshl_add_u32 v19, v21, 16, v19
    v_mad_u64_u32 v[14:15], vcc, v16, s18, v[14:15]
    v_mad_u64_u32 v[18:19], vcc, v20, s18, v[18:19]
    ds_add_rtn_u64 v[28:29], v22, v[14:15] offset:7392
    ds_add_rtn_u64 v[74:75], v22, v[18:19] offset:57400
    v_pk_mul_f32 v[8:9], v[22:23], s[16:17] op_sel:[1,0] op_sel_hi:[1,1]
    v_and_b32 v22, 0xfff8, v73
    v_fma_f32 v9, v8, v9, v5
    s_waitcnt vmcnt(7)
    v_lshlrev_b32 v10, 16, v30
    v_and_b32 v11, 0xffff0000, v30
    v_lshlrev_b32 v12, 16, v31
    v_and_b32 v13, 0xffff0000, v31
    v_pk_fma_f32 v[14:15], v[8:9], v[10:11], s[12:13] op_sel_hi:[1,0,1]
    v_pk_fma_f32 v[16:17], v[8:9], v[10:11], s[14:15] op_sel:[0,1,0]
    v_pk_fma_f32 v[18:19], v[8:9], v[12:13], s[12:13] op_sel_hi:[1,0,1]
    v_pk_fma_f32 v[20:21], v[8:9], v[12:13], s[14:15] op_sel:[0,1,0]
    v_lshl_add_u32 v15, v17, 16, v15
    v_lshl_add_u32 v19, v21, 16, v19
    v_mad_u64_u32 v[14:15], vcc, v16, s18, v[14:15]
    v_mad_u64_u32 v[18:19], vcc, v20, s18, v[18:19]
    ds_add_rtn_u64 v[30:31], v22, v[14:15] offset:7392
    ds_add_rtn_u64 v[72:73], v22, v[18:19] offset:57400
    s_waitcnt lgkmcnt(3)
    v_or3_b32 v7, v7, v28, v29
    s_waitcnt lgkmcnt(2)
    v_or3_b32 v7, v7, v74, v75
    s_waitcnt lgkmcnt(1)
    v_or3_b32 v7, v7, v30, v31
    s_waitcnt lgkmcnt(0)
    v_or3_b32 v7, v7, v72, v73
    v_lshlrev_b32 v86, 10, v86
    v_sub_u32 v28, v84, v86
    v_sub_u32 v30, v85, v86
    v_and_b32 v28, 0xff8, v28
    v_and_b32 v30, 0xff8, v30
    v_add_u32 v28, v28, v86
    v_add_u32 v30, v30, v86
    buffer_load_dwordx2 v[28:29], v28, s[8:11], 0 offen
    buffer_load_dwordx2 v[30:31], v30, s[8:11], 0 offen
    v_mad_u32_u16 v36, v36, 2, s19 op_sel:[0,0,0,0]
    v_mad_u32_u16 v37, v37, 2, s19 op_sel:[0,0,0,0]
    ds_write_b32 v36, v101
    ds_write_b32 v37, v100
    v_bfe_i32 v40, v110, 0, 16
    v_ashrrev_i32 v41, 16, v110
    ds_add_rtn_u32 v40, v40, v3
    ds_add_rtn_u32 v41, v41, v3
    v_mad_u32_u16 v38, v38, 2, s19 op_sel:[0,0,0,0]
    v_mad_u32_u16 v39, v39, 2, s19 op_sel:[0,0,0,0]
    ds_write_b32 v38, v105
    ds_write_b32 v39, v104
    v_bfe_i32 v36, v114, 0, 16
    v_ashrrev_i32 v37, 16, v114
    ds_add_rtn_u32 v36, v36, v3
    ds_add_rtn_u32 v37, v37, v3
    v_perm_b32 v22, v56, v58, v4
    v_cndmask_b32_e64 v56, v56, v58, s[84:85]
    v_pk_mad_u16 v22, v22, 4, -16 op_sel_hi:[1,0,0]
    v_perm_b32 v23, v56, v57, s101
    v_and_or_b32 v58, v23, s3, v22
    v_bfe_i32 v23, v58, 0, 16
    v_ashrrev_i32 v22, 16, v58
    ds_add_u32 v23, v6
    ds_add_u32 v22, v6
    s_waitcnt lgkmcnt(7)
    v_mad_u32_u16 v40, v40, 2, s19 op_sel:[0,0,0,0]
    s_waitcnt lgkmcnt(6)
    v_mad_u32_u16 v41, v41, 2, s19 op_sel:[0,0,0,0]
    ds_write_b32 v40, v109
    ds_write_b32 v41, v108
    v_bfe_i32 v38, v118, 0, 16
    v_ashrrev_i32 v39, 16, v118
    ds_add_rtn_u32 v38, v38, v3
    ds_add_rtn_u32 v39, v39, v3
    v_alignbit_b32 v76, v76, v76, 9
    v_alignbit_b32 v77, v77, v77, 9
    v_and_b32 v8, 0x3ff0000, v76
    v_and_b32 v9, 0x3ff0000, v77
    v_pk_mul_f32 v[8:9], v[8:9], s[20:21] op_sel_hi:[1,0]
    v_cos_f32 v8, v8
    v_cos_f32 v23, v9
    s_nop 0
    v_pk_mul_f32 v[8:9], v[8:9], s[16:17] op_sel_hi:[0,1]
    v_and_b32 v22, 0xfff8, v76
    v_fma_f32 v9, v8, v9, v5
    s_waitcnt vmcnt(7)
    v_lshlrev_b32 v10, 16, v32
    v_and_b32 v11, 0xffff0000, v32
    v_lshlrev_b32 v12, 16, v33
    v_and_b32 v13, 0xffff0000, v33
    v_pk_fma_f32 v[14:15], v[8:9], v[10:11], s[12:13] op_sel_hi:[1,0,1]
    v_pk_fma_f32 v[16:17], v[8:9], v[10:11], s[14:15] op_sel:[0,1,0]
    v_pk_fma_f32 v[18:19], v[8:9], v[12:13], s[12:13] op_sel_hi:[1,0,1]
    v_pk_fma_f32 v[20:21], v[8:9], v[12:13], s[14:15] op_sel:[0,1,0]
    v_lshl_add_u32 v15, v17, 16, v15
    v_lshl_add_u32 v19, v21, 16, v19
    v_mad_u64_u32 v[14:15], vcc, v16, s18, v[14:15]
    v_mad_u64_u32 v[18:19], vcc, v20, s18, v[18:19]
    ds_add_rtn_u64 v[32:33], v22, v[14:15] offset:7392
    ds_add_rtn_u64 v[78:79], v22, v[18:19] offset:57400
    v_pk_mul_f32 v[8:9], v[22:23], s[16:17] op_sel:[1,0] op_sel_hi:[1,1]
    v_and_b32 v22, 0xfff8, v77
    v_fma_f32 v9, v8, v9, v5
    s_waitcnt vmcnt(6)
    v_lshlrev_b32 v10, 16, v34
    v_and_b32 v11, 0xffff0000, v34
    v_lshlrev_b32 v12, 16, v35
    v_and_b32 v13, 0xffff0000, v35
    v_pk_fma_f32 v[14:15], v[8:9], v[10:11], s[12:13] op_sel_hi:[1,0,1]
    v_pk_fma_f32 v[16:17], v[8:9], v[10:11], s[14:15] op_sel:[0,1,0]
    v_pk_fma_f32 v[18:19], v[8:9], v[12:13], s[12:13] op_sel_hi:[1,0,1]
    v_pk_fma_f32 v[20:21], v[8:9], v[12:13], s[14:15] op_sel:[0,1,0]
    v_lshl_add_u32 v15, v17, 16, v15
    v_lshl_add_u32 v19, v21, 16, v19
    v_mad_u64_u32 v[14:15], vcc, v16, s18, v[14:15]
    v_mad_u64_u32 v[18:19], vcc, v20, s18, v[18:19]
    ds_add_rtn_u64 v[34:35], v22, v[14:15] offset:7392
    ds_add_rtn_u64 v[76:77], v22, v[18:19] offset:57400
    s_waitcnt lgkmcnt(3)
    v_or3_b32 v7, v7, v32, v33
    s_waitcnt lgkmcnt(2)
    v_or3_b32 v7, v7, v78, v79
    s_waitcnt lgkmcnt(1)
    v_or3_b32 v7, v7, v34, v35
    s_waitcnt lgkmcnt(0)
    v_or3_b32 v7, v7, v76, v77
    v_lshlrev_b32 v90, 10, v90
    v_sub_u32 v32, v88, v90
    v_sub_u32 v34, v89, v90
    v_and_b32 v32, 0xff8, v32
    v_and_b32 v34, 0xff8, v34
    v_add_u32 v32, v32, v90
    v_add_u32 v34, v34, v90
    buffer_load_dwordx2 v[32:33], v32, s[8:11], 0 offen
    buffer_load_dwordx2 v[34:35], v34, s[8:11], 0 offen
    v_perm_b32 v22, v60, v62, v4
    v_cndmask_b32_e64 v60, v60, v62, s[84:85]
    v_pk_mad_u16 v22, v22, 4, -16 op_sel_hi:[1,0,0]
    v_perm_b32 v23, v60, v61, s101
    v_and_or_b32 v62, v23, s3, v22
    v_bfe_i32 v23, v62, 0, 16
    v_ashrrev_i32 v22, 16, v62
    ds_add_u32 v23, v6
    ds_add_u32 v22, v6
    v_mad_u32_u16 v36, v36, 2, s19 op_sel:[0,0,0,0]
    v_mad_u32_u16 v37, v37, 2, s19 op_sel:[0,0,0,0]
    ds_write_b32 v36, v113
    ds_write_b32 v37, v112
    v_bfe_i32 v40, v122, 0, 16
    v_ashrrev_i32 v41, 16, v122
    ds_add_rtn_u32 v40, v40, v3
    ds_add_rtn_u32 v41, v41, v3
    v_mad_u32_u16 v38, v38, 2, s19 op_sel:[0,0,0,0]
    v_mad_u32_u16 v39, v39, 2, s19 op_sel:[0,0,0,0]
    ds_write_b32 v38, v117
    ds_write_b32 v39, v116
    v_bfe_i32 v36, v126, 0, 16
    v_ashrrev_i32 v37, 16, v126
    ds_add_rtn_u32 v36, v36, v3
    ds_add_rtn_u32 v37, v37, v3
    v_alignbit_b32 v80, v80, v80, 9
    v_alignbit_b32 v81, v81, v81, 9
    v_and_b32 v8, 0x3ff0000, v80
    v_and_b32 v9, 0x3ff0000, v81
    v_pk_mul_f32 v[8:9], v[8:9], s[20:21] op_sel_hi:[1,0]
    v_cos_f32 v8, v8
    v_cos_f32 v23, v9
    s_nop 0
    v_pk_mul_f32 v[8:9], v[8:9], s[16:17] op_sel_hi:[0,1]
    v_and_b32 v22, 0xfff8, v80
    v_fma_f32 v9, v8, v9, v5
    s_waitcnt vmcnt(6)
    v_lshlrev_b32 v10, 16, v24
    v_and_b32 v11, 0xffff0000, v24
    v_lshlrev_b32 v12, 16, v25
    v_and_b32 v13, 0xffff0000, v25
    v_pk_fma_f32 v[14:15], v[8:9], v[10:11], s[12:13] op_sel_hi:[1,0,1]
    v_pk_fma_f32 v[16:17], v[8:9], v[10:11], s[14:15] op_sel:[0,1,0]
    v_pk_fma_f32 v[18:19], v[8:9], v[12:13], s[12:13] op_sel_hi:[1,0,1]
    v_pk_fma_f32 v[20:21], v[8:9], v[12:13], s[14:15] op_sel:[0,1,0]
    v_lshl_add_u32 v15, v17, 16, v15
    v_lshl_add_u32 v19, v21, 16, v19
    v_mad_u64_u32 v[14:15], vcc, v16, s18, v[14:15]
    v_mad_u64_u32 v[18:19], vcc, v20, s18, v[18:19]
    ds_add_rtn_u64 v[24:25], v22, v[14:15] offset:7392
    ds_add_rtn_u64 v[82:83], v22, v[18:19] offset:57400
    v_pk_mul_f32 v[8:9], v[22:23], s[16:17] op_sel:[1,0] op_sel_hi:[1,1]
    v_and_b32 v22, 0xfff8, v81
    v_fma_f32 v9, v8, v9, v5
    s_waitcnt vmcnt(5)
    v_lshlrev_b32 v10, 16, v26
    v_and_b32 v11, 0xffff0000, v26
    v_lshlrev_b32 v12, 16, v27
    v_and_b32 v13, 0xffff0000, v27
    v_pk_fma_f32 v[14:15], v[8:9], v[10:11], s[12:13] op_sel_hi:[1,0,1]
    v_pk_fma_f32 v[16:17], v[8:9], v[10:11], s[14:15] op_sel:[0,1,0]
    v_pk_fma_f32 v[18:19], v[8:9], v[12:13], s[12:13] op_sel_hi:[1,0,1]
    v_pk_fma_f32 v[20:21], v[8:9], v[12:13], s[14:15] op_sel:[0,1,0]
    v_lshl_add_u32 v15, v17, 16, v15
    v_lshl_add_u32 v19, v21, 16, v19
    v_mad_u64_u32 v[14:15], vcc, v16, s18, v[14:15]
    v_mad_u64_u32 v[18:19], vcc, v20, s18, v[18:19]
    ds_add_rtn_u64 v[26:27], v22, v[14:15] offset:7392
    ds_add_rtn_u64 v[80:81], v22, v[18:19] offset:57400
    s_waitcnt lgkmcnt(3)
    v_or3_b32 v7, v7, v24, v25
    s_waitcnt lgkmcnt(2)
    v_or3_b32 v7, v7, v82, v83
    s_waitcnt lgkmcnt(1)
    v_or3_b32 v7, v7, v26, v27
    s_waitcnt lgkmcnt(0)
    v_or3_b32 v7, v7, v80, v81
    v_lshlrev_b32 v94, 10, v94
    v_sub_u32 v24, v92, v94
    v_sub_u32 v26, v93, v94
    v_and_b32 v24, 0xff8, v24
    v_and_b32 v26, 0xff8, v26
    v_add_u32 v24, v24, v94
    v_add_u32 v26, v26, v94
    buffer_load_dwordx2 v[24:25], v24, s[8:11], 0 offen
    buffer_load_dwordx2 v[26:27], v26, s[8:11], 0 offen
    v_perm_b32 v22, v64, v66, v4
    v_cndmask_b32_e64 v64, v64, v66, s[84:85]
    v_pk_mad_u16 v22, v22, 4, -16 op_sel_hi:[1,0,0]
    v_perm_b32 v23, v64, v65, s101
    v_and_or_b32 v66, v23, s3, v22
    v_bfe_i32 v23, v66, 0, 16
    v_ashrrev_i32 v22, 16, v66
    ds_add_u32 v23, v6
    ds_add_u32 v22, v6
    v_mad_u32_u16 v40, v40, 2, s19 op_sel:[0,0,0,0]
    v_mad_u32_u16 v41, v41, 2, s19 op_sel:[0,0,0,0]
    ds_write_b32 v40, v121
    ds_write_b32 v41, v120
    s_waitcnt vmcnt(6)
    v_perm_b32 v22, v68, v70, v4
    v_cndmask_b32_e64 v68, v68, v70, s[84:85]
    v_pk_mad_u16 v22, v22, 4, -16 op_sel_hi:[1,0,0]
    v_perm_b32 v23, v68, v69, s101
    v_and_or_b32 v70, v23, s3, v22
    v_bfe_i32 v23, v70, 0, 16
    v_ashrrev_i32 v22, 16, v70
    ds_add_u32 v23, v6
    ds_add_u32 v22, v6
    v_mad_u32_u16 v36, v36, 2, s19 op_sel:[0,0,0,0]
    v_mad_u32_u16 v37, v37, 2, s19 op_sel:[0,0,0,0]
    ds_write_b32 v36, v125
    ds_write_b32 v37, v124
    s_waitcnt lgkmcnt(0)
    s_barrier
    v_lshrrev_b32 v43, 3, v1
    v_and_b32 v43, -2, v43
    ds_read_b64 v[100:101], v2 offset:0
    ds_read_u16 v102, v43 offset:3872
    ds_read_b64 v[104:105], v2 offset:8192
    ds_read_u16 v106, v43 offset:4384
    ds_read_b64 v[108:109], v2 offset:16384
    ds_read_u16 v110, v43 offset:4896
    ds_read_b64 v[112:113], v2 offset:24576
    ds_read_u16 v114, v43 offset:5408
    ds_read_b64 v[116:117], v2 offset:32768
    ds_read_u16 v118, v43 offset:5920
    ds_read_b64 v[120:121], v2 offset:40960
    ds_read_u16 v122, v43 offset:6432
    ds_read_b64 v[124:125], v2 offset:49152
    ds_read_u16 v126, v43 offset:6944
    v_alignbit_b32 v84, v84, v84, 9
    v_alignbit_b32 v85, v85, v85, 9
    v_and_b32 v8, 0x3ff0000, v84
    v_and_b32 v9, 0x3ff0000, v85
    v_pk_mul_f32 v[8:9], v[8:9], s[20:21] op_sel_hi:[1,0]
    v_cos_f32 v8, v8
    v_cos_f32 v23, v9
    s_nop 0
    v_pk_mul_f32 v[8:9], v[8:9], s[16:17] op_sel_hi:[0,1]
    v_and_b32 v22, 0xfff8, v84
    v_fma_f32 v9, v8, v9, v5
    s_waitcnt vmcnt(5)
    v_lshlrev_b32 v10, 16, v28
    v_and_b32 v11, 0xffff0000, v28
    v_lshlrev_b32 v12, 16, v29
    v_and_b32 v13, 0xffff0000, v29
    v_pk_fma_f32 v[14:15], v[8:9], v[10:11], s[12:13] op_sel_hi:[1,0,1]
    v_pk_fma_f32 v[16:17], v[8:9], v[10:11], s[14:15] op_sel:[0,1,0]
    v_pk_fma_f32 v[18:19], v[8:9], v[12:13], s[12:13] op_sel_hi:[1,0,1]
    v_pk_fma_f32 v[20:21], v[8:9], v[12:13], s[14:15] op_sel:[0,1,0]
    v_lshl_add_u32 v15, v17, 16, v15
    v_lshl_add_u32 v19, v21, 16, v19
    v_mad_u64_u32 v[14:15], vcc, v16, s18, v[14:15]
    v_mad_u64_u32 v[18:19], vcc, v20, s18, v[18:19]
    ds_add_rtn_u64 v[28:29], v22, v[14:15] offset:7392
    ds_add_rtn_u64 v[86:87], v22, v[18:19] offset:57400
    v_pk_mul_f32 v[8:9], v[22:23], s[16:17] op_sel:[1,0] op_sel_hi:[1,1]
    v_and_b32 v22, 0xfff8, v85
    v_fma_f32 v9, v8, v9, v5
    s_waitcnt vmcnt(4)
    v_lshlrev_b32 v10, 16, v30
    v_and_b32 v11, 0xffff0000, v30
    v_lshlrev_b32 v12, 16, v31
    v_and_b32 v13, 0xffff0000, v31
    v_pk_fma_f32 v[14:15], v[8:9], v[10:11], s[12:13] op_sel_hi:[1,0,1]
    v_pk_fma_f32 v[16:17], v[8:9], v[10:11], s[14:15] op_sel:[0,1,0]
    v_pk_fma_f32 v[18:19], v[8:9], v[12:13], s[12:13] op_sel_hi:[1,0,1]
    v_pk_fma_f32 v[20:21], v[8:9], v[12:13], s[14:15] op_sel:[0,1,0]
    v_lshl_add_u32 v15, v17, 16, v15
    v_lshl_add_u32 v19, v21, 16, v19
    v_mad_u64_u32 v[14:15], vcc, v16, s18, v[14:15]
    v_mad_u64_u32 v[18:19], vcc, v20, s18, v[18:19]
    ds_add_rtn_u64 v[30:31], v22, v[14:15] offset:7392
    ds_add_rtn_u64 v[84:85], v22, v[18:19] offset:57400
    s_waitcnt lgkmcnt(3)
    v_or3_b32 v7, v7, v28, v29
    s_waitcnt lgkmcnt(2)
    v_or3_b32 v7, v7, v86, v87
    s_waitcnt lgkmcnt(1)
    v_or3_b32 v7, v7, v30, v31
    s_waitcnt lgkmcnt(0)
    v_or3_b32 v7, v7, v84, v85
    s_sub_u32 s100, s27, 12288
    v_lshlrev_b32 v98, 10, v98
    v_sub_u32 v28, v96, v98
    v_sub_u32 v30, v97, v98
    v_and_b32 v28, 0xff8, v28
    v_and_b32 v30, 0xff8, v30
    v_add_u32 v28, v28, v98
    v_add_u32 v30, v30, v98
    v_cmpx_gt_i32 vcc, s100, v0
    buffer_load_dwordx2 v[28:29], v28, s[8:11], 0 offen
    buffer_load_dwordx2 v[30:31], v30, s[8:11], 0 offen
    s_mov_b64 exec, -1
    s_waitcnt lgkmcnt(0)
    s_cmp_lg_u32 s24, 15
    s_cbranch_scc1 .Lsc3
    v_and_b32 v22, 0xff, v1
    v_lshlrev_b32 v22, 2, v22
    s_bfm_b64 exec, 50, 0
    ds_read_b128 v[8:11], v22 offset:0
    ds_read_b128 v[12:15], v22 offset:1024
    ds_read_b128 v[16:19], v22 offset:2048
    ds_read_b128 v[36:39], v22 offset:3072
    s_waitcnt lgkmcnt(2)
    v_add_u32_sdwa v12, v12, v8 dst_sel:DWORD dst_unused:UNUSED_PAD src0_sel:WORD_1 src1_sel:WORD_1
    s_waitcnt lgkmcnt(1)
    v_add_u32_sdwa v16, v16, v12 dst_sel:DWORD dst_unused:UNUSED_PAD src0_sel:WORD_1 src1_sel:DWORD
    s_waitcnt lgkmcnt(0)
    v_add_u32_sdwa v36, v36, v16 dst_sel:DWORD dst_unused:UNUSED_PAD src0_sel:WORD_1 src1_sel:DWORD
    v_add_u32_sdwa v9, v9, v36 dst_sel:DWORD dst_unused:UNUSED_PAD src0_sel:WORD_1 src1_sel:DWORD
    v_add_u32_sdwa v13, v13, v9 dst_sel:DWORD dst_unused:UNUSED_PAD src0_sel:WORD_1 src1_sel:DWORD
    v_add_u32_sdwa v17, v17, v13 dst_sel:DWORD dst_unused:UNUSED_PAD src0_sel:WORD_1 src1_sel:DWORD
    v_add_u32_sdwa v37, v37, v17 dst_sel:DWORD dst_unused:UNUSED_PAD src0_sel:WORD_1 src1_sel:DWORD
    v_add_u32_sdwa v10, v10, v37 dst_sel:DWORD dst_unused:UNUSED_PAD src0_sel:WORD_1 src1_sel:DWORD
    v_add_u32_sdwa v14, v14, v10 dst_sel:DWORD dst_unused:UNUSED_PAD src0_sel:WORD_1 src1_sel:DWORD
    v_add_u32_sdwa v18, v18, v14 dst_sel:DWORD dst_unused:UNUSED_PAD src0_sel:WORD_1 src1_sel:DWORD
    v_add_u32_sdwa v38, v38, v18 dst_sel:DWORD dst_unused:UNUSED_PAD src0_sel:WORD_1 src1_sel:DWORD
    v_add_u32_sdwa v11, v11, v38 dst_sel:DWORD dst_unused:UNUSED_PAD src0_sel:WORD_1 src1_sel:DWORD
    v_add_u32_sdwa v15, v15, v11 dst_sel:DWORD dst_unused:UNUSED_PAD src0_sel:WORD_1 src1_sel:DWORD
    v_add_u32_sdwa v19, v19, v15 dst_sel:DWORD dst_unused:UNUSED_PAD src0_sel:WORD_1 src1_sel:DWORD
    v_add_u32_sdwa v39, v39, v19 dst_sel:DWORD dst_unused:UNUSED_PAD src0_sel:WORD_1 src1_sel:DWORD
    v_mov_b32 v23, v39
    s_nop 1
    v_add_u32_dpp v23, v23, v23 row_shr:1 row_mask:0xf bank_mask:0xf
    s_nop 1
    v_add_u32_dpp v23, v23, v23 row_shr:2 row_mask:0xf bank_mask:0xf
    s_nop 1
    v_add_u32_dpp v23, v23, v23 row_shr:4 row_mask:0xf bank_mask:0xf
    s_nop 1
    v_add_u32_dpp v23, v23, v23 row_shr:8 row_mask:0xf bank_mask:0xf
    s_nop 1
    v_add_u32_dpp v23, v23, v23 row_bcast:15 row_mask:0xa bank_mask:0xf
    s_nop 1
    v_add_u32_dpp v23, v23, v23 row_bcast:31 row_mask:0xc bank_mask:0xf
    v_sub_u32 v23, v23, v39
    v_add_u32 v23, 2, v23
    v_add_u32_sdwa v39, v23, v19 dst_sel:WORD_1 dst_unused:UNUSED_PAD src0_sel:DWORD src1_sel:DWORD
    v_add_u32_sdwa v19, v23, v15 dst_sel:WORD_1 dst_unused:UNUSED_PAD src0_sel:DWORD src1_sel:DWORD
    v_add_u32_sdwa v15, v23, v11 dst_sel:WORD_1 dst_unused:UNUSED_PAD src0_sel:DWORD src1_sel:DWORD
    v_add_u32_sdwa v11, v23, v38 dst_sel:WORD_1 dst_unused:UNUSED_PAD src0_sel:DWORD src1_sel:DWORD
    v_add_u32_sdwa v38, v23, v18 dst_sel:WORD_1 dst_unused:UNUSED_PAD src0_sel:DWORD src1_sel:DWORD
    v_add_u32_sdwa v18, v23, v14 dst_sel:WORD_1 dst_unused:UNUSED_PAD src0_sel:DWORD src1_sel:DWORD
    v_add_u32_sdwa v14, v23, v10 dst_sel:WORD_1 dst_unused:UNUSED_PAD src0_sel:DWORD src1_sel:DWORD
    v_add_u32_sdwa v10, v23, v37 dst_sel:WORD_1 dst_unused:UNUSED_PAD src0_sel:DWORD src1_sel:DWORD
    v_add_u32_sdwa v37, v23, v17 dst_sel:WORD_1 dst_unused:UNUSED_PAD src0_sel:DWORD src1_sel:DWORD
    v_add_u32_sdwa v17, v23, v13 dst_sel:WORD_1 dst_unused:UNUSED_PAD src0_sel:DWORD src1_sel:DWORD
    v_add_u32_sdwa v13, v23, v9 dst_sel:WORD_1 dst_unused:UNUSED_PAD src0_sel:DWORD src1_sel:DWORD
    v_add_u32_sdwa v9, v23, v36 dst_sel:WORD_1 dst_unused:UNUSED_PAD src0_sel:DWORD src1_sel:DWORD
    v_add_u32_sdwa v36, v23, v16 dst_sel:WORD_1 dst_unused:UNUSED_PAD src0_sel:DWORD src1_sel:DWORD
    v_add_u32_sdwa v16, v23, v12 dst_sel:WORD_1 dst_unused:UNUSED_PAD src0_sel:DWORD src1_sel:DWORD
    v_add_u32_sdwa v12, v23, v8 dst_sel:WORD_1 dst_unused:UNUSED_PAD src0_sel:DWORD src1_sel:WORD_1
    v_lshlrev_b32 v8, 16, v23
    s_nop 0
    ds_write_b128 v22, v[8:11] offset:0
    ds_write_b128 v22, v[12:15] offset:1024
    ds_write_b128 v22, v[16:19] offset:2048
    ds_write_b128 v22, v[36:39] offset:3072
    s_mov_b64 exec, -1
    s_waitcnt lgkmcnt(0)
.Lsc3:
    v_alignbit_b32 v88, v88, v88, 9
    v_alignbit_b32 v89, v89, v89, 9
    v_and_b32 v8, 0x3ff0000, v88
    v_and_b32 v9, 0x3ff0000, v89
    v_pk_mul_f32 v[8:9], v[8:9], s[20:21] op_sel_hi:[1,0]
    v_cos_f32 v8, v8
    v_cos_f32 v23, v9
    s_nop 0
    v_pk_mul_f32 v[8:9], v[8:9], s[16:17] op_sel_hi:[0,1]
    v_and_b32 v22, 0xfff8, v88
    v_fma_f32 v9, v8, v9, v5
    s_waitcnt vmcnt(5)
    v_lshlrev_b32 v10, 16, v32
    v_and_b32 v11, 0xffff0000, v32
    v_lshlrev_b32 v12, 16, v33
    v_and_b32 v13, 0xffff0000, v33
    v_pk_fma_f32 v[14:15], v[8:9], v[10:11], s[12:13] op_sel_hi:[1,0,1]
    v_pk_fma_f32 v[16:17], v[8:9], v[10:11], s[14:15] op_sel:[0,1,0]
    v_pk_fma_f32 v[18:19], v[8:9], v[12:13], s[12:13] op_sel_hi:[1,0,1]
    v_pk_fma_f32 v[20:21], v[8:9], v[12:13], s[14:15] op_sel:[0,1,0]
    v_lshl_add_u32 v15, v17, 16, v15
    v_lshl_add_u32 v19, v21, 16, v19
    v_mad_u64_u32 v[14:15], vcc, v16, s18, v[14:15]
    v_mad_u64_u32 v[18:19], vcc, v20, s18, v[18:19]
    ds_add_rtn_u64 v[32:33], v22, v[14:15] offset:7392
    ds_add_rtn_u64 v[90:91], v22, v[18:19] offset:57400
    v_pk_mul_f32 v[8:9], v[22:23], s[16:17] op_sel:[1,0] op_sel_hi:[1,1]
    v_and_b32 v22, 0xfff8, v89
    v_fma_f32 v9, v8, v9, v5
    s_waitcnt vmcnt(4)
    v_lshlrev_b32 v10, 16, v34
    v_and_b32 v11, 0xffff0000, v34
    v_lshlrev_b32 v12, 16, v35
    v_and_b32 v13, 0xffff0000, v35
    v_pk_fma_f32 v[14:15], v[8:9], v[10:11], s[12:13] op_sel_hi:[1,0,1]
    v_pk_fma_f32 v[16:17], v[8:9], v[10:11], s[14:15] op_sel:[0,1,0]
    v_pk_fma_f32 v[18:19], v[8:9], v[12:13], s[12:13] op_sel_hi:[1,0,1]
    v_pk_fma_f32 v[20:21], v[8:9], v[12:13], s[14:15] op_sel:[0,1,0]
    v_lshl_add_u32 v15, v17, 16, v15
    v_lshl_add_u32 v19, v21, 16, v19
    v_mad_u64_u32 v[14:15], vcc, v16, s18, v[14:15]
    v_mad_u64_u32 v[18:19], vcc, v20, s18, v[18:19]
    ds_add_rtn_u64 v[34:35], v22, v[14:15] offset:7392
    ds_add_rtn_u64 v[88:89], v22, v[18:19] offset:57400
    s_waitcnt lgkmcnt(3)
    v_or3_b32 v7, v7, v32, v33
    s_waitcnt lgkmcnt(2)
    v_or3_b32 v7, v7, v90, v91
    s_waitcnt lgkmcnt(1)
    v_or3_b32 v7, v7, v34, v35
    s_waitcnt lgkmcnt(0)
    v_or3_b32 v7, v7, v88, v89
    s_add_u32 s8, s8, 800000
    s_addc_u32 s9, s9, 0
    s_sub_u32 s10, s10, 800000
    v_lshlrev_b32 v102, 10, v102
    v_sub_u32 v32, v100, v102
    v_sub_u32 v34, v101, v102
    v_and_b32 v32, 0xff8, v32
    v_and_b32 v34, 0xff8, v34
    v_add_u32 v32, v32, v102
    v_add_u32 v34, v34, v102
    buffer_load_dwordx2 v[32:33], v32, s[8:11], 0 offen
    buffer_load_dwordx2 v[34:35], v34, s[8:11], 0 offen
    s_waitcnt lgkmcnt(0)
    s_barrier
    v_lshrrev_b32 v40, 2, v1
    v_and_b32 v41, 3, v40
    v_and_b32 v36, -4, v40
    v_lshl_or_b32 v36, v41, 10, v36
    v_add_u32 v38, 1, v40
    v_and_b32 v41, 3, v38
    v_and_b32 v38, -4, v38
    v_lshl_or_b32 v38, v41, 10, v38
    ds_read_b32 v39, v3 offset:3866
    ds_read_b32 v37, v36 offset:4
    ds_read_b32 v36, v36 offset:0
    ds_read_b32 v38, v38 offset:0
    v_alignbit_b32 v92, v92, v92, 9
    v_alignbit_b32 v93, v93, v93, 9
    v_and_b32 v8, 0x3ff0000, v92
    v_and_b32 v9, 0x3ff0000, v93
    v_pk_mul_f32 v[8:9], v[8:9], s[20:21] op_sel_hi:[1,0]
    v_cos_f32 v8, v8
    v_cos_f32 v23, v9
    s_nop 0
    v_pk_mul_f32 v[8:9], v[8:9], s[16:17] op_sel_hi:[0,1]
    v_and_b32 v22, 0xfff8, v92
    v_fma_f32 v9, v8, v9, v5
    s_waitcnt vmcnt(5)
    v_lshlrev_b32 v10, 16, v24
    v_and_b32 v11, 0xffff0000, v24
    v_lshlrev_b32 v12, 16, v25
    v_and_b32 v13, 0xffff0000, v25
    v_pk_fma_f32 v[14:15], v[8:9], v[10:11], s[12:13] op_sel_hi:[1,0,1]
    v_pk_fma_f32 v[16:17], v[8:9], v[10:11], s[14:15] op_sel:[0,1,0]
    v_pk_fma_f32 v[18:19], v[8:9], v[12:13], s[12:13] op_sel_hi:[1,0,1]
    v_pk_fma_f32 v[20:21], v[8:9], v[12:13], s[14:15] op_sel:[0,1,0]
    v_lshl_add_u32 v15, v17, 16, v15
    v_lshl_add_u32 v19, v21, 16, v19
    v_mad_u64_u32 v[14:15], vcc, v16, s18, v[14:15]
    v_mad_u64_u32 v[18:19], vcc, v20, s18, v[18:19]
    ds_add_rtn_u64 v[24:25], v22, v[14:15] offset:7392
    ds_add_rtn_u64 v[94:95], v22, v[18:19] offset:57400
    v_pk_mul_f32 v[8:9], v[22:23], s[16:17] op_sel:[1,0] op_sel_hi:[1,1]
    v_and_b32 v22, 0xfff8, v93
    v_fma_f32 v9, v8, v9, v5
    s_waitcnt vmcnt(4)
    v_lshlrev_b32 v10, 16, v26
    v_and_b32 v11, 0xffff0000, v26
    v_lshlrev_b32 v12, 16, v27
    v_and_b32 v13, 0xffff0000, v27
    v_pk_fma_f32 v[14:15], v[8:9], v[10:11], s[12:13] op_sel_hi:[1,0,1]
    v_pk_fma_f32 v[16:17], v[8:9], v[10:11], s[14:15] op_sel:[0,1,0]
    v_pk_fma_f32 v[18:19], v[8:9], v[12:13], s[12:13] op_sel_hi:[1,0,1]
    v_pk_fma_f32 v[20:21], v[8:9], v[12:13], s[14:15] op_sel:[0,1,0]
    v_lshl_add_u32 v15, v17, 16, v15
    v_lshl_add_u32 v19, v21, 16, v19
    v_mad_u64_u32 v[14:15], vcc, v16, s18, v[14:15]
    v_mad_u64_u32 v[18:19], vcc, v20, s18, v[18:19]
    ds_add_rtn_u64 v[26:27], v22, v[14:15] offset:7392
    ds_add_rtn_u64 v[92:93], v22, v[18:19] offset:57400
    s_waitcnt lgkmcnt(3)
    v_or3_b32 v7, v7, v24, v25
    s_waitcnt lgkmcnt(2)
    v_or3_b32 v7, v7, v94, v95
    s_waitcnt lgkmcnt(1)
    v_or3_b32 v7, v7, v26, v27
    s_waitcnt lgkmcnt(0)
    v_or3_b32 v7, v7, v92, v93
    v_lshlrev_b32 v106, 10, v106
    v_sub_u32 v24, v104, v106
    v_sub_u32 v26, v105, v106
    v_and_b32 v24, 0xff8, v24
    v_and_b32 v26, 0xff8, v26
    v_add_u32 v24, v24, v106
    v_add_u32 v26, v26, v106
    buffer_load_dwordx2 v[24:25], v24, s[8:11], 0 offen
    buffer_load_dwordx2 v[26:27], v26, s[8:11], 0 offen
    v_lshrrev_b32 v39, 16, v39
    s_nop 0
    v_readfirstlane_b32 s29, v39
    v_lshl_add_u32 v41, v39, 1, s19
    v_mov_b32 v43, 0
    s_cmp_gt_u32 s29, 28160
    s_cbranch_scc1 .Lslow0
    s_mov_b64 exec, 1
    ds_write_b32 v41, v43
    v_mov_b32 v41, s19
    ds_write_b32 v41, v43
    s_mov_b64 exec, -1
    s_lshr_b32 s29, s29, 1
    s_cmp_lt_u32 s29, 12288
    s_cbranch_scc1 .Lfl3
.Lflx3:
    v_lshrrev_b32 v37, 16, v37
    v_lshrrev_b32 v36, 16, v36
    v_lshrrev_b32 v38, 16, v38
    v_cmp_ne_u32 vcc, 0, v40
    s_nop 1
    v_cndmask_b32 v36, 0, v36, vcc
    v_add_u32 v36, 15, v36
    v_sub_u32 v41, v37, v38
    v_and_b32 v36, -16, v36
    v_cmpx_gt_u32 vcc, 796, v40
    v_cmpx_lt_u32 vcc, v36, v38
    v_cmp_ne_u32 vcc, v37, v39
    s_nop 1
    v_cndmask_b32 v41, 14, v41, vcc
    v_subrev_u32 v41, 14, v41
    v_and_b32 v41, 0x80000000, v41
    v_or_b32 v7, v7, v41
.Lbd3:
    v_lshrrev_b32 v41, 3, v36
    v_add_u32 v36, 16, v36
    ds_write_b16 v41, v40 offset:3872
    v_cmpx_lt_u32 vcc, v36, v38
    s_nop 1
    s_cbranch_execnz .Lbd3
    s_mov_b64 exec, -1
    s_sub_u32 s100, s27, 12288
    v_cmpx_gt_i32 vcc, s100, v0
    s_waitcnt vmcnt(4)
    v_and_b32 v22, v97, v31
    s_cbranch_execz .Lk1a
    v_alignbit_b32 v96, v96, v96, 9
    v_alignbit_b32 v97, v97, v97, 9
    v_and_b32 v8, 0x3ff0000, v96
    v_and_b32 v9, 0x3ff0000, v97
    v_pk_mul_f32 v[8:9], v[8:9], s[20:21] op_sel_hi:[1,0]
    v_cos_f32 v8, v8
    v_cos_f32 v23, v9
    v_pk_mul_f32 v[8:9], v[8:9], s[16:17] op_sel_hi:[0,1]
    v_and_b32 v22, 0xfff8, v96
    v_fma_f32 v9, v8, v9, v5
    v_lshlrev_b32 v10, 16, v28
    v_and_b32 v11, 0xffff0000, v28
    v_lshlrev_b32 v12, 16, v29
    v_and_b32 v13, 0xffff0000, v29
    v_pk_fma_f32 v[14:15], v[8:9], v[10:11], s[12:13] op_sel_hi:[1,0,1]
    v_pk_fma_f32 v[16:17], v[8:9], v[10:11], s[14:15] op_sel:[0,1,0]
    v_pk_fma_f32 v[18:19], v[8:9], v[12:13], s[12:13] op_sel_hi:[1,0,1]
    v_pk_fma_f32 v[20:21], v[8:9], v[12:13], s[14:15] op_sel:[0,1,0]
    v_lshl_add_u32 v15, v17, 16, v15
    v_lshl_add_u32 v19, v21, 16, v19
    v_mad_u64_u32 v[14:15], vcc, v16, s18, v[14:15]
    v_mad_u64_u32 v[18:19], vcc, v20, s18, v[18:19]
.Lk1a:
    ds_add_rtn_u64 v[28:29], v22, v[14:15] offset:7392
    ds_add_rtn_u64 v[98:99], v22, v[18:19] offset:57400
    s_cbranch_execz .Lk1b
    v_pk_mul_f32 v[8:9], v[22:23], s[16:17] op_sel:[1,0] op_sel_hi:[1,1]
    v_and_b32 v22, 0xfff8, v97
    v_fma_f32 v9, v8, v9, v5
    v_lshlrev_b32 v10, 16, v30
    v_and_b32 v11, 0xffff0000, v30
    v_lshlrev_b32 v12, 16, v31
    v_and_b32 v13, 0xffff0000, v31
    v_pk_fma_f32 v[14:15], v[8:9], v[10:11], s[12:13] op_sel_hi:[1,0,1]
    v_pk_fma_f32 v[16:17], v[8:9], v[10:11], s[14:15] op_sel:[0,1,0]
    v_pk_fma_f32 v[18:19], v[8:9], v[12:13], s[12:13] op_sel_hi:[1,0,1]
    v_pk_fma_f32 v[20:21], v[8:9], v[12:13], s[14:15] op_sel:[0,1,0]
    v_lshl_add_u32 v15, v17, 16, v15
    v_lshl_add_u32 v19, v21, 16, v19
    v_mad_u64_u32 v[14:15], vcc, v16, s18, v[14:15]
    v_mad_u64_u32 v[18:19], vcc, v20, s18, v[18:19]
.Lk1b:
    ds_add_rtn_u64 v[30:31], v22, v[14:15] offset:7392
    ds_add_rtn_u64 v[96:97], v22, v[18:19] offset:57400
    s_mov_b64 exec, -1
    s_sub_u32 s100, s27, 12288
    v_cmpx_gt_i32 vcc, s100, v0
    s_waitcnt lgkmcnt(3)
    v_or3_b32 v7, v7, v28, v29
    s_waitcnt lgkmcnt(2)
    v_or3_b32 v7, v7, v98, v99
    s_waitcnt lgkmcnt(1)
    v_or3_b32 v7, v7, v30, v31
    s_waitcnt lgkmcnt(0)
    v_or3_b32 v7, v7, v96, v97
    s_mov_b64 exec, -1
    v_lshlrev_b32 v110, 10, v110
    v_sub_u32 v28, v108, v110
    v_sub_u32 v30, v109, v110
    v_and_b32 v28, 0xff8, v28
    v_and_b32 v30, 0xff8, v30
    v_add_u32 v28, v28, v110
    v_add_u32 v30, v30, v110
    buffer_load_dwordx2 v[28:29], v28, s[8:11], 0 offen
    buffer_load_dwordx2 v[30:31], v30, s[8:11], 0 offen
    s_waitcnt lgkmcnt(0)
    s_barrier
    v_bfe_i32 v36, v46, 0, 16
    v_ashrrev_i32 v37, 16, v46
    ds_add_rtn_u32 v36, v36, v6
    ds_add_rtn_u32 v37, v37, v6
    v_bfe_i32 v38, v50, 0, 16
    v_ashrrev_i32 v39, 16, v50
    ds_add_rtn_u32 v38, v38, v6
    ds_add_rtn_u32 v39, v39, v6
    v_alignbit_b32 v100, v100, v100, 9
    v_alignbit_b32 v101, v101, v101, 9
    v_and_b32 v8, 0x3ff0000, v100
    v_and_b32 v9, 0x3ff0000, v101
    v_pk_mul_f32 v[8:9], v[8:9], s[20:21] op_sel_hi:[1,0]
    v_cos_f32 v8, v8
    v_cos_f32 v23, v9
    s_nop 0
    v_pk_mul_f32 v[8:9], v[8:9], s[16:17] op_sel_hi:[0,1]
    v_and_b32 v22, 0xfff8, v100
    v_fma_f32 v9, v8, v9, v5
    s_waitcnt vmcnt(5)
    v_lshlrev_b32 v10, 16, v32
    v_and_b32 v11, 0xffff0000, v32
    v_lshlrev_b32 v12, 16, v33
    v_and_b32 v13, 0xffff0000, v33
    v_pk_fma_f32 v[14:15], v[8:9], v[10:11], s[12:13] op_sel_hi:[1,0,1]
    v_pk_fma_f32 v[16:17], v[8:9], v[10:11], s[14:15] op_sel:[0,1,0]
    v_pk_fma_f32 v[18:19], v[8:9], v[12:13], s[12:13] op_sel_hi:[1,0,1]
    v_pk_fma_f32 v[20:21], v[8:9], v[12:13], s[14:15] op_sel:[0,1,0]
    v_lshl_add_u32 v15, v17, 16, v15
    v_lshl_add_u32 v19, v21, 16, v19
    v_mad_u64_u32 v[14:15], vcc, v16, s18, v[14:15]
    v_mad_u64_u32 v[18:19], vcc, v20, s18, v[18:19]
    ds_add_rtn_u64 v[32:33], v22, v[14:15] offset:7392
    ds_add_rtn_u64 v[102:103], v22, v[18:19] offset:57400
    v_pk_mul_f32 v[8:9], v[22:23], s[16:17] op_sel:[1,0] op_sel_hi:[1,1]
    v_and_b32 v22, 0xfff8, v101
    v_fma_f32 v9, v8, v9, v5
    s_waitcnt vmcnt(4)
    v_lshlrev_b32 v10, 16, v34
    v_and_b32 v11, 0xffff0000, v34
    v_lshlrev_b32 v12, 16, v35
    v_and_b32 v13, 0xffff0000, v35
    v_pk_fma_f32 v[14:15], v[8:9], v[10:11], s[12:13] op_sel_hi:[1,0,1]
    v_pk_fma_f32 v[16:17], v[8:9], v[10:11], s[14:15] op_sel:[0,1,0]
    v_pk_fma_f32 v[18:19], v[8:9], v[12:13], s[12:13] op_sel_hi:[1,0,1]
    v_pk_fma_f32 v[20:21], v[8:9], v[12:13], s[14:15] op_sel:[0,1,0]
    v_lshl_add_u32 v15, v17, 16, v15
    v_lshl_add_u32 v19, v21, 16, v19
    v_mad_u64_u32 v[14:15], vcc, v16, s18, v[14:15]
    v_mad_u64_u32 v[18:19], vcc, v20, s18, v[18:19]
    ds_add_rtn_u64 v[34:35], v22, v[14:15] offset:7392
    ds_add_rtn_u64 v[100:101], v22, v[18:19] offset:57400
    s_waitcnt lgkmcnt(3)
    v_or3_b32 v7, v7, v32, v33
    s_waitcnt lgkmcnt(2)
    v_or3_b32 v7, v7, v102, v103
    s_waitcnt lgkmcnt(1)
    v_or3_b32 v7, v7, v34, v35
    s_waitcnt lgkmcnt(0)
    v_or3_b32 v7, v7, v100, v101
    v_lshlrev_b32 v114, 10, v114
    v_sub_u32 v32, v112, v114
    v_sub_u32 v34, v113, v114
    v_and_b32 v32, 0xff8, v32
    v_and_b32 v34, 0xff8, v34
    v_add_u32 v32, v32, v114
    v_add_u32 v34, v34, v114
    buffer_load_dwordx2 v[32:33], v32, s[8:11], 0 offen
    buffer_load_dwordx2 v[34:35], v34, s[8:11], 0 offen
    v_mad_u32_u16 v36, v36, 2, s19 op_sel:[1,0,0,0]
    v_mad_u32_u16 v37, v37, 2, s19 op_sel:[1,0,0,0]
    ds_write_b32 v36, v45
    ds_write_b32 v37, v44
    v_bfe_i32 v40, v54, 0, 16
    v_ashrrev_i32 v41, 16, v54
    ds_add_rtn_u32 v40, v40, v6
    ds_add_rtn_u32 v41, v41, v6
    v_mad_u32_u16 v38, v38, 2, s19 op_sel:[1,0,0,0]
    v_mad_u32_u16 v39, v39, 2, s19 op_sel:[1,0,0,0]
    ds_write_b32 v38, v49
    ds_write_b32 v39, v48
    v_bfe_i32 v36, v58, 0, 16
    v_ashrrev_i32 v37, 16, v58
    ds_add_rtn_u32 v36, v36, v6
    ds_add_rtn_u32 v37, v37, v6
    s_waitcnt lgkmcnt(5)
    v_mad_u32_u16 v40, v40, 2, s19 op_sel:[1,0,0,0]
    s_waitcnt lgkmcnt(4)
    v_mad_u32_u16 v41, v41, 2, s19 op_sel:[1,0,0,0]
    ds_write_b32 v40, v53
    ds_write_b32 v41, v52
    v_bfe_i32 v38, v62, 0, 16
    v_ashrrev_i32 v39, 16, v62
    ds_add_rtn_u32 v38, v38, v6
    ds_add_rtn_u32 v39, v39, v6
    v_alignbit_b32 v104, v104, v104, 9
    v_alignbit_b32 v105, v105, v105, 9
    v_and_b32 v8, 0x3ff0000, v104
    v_and_b32 v9, 0x3ff0000, v105
    v_pk_mul_f32 v[8:9], v[8:9], s[20:21] op_sel_hi:[1,0]
    v_cos_f32 v8, v8
    v_cos_f32 v23, v9
    s_nop 0
    v_pk_mul_f32 v[8:9], v[8:9], s[16:17] op_sel_hi:[0,1]
    v_and_b32 v22, 0xfff8, v104
    v_fma_f32 v9, v8, v9, v5
    s_waitcnt vmcnt(5)
    v_lshlrev_b32 v10, 16, v24
    v_and_b32 v11, 0xffff0000, v24
    v_lshlrev_b32 v12, 16, v25
    v_and_b32 v13, 0xffff0000, v25
    v_pk_fma_f32 v[14:15], v[8:9], v[10:11], s[12:13] op_sel_hi:[1,0,1]
    v_pk_fma_f32 v[16:17], v[8:9], v[10:11], s[14:15] op_sel:[0,1,0]
    v_pk_fma_f32 v[18:19], v[8:9], v[12:13], s[12:13] op_sel_hi:[1,0,1]
    v_pk_fma_f32 v[20:21], v[8:9], v[12:13], s[14:15] op_sel:[0,1,0]
    v_lshl_add_u32 v15, v17, 16, v15
    v_lshl_add_u32 v19, v21, 16, v19
    v_mad_u64_u32 v[14:15], vcc, v16, s18, v[14:15]
    v_mad_u64_u32 v[18:19], vcc, v20, s18, v[18:19]
    ds_add_rtn_u64 v[24:25], v22, v[14:15] offset:7392
    ds_add_rtn_u64 v[106:107], v22, v[18:19] offset:57400
    v_pk_mul_f32 v[8:9], v[22:23], s[16:17] op_sel:[1,0] op_sel_hi:[1,1]
    v_and_b32 v22, 0xfff8, v105
    v_fma_f32 v9, v8, v9, v5
    s_waitcnt vmcnt(4)
    v_lshlrev_b32 v10, 16, v26
    v_and_b32 v11, 0xffff0000, v26
    v_lshlrev_b32 v12, 16, v27
    v_and_b32 v13, 0xffff0000, v27
    v_pk_fma_f32 v[14:15], v[8:9], v[10:11], s[12:13] op_sel_hi:[1,0,1]
    v_pk_fma_f32 v[16:17], v[8:9], v[10:11], s[14:15] op_sel:[0,1,0]
    v_pk_fma_f32 v[18:19], v[8:9], v[12:13], s[12:13] op_sel_hi:[1,0,1]
    v_pk_fma_f32 v[20:21], v[8:9], v[12:13], s[14:15] op_sel:[0,1,0]
    v_lshl_add_u32 v15, v17, 16, v15
    v_lshl_add_u32 v19, v21, 16, v19
    v_mad_u64_u32 v[14:15], vcc, v16, s18, v[14:15]
    v_mad_u64_u32 v[18:19], vcc, v20, s18, v[18:19]
    ds_add_rtn_u64 v[26:27], v22, v[14:15] offset:7392
    ds_add_rtn_u64 v[104:105], v22, v[18:19] offset:57400
    s_waitcnt lgkmcnt(3)
    v_or3_b32 v7, v7, v24, v25
    s_waitcnt lgkmcnt(2)
    v_or3_b32 v7, v7, v106, v107
    s_waitcnt lgkmcnt(1)
    v_or3_b32 v7, v7, v26, v27
    s_waitcnt lgkmcnt(0)
    v_or3_b32 v7, v7, v104, v105
    v_lshlrev_b32 v118, 10, v118
    v_sub_u32 v24, v116, v118
    v_sub_u32 v26, v117, v118
    v_and_b32 v24, 0xff8, v24
    v_and_b32 v26, 0xff8, v26
    v_add_u32 v24, v24, v118
    v_add_u32 v26, v26, v118
    buffer_load_dwordx2 v[24:25], v24, s[8:11], 0 offen
    buffer_load_dwordx2 v[26:27], v26, s[8:11], 0 offen
    v_mad_u32_u16 v36, v36, 2, s19 op_sel:[1,0,0,0]
    v_mad_u32_u16 v37, v37, 2, s19 op_sel:[1,0,0,0]
    ds_write_b32 v36, v57
    ds_write_b32 v37, v56
    v_bfe_i32 v40, v66, 0, 16
    v_ashrrev_i32 v41, 16, v66
    ds_add_rtn_u32 v40, v40, v6
    ds_add_rtn_u32 v41, v41, v6
    v_mad_u32_u16 v38, v38, 2, s19 op_sel:[1,0,0,0]
    v_mad_u32_u16 v39, v39, 2, s19 op_sel:[1,0,0,0]
    ds_write_b32 v38, v61
    ds_write_b32 v39, v60
    v_bfe_i32 v36, v70, 0, 16
    v_ashrrev_i32 v37, 16, v70
    ds_add_rtn_u32 v36, v36, v6
    ds_add_rtn_u32 v37, v37, v6
    v_alignbit_b32 v108, v108, v108, 9
    v_alignbit_b32 v109, v109, v109, 9
    v_and_b32 v8, 0x3ff0000, v108
    v_and_b32 v9, 0x3ff0000, v109
    v_pk_mul_f32 v[8:9], v[8:9], s[20:21] op_sel_hi:[1,0]
    v_cos_f32 v8, v8
    v_cos_f32 v23, v9
    s_nop 0
    v_pk_mul_f32 v[8:9], v[8:9], s[16:17] op_sel_hi:[0,1]
    v_and_b32 v22, 0xfff8, v108
    v_fma_f32 v9, v8, v9, v5
    s_waitcnt vmcnt(5)
    v_lshlrev_b32 v10, 16, v28
    v_and_b32 v11, 0xffff0000, v28
    v_lshlrev_b32 v12, 16, v29
    v_and_b32 v13, 0xffff0000, v29
    v_pk_fma_f32 v[14:15], v[8:9], v[10:11], s[12:13] op_sel_hi:[1,0,1]
    v_pk_fma_f32 v[16:17], v[8:9], v[10:11], s[14:15] op_sel:[0,1,0]
    v_pk_fma_f32 v[18:19], v[8:9], v[12:13], s[12:13] op_sel_hi:[1,0,1]
    v_pk_fma_f32 v[20:21], v[8:9], v[12:13], s[14:15] op_sel:[0,1,0]
    v_lshl_add_u32 v15, v17, 16, v15
    v_lshl_add_u32 v19, v21, 16, v19
    v_mad_u64_u32 v[14:15], vcc, v16, s18, v[14:15]
    v_mad_u64_u32 v[18:19], vcc, v20, s18, v[18:19]
    ds_add_rtn_u64 v[28:29], v22, v[14:15] offset:7392
    ds_add_rtn_u64 v[110:111], v22, v[18:19] offset:57400
    v_pk_mul_f32 v[8:9], v[22:23], s[16:17] op_sel:[1,0] op_sel_hi:[1,1]
    v_and_b32 v22, 0xfff8, v109
    v_fma_f32 v9, v8, v9, v5
    s_waitcnt vmcnt(4)
    v_lshlrev_b32 v10, 16, v30
    v_and_b32 v11, 0xffff0000, v30
    v_lshlrev_b32 v12, 16, v31
    v_and_b32 v13, 0xffff0000, v31
    v_pk_fma_f32 v[14:15], v[8:9], v[10:11], s[12:13] op_sel_hi:[1,0,1]
    v_pk_fma_f32 v[16:17], v[8:9], v[10:11], s[14:15] op_sel:[0,1,0]
    v_pk_fma_f32 v[18:19], v[8:9], v[12:13], s[12:13] op_sel_hi:[1,0,1]
    v_pk_fma_f32 v[20:21], v[8:9], v[12:13], s[14:15] op_sel:[0,1,0]
    v_lshl_add_u32 v15, v17, 16, v15
    v_lshl_add_u32 v19, v21, 16, v19
    v_mad_u64_u32 v[14:15], vcc, v16, s18, v[14:15]
    v_mad_u64_u32 v[18:19], vcc, v20, s18, v[18:19]
    ds_add_rtn_u64 v[30:31], v22, v[14:15] offset:7392
    ds_add_rtn_u64 v[108:109], v22, v[18:19] offset:57400
    s_waitcnt lgkmcnt(3)
    v_or3_b32 v7, v7, v28, v29
    s_waitcnt lgkmcnt(2)
    v_or3_b32 v7, v7, v110, v111
    s_waitcnt lgkmcnt(1)
    v_or3_b32 v7, v7, v30, v31
    s_waitcnt lgkmcnt(0)
    v_or3_b32 v7, v7, v108, v109
    v_lshlrev_b32 v122, 10, v122
    v_sub_u32 v28, v120, v122
    v_sub_u32 v30, v121, v122
    v_and_b32 v28, 0xff8, v28
    v_and_b32 v30, 0xff8, v30
    v_add_u32 v28, v28, v122
    v_add_u32 v30, v30, v122
    buffer_load_dwordx2 v[28:29], v28, s[8:11], 0 offen
    buffer_load_dwordx2 v[30:31], v30, s[8:11], 0 offen
    v_mad_u32_u16 v40, v40, 2, s19 op_sel:[1,0,0,0]
    v_mad_u32_u16 v41, v41, 2, s19 op_sel:[1,0,0,0]
    ds_write_b32 v40, v65
    ds_write_b32 v41, v64
    v_mad_u32_u16 v36, v36, 2, s19 op_sel:[1,0,0,0]
    v_mad_u32_u16 v37, v37, 2, s19 op_sel:[1,0,0,0]
    ds_write_b32 v36, v69
    ds_write_b32 v37, v68
    s_waitcnt lgkmcnt(0)
    s_barrier
    v_lshrrev_b32 v43, 3, v1
    v_and_b32 v43, -2, v43
    ds_read_b64 v[44:45], v2 offset:0
    ds_read_u16 v46, v43 offset:3872
    ds_read_b64 v[48:49], v2 offset:8192
    ds_read_u16 v50, v43 offset:4384
    ds_read_b64 v[52:53], v2 offset:16384
    ds_read_u16 v54, v43 offset:4896
    ds_read_b64 v[56:57], v2 offset:24576
    ds_read_u16 v58, v43 offset:5408
    ds_read_b64 v[60:61], v2 offset:32768
    ds_read_u16 v62, v43 offset:5920
    ds_read_b64 v[64:65], v2 offset:40960
    ds_read_u16 v66, v43 offset:6432
    ds_read_b64 v[68:69], v2 offset:49152
    ds_read_u16 v70, v43 offset:6944
    v_alignbit_b32 v112, v112, v112, 9
    v_alignbit_b32 v113, v113, v113, 9
    v_and_b32 v8, 0x3ff0000, v112
    v_and_b32 v9, 0x3ff0000, v113
    v_pk_mul_f32 v[8:9], v[8:9], s[20:21] op_sel_hi:[1,0]
    v_cos_f32 v8, v8
    v_cos_f32 v23, v9
    s_nop 0
    v_pk_mul_f32 v[8:9], v[8:9], s[16:17] op_sel_hi:[0,1]
    v_and_b32 v22, 0xfff8, v112
    v_fma_f32 v9, v8, v9, v5
    s_waitcnt vmcnt(5)
    v_lshlrev_b32 v10, 16, v32
    v_and_b32 v11, 0xffff0000, v32
    v_lshlrev_b32 v12, 16, v33
    v_and_b32 v13, 0xffff0000, v33
    v_pk_fma_f32 v[14:15], v[8:9], v[10:11], s[12:13] op_sel_hi:[1,0,1]
    v_pk_fma_f32 v[16:17], v[8:9], v[10:11], s[14:15] op_sel:[0,1,0]
    v_pk_fma_f32 v[18:19], v[8:9], v[12:13], s[12:13] op_sel_hi:[1,0,1]
    v_pk_fma_f32 v[20:21], v[8:9], v[12:13], s[14:15] op_sel:[0,1,0]
    v_lshl_add_u32 v15, v17, 16, v15
    v_lshl_add_u32 v19, v21, 16, v19
    v_mad_u64_u32 v[14:15], vcc, v16, s18, v[14:15]
    v_mad_u64_u32 v[18:19], vcc, v20, s18, v[18:19]
    ds_add_rtn_u64 v[32:33], v22, v[14:15] offset:7392
    ds_add_rtn_u64 v[114:115], v22, v[18:19] offset:57400
    v_pk_mul_f32 v[8:9], v[22:23], s[16:17] op_sel:[1,0] op_sel_hi:[1,1]
    v_and_b32 v22, 0xfff8, v113
    v_fma_f32 v9, v8, v9, v5
    s_waitcnt vmcnt(4)
    v_lshlrev_b32 v10, 16, v34
    v_and_b32 v11, 0xffff0000, v34
    v_lshlrev_b32 v12, 16, v35
    v_and_b32 v13, 0xffff0000, v35
    v_pk_fma_f32 v[14:15], v[8:9], v[10:11], s[12:13] op_sel_hi:[1,0,1]
    v_pk_fma_f32 v[16:17], v[8:9], v[10:11], s[14:15] op_sel:[0,1,0]
    v_pk_fma_f32 v[18:19], v[8:9], v[12:13], s[12:13] op_sel_hi:[1,0,1]
    v_pk_fma_f32 v[20:21], v[8:9], v[12:13], s[14:15] op_sel:[0,1,0]
    v_lshl_add_u32 v15, v17, 16, v15
    v_lshl_add_u32 v19, v21, 16, v19
    v_mad_u64_u32 v[14:15], vcc, v16, s18, v[14:15]
    v_mad_u64_u32 v[18:19], vcc, v20, s18, v[18:19]
    ds_add_rtn_u64 v[34:35], v22, v[14:15] offset:7392
    ds_add_rtn_u64 v[112:113], v22, v[18:19] offset:57400
    s_waitcnt lgkmcnt(3)
    v_or3_b32 v7, v7, v32, v33
    s_waitcnt lgkmcnt(2)
    v_or3_b32 v7, v7, v114, v115
    s_waitcnt lgkmcnt(1)
    v_or3_b32 v7, v7, v34, v35
    s_waitcnt lgkmcnt(0)
    v_or3_b32 v7, v7, v112, v113
    s_sub_u32 s100, s28, 12288
    v_lshlrev_b32 v126, 10, v126
    v_sub_u32 v32, v124, v126
    v_sub_u32 v34, v125, v126
    v_and_b32 v32, 0xff8, v32
    v_and_b32 v34, 0xff8, v34
    v_add_u32 v32, v32, v126
    v_add_u32 v34, v34, v126
    v_cmpx_gt_i32 vcc, s100, v0
    buffer_load_dwordx2 v[32:33], v32, s[8:11], 0 offen
    buffer_load_dwordx2 v[34:35], v34, s[8:11], 0 offen
    s_mov_b64 exec, -1
    v_alignbit_b32 v116, v116, v116, 9
    v_alignbit_b32 v117, v117, v117, 9
    v_and_b32 v8, 0x3ff0000, v116
    v_and_b32 v9, 0x3ff0000, v117
    v_pk_mul_f32 v[8:9], v[8:9], s[20:21] op_sel_hi:[1,0]
    v_cos_f32 v8, v8
    v_cos_f32 v23, v9
    s_nop 0
    v_pk_mul_f32 v[8:9], v[8:9], s[16:17] op_sel_hi:[0,1]
    v_and_b32 v22, 0xfff8, v116
    v_fma_f32 v9, v8, v9, v5
    s_waitcnt vmcnt(5)
    v_lshlrev_b32 v10, 16, v24
    v_and_b32 v11, 0xffff0000, v24
    v_lshlrev_b32 v12, 16, v25
    v_and_b32 v13, 0xffff0000, v25
    v_pk_fma_f32 v[14:15], v[8:9], v[10:11], s[12:13] op_sel_hi:[1,0,1]
    v_pk_fma_f32 v[16:17], v[8:9], v[10:11], s[14:15] op_sel:[0,1,0]
    v_pk_fma_f32 v[18:19], v[8:9], v[12:13], s[12:13] op_sel_hi:[1,0,1]
    v_pk_fma_f32 v[20:21], v[8:9], v[12:13], s[14:15] op_sel:[0,1,0]
    v_lshl_add_u32 v15, v17, 16, v15
    v_lshl_add_u32 v19, v21, 16, v19
    v_mad_u64_u32 v[14:15], vcc, v16, s18, v[14:15]
    v_mad_u64_u32 v[18:19], vcc, v20, s18, v[18:19]
    ds_add_rtn_u64 v[24:25], v22, v[14:15] offset:7392
    ds_add_rtn_u64 v[118:119], v22, v[18:19] offset:57400
    v_pk_mul_f32 v[8:9], v[22:23], s[16:17] op_sel:[1,0] op_sel_hi:[1,1]
    v_and_b32 v22, 0xfff8, v117
    v_fma_f32 v9, v8, v9, v5
    s_waitcnt vmcnt(4)
    v_lshlrev_b32 v10, 16, v26
    v_and_b32 v11, 0xffff0000, v26
    v_lshlrev_b32 v12, 16, v27
    v_and_b32 v13, 0xffff0000, v27
    v_pk_fma_f32 v[14:15], v[8:9], v[10:11], s[12:13] op_sel_hi:[1,0,1]
    v_pk_fma_f32 v[16:17], v[8:9], v[10:11], s[14:15] op_sel:[0,1,0]
    v_pk_fma_f32 v[18:19], v[8:9], v[12:13], s[12:13] op_sel_hi:[1,0,1]
    v_pk_fma_f32 v[20:21], v[8:9], v[12:13], s[14:15] op_sel:[0,1,0]
    v_lshl_add_u32 v15, v17, 16, v15
    v_lshl_add_u32 v19, v21, 16, v19
    v_mad_u64_u32 v[14:15], vcc, v16, s18, v[14:15]
    v_mad_u64_u32 v[18:19], vcc, v20, s18, v[18:19]
    ds_add_rtn_u64 v[26:27], v22, v[14:15] offset:7392
    ds_add_rtn_u64 v[116:117], v22, v[18:19] offset:57400
    s_waitcnt lgkmcnt(3)
    v_or3_b32 v7, v7, v24, v25
    s_waitcnt lgkmcnt(2)
    v_or3_b32 v7, v7, v118, v119
    s_waitcnt lgkmcnt(1)
    v_or3_b32 v7, v7, v26, v27
    s_waitcnt lgkmcnt(0)
    v_or3_b32 v7, v7, v116, v117
    s_add_u32 s8, s8, 800000
    s_addc_u32 s9, s9, 0
    s_sub_u32 s10, s10, 800000
    v_lshlrev_b32 v46, 10, v46
    v_sub_u32 v24, v44, v46
    v_sub_u32 v26, v45, v46
    v_and_b32 v24, 0xff8, v24
    v_and_b32 v26, 0xff8, v26
    v_add_u32 v24, v24, v46
    v_add_u32 v26, v26, v46
    buffer_load_dwordx2 v[24:25], v24, s[8:11], 0 offen
    buffer_load_dwordx2 v[26:27], v26, s[8:11], 0 offen
    v_alignbit_b32 v120, v120, v120, 9
    v_alignbit_b32 v121, v121, v121, 9
    v_and_b32 v8, 0x3ff0000, v120
    v_and_b32 v9, 0x3ff0000, v121
    v_pk_mul_f32 v[8:9], v[8:9], s[20:21] op_sel_hi:[1,0]
    v_cos_f32 v8, v8
    v_cos_f32 v23, v9
    s_nop 0
    v_pk_mul_f32 v[8:9], v[8:9], s[16:17] op_sel_hi:[0,1]
    v_and_b32 v22, 0xfff8, v120
    v_fma_f32 v9, v8, v9, v5
    s_waitcnt vmcnt(5)
    v_lshlrev_b32 v10, 16, v28
    v_and_b32 v11, 0xffff0000, v28
    v_lshlrev_b32 v12, 16, v29
    v_and_b32 v13, 0xffff0000, v29
    v_pk_fma_f32 v[14:15], v[8:9], v[10:11], s[12:13] op_sel_hi:[1,0,1]
    v_pk_fma_f32 v[16:17], v[8:9], v[10:11], s[14:15] op_sel:[0,1,0]
    v_pk_fma_f32 v[18:19], v[8:9], v[12:13], s[12:13] op_sel_hi:[1,0,1]
    v_pk_fma_f32 v[20:21], v[8:9], v[12:13], s[14:15] op_sel:[0,1,0]
    v_lshl_add_u32 v15, v17, 16, v15
    v_lshl_add_u32 v19, v21, 16, v19
    v_mad_u64_u32 v[14:15], vcc, v16, s18, v[14:15]
    v_mad_u64_u32 v[18:19], vcc, v20, s18, v[18:19]
    ds_add_rtn_u64 v[28:29], v22, v[14:15] offset:7392
    ds_add_rtn_u64 v[122:123], v22, v[18:19] offset:57400
    v_pk_mul_f32 v[8:9], v[22:23], s[16:17] op_sel:[1,0] op_sel_hi:[1,1]
    v_and_b32 v22, 0xfff8, v121
    v_fma_f32 v9, v8, v9, v5
    s_waitcnt vmcnt(4)
    v_lshlrev_b32 v10, 16, v30
    v_and_b32 v11, 0xffff0000, v30
    v_lshlrev_b32 v12, 16, v31
    v_and_b32 v13, 0xffff0000, v31
    v_pk_fma_f32 v[14:15], v[8:9], v[10:11], s[12:13] op_sel_hi:[1,0,1]
    v_pk_fma_f32 v[16:17], v[8:9], v[10:11], s[14:15] op_sel:[0,1,0]
    v_pk_fma_f32 v[18:19], v[8:9], v[12:13], s[12:13] op_sel_hi:[1,0,1]
    v_pk_fma_f32 v[20:21], v[8:9], v[12:13], s[14:15] op_sel:[0,1,0]
    v_lshl_add_u32 v15, v17, 16, v15
    v_lshl_add_u32 v19, v21, 16, v19
    v_mad_u64_u32 v[14:15], vcc, v16, s18, v[14:15]
    v_mad_u64_u32 v[18:19], vcc, v20, s18, v[18:19]
    ds_add_rtn_u64 v[30:31], v22, v[14:15] offset:7392
    ds_add_rtn_u64 v[120:121], v22, v[18:19] offset:57400
    s_waitcnt lgkmcnt(3)
    v_or3_b32 v7, v7, v28, v29
    s_waitcnt lgkmcnt(2)
    v_or3_b32 v7, v7, v122, v123
    s_waitcnt lgkmcnt(1)
    v_or3_b32 v7, v7, v30, v31
    s_waitcnt lgkmcnt(0)
    v_or3_b32 v7, v7, v120, v121
    v_lshlrev_b32 v50, 10, v50
    v_sub_u32 v28, v48, v50
    v_sub_u32 v30, v49, v50
    v_and_b32 v28, 0xff8, v28
    v_and_b32 v30, 0xff8, v30
    v_add_u32 v28, v28, v50
    v_add_u32 v30, v30, v50
    buffer_load_dwordx2 v[28:29], v28, s[8:11], 0 offen
    buffer_load_dwordx2 v[30:31], v30, s[8:11], 0 offen
    s_sub_u32 s100, s28, 12288
    v_cmpx_gt_i32 vcc, s100, v0
    s_waitcnt vmcnt(4)
    v_and_b32 v22, v125, v35
    s_cbranch_execz .Lk2a
    v_alignbit_b32 v124, v124, v124, 9
    v_alignbit_b32 v125, v125, v125, 9
    v_and_b32 v8, 0x3ff0000, v124
    v_and_b32 v9, 0x3ff0000, v125
    v_pk_mul_f32 v[8:9], v[8:9], s[20:21] op_sel_hi:[1,0]
    v_cos_f32 v8, v8
    v_cos_f32 v23, v9
    v_pk_mul_f32 v[8:9], v[8:9], s[16:17] op_sel_hi:[0,1]
    v_and_b32 v22, 0xfff8, v124
    v_fma_f32 v9, v8, v9, v5
    v_lshlrev_b32 v10, 16, v32
    v_and_b32 v11, 0xffff0000, v32
    v_lshlrev_b32 v12, 16, v33
    v_and_b32 v13, 0xffff0000, v33
    v_pk_fma_f32 v[14:15], v[8:9], v[10:11], s[12:13] op_sel_hi:[1,0,1]
    v_pk_fma_f32 v[16:17], v[8:9], v[10:11], s[14:15] op_sel:[0,1,0]
    v_pk_fma_f32 v[18:19], v[8:9], v[12:13], s[12:13] op_sel_hi:[1,0,1]
    v_pk_fma_f32 v[20:21], v[8:9], v[12:13], s[14:15] op_sel:[0,1,0]
    v_lshl_add_u32 v15, v17, 16, v15
    v_lshl_add_u32 v19, v21, 16, v19
    v_mad_u64_u32 v[14:15], vcc, v16, s18, v[14:15]
    v_mad_u64_u32 v[18:19], vcc, v20, s18, v[18:19]
.Lk2a:
    ds_add_rtn_u64 v[32:33], v22, v[14:15] offset:7392
    ds_add_rtn_u64 v[126:127], v22, v[18:19] offset:57400
    s_cbranch_execz .Lk2b
    v_pk_mul_f32 v[8:9], v[22:23], s[16:17] op_sel:[1,0] op_sel_hi:[1,1]
    v_and_b32 v22, 0xfff8, v125
    v_fma_f32 v9, v8, v9, v5
    v_lshlrev_b32 v10, 16, v34
    v_and_b32 v11, 0xffff0000, v34
    v_lshlrev_b32 v12, 16, v35
    v_and_b32 v13, 0xffff0000, v35
    v_pk_fma_f32 v[14:15], v[8:9], v[10:11], s[12:13] op_sel_hi:[1,0,1]
    v_pk_fma_f32 v[16:17], v[8:9], v[10:11], s[14:15] op_sel:[0,1,0]
    v_pk_fma_f32 v[18:19], v[8:9], v[12:13], s[12:13] op_sel_hi:[1,0,1]
    v_pk_fma_f32 v[20:21], v[8:9], v[12:13], s[14:15] op_sel:[0,1,0]
    v_lshl_add_u32 v15, v17, 16, v15
    v_lshl_add_u32 v19, v21, 16, v19
    v_mad_u64_u32 v[14:15], vcc, v16, s18, v[14:15]
    v_mad_u64_u32 v[18:19], vcc, v20, s18, v[18:19]
.Lk2b:
    ds_add_rtn_u64 v[34:35], v22, v[14:15] offset:7392
    ds_add_rtn_u64 v[124:125], v22, v[18:19] offset:57400
    s_mov_b64 exec, -1
    s_sub_u32 s100, s28, 12288
    v_cmpx_gt_i32 vcc, s100, v0
    s_waitcnt lgkmcnt(3)
    v_or3_b32 v7, v7, v32, v33
    s_waitcnt lgkmcnt(2)
    v_or3_b32 v7, v7, v126, v127
    s_waitcnt lgkmcnt(1)
    v_or3_b32 v7, v7, v34, v35
    s_waitcnt lgkmcnt(0)
    v_or3_b32 v7, v7, v124, v125
    s_mov_b64 exec, -1
    v_lshlrev_b32 v54, 10, v54
    v_sub_u32 v32, v52, v54
    v_sub_u32 v34, v53, v54
    v_and_b32 v32, 0xff8, v32
    v_and_b32 v34, 0xff8, v34
    v_add_u32 v32, v32, v54
    v_add_u32 v34, v34, v54
    buffer_load_dwordx2 v[32:33], v32, s[8:11], 0 offen
    buffer_load_dwordx2 v[34:35], v34, s[8:11], 0 offen
    v_add_u32 v36, 0, v0
    v_lshlrev_b32 v120, 2, v36
    global_load_ushort v36, v36, s[30:31]
    v_add_u32 v37, 2048, v0
    v_lshlrev_b32 v122, 2, v37
    global_load_ushort v37, v37, s[30:31]
    v_add_u32 v38, 4096, v0
    v_lshlrev_b32 v124, 2, v38
    global_load_ushort v38, v38, s[30:31]
    v_add_u32 v39, 6144, v0
    v_min_u32 v39, 6248, v39
    v_lshlrev_b32 v126, 2, v39
    global_load_ushort v39, v39, s[30:31]
    v_alignbit_b32 v44, v44, v44, 9
    v_alignbit_b32 v45, v45, v45, 9
    v_and_b32 v8, 0x3ff0000, v44
    v_and_b32 v9, 0x3ff0000, v45
    v_pk_mul_f32 v[8:9], v[8:9], s[20:21] op_sel_hi:[1,0]
    v_cos_f32 v8, v8
    v_cos_f32 v23, v9
    s_nop 0
    v_pk_mul_f32 v[8:9], v[8:9], s[16:17] op_sel_hi:[0,1]
    v_and_b32 v22, 0xfff8, v44
    v_fma_f32 v9, v8, v9, v5
    s_waitcnt vmcnt(9)
    v_lshlrev_b32 v10, 16, v24
    v_and_b32 v11, 0xffff0000, v24
    v_lshlrev_b32 v12, 16, v25
    v_and_b32 v13, 0xffff0000, v25
    v_pk_fma_f32 v[14:15], v[8:9], v[10:11], s[12:13] op_sel_hi:[1,0,1]
    v_pk_fma_f32 v[16:17], v[8:9], v[10:11], s[14:15] op_sel:[0,1,0]
    v_pk_fma_f32 v[18:19], v[8:9], v[12:13], s[12:13] op_sel_hi:[1,0,1]
    v_pk_fma_f32 v[20:21], v[8:9], v[12:13], s[14:15] op_sel:[0,1,0]
    v_lshl_add_u32 v15, v17, 16, v15
    v_lshl_add_u32 v19, v21, 16, v19
    v_mad_u64_u32 v[14:15], vcc, v16, s18, v[14:15]
    v_mad_u64_u32 v[18:19], vcc, v20, s18, v[18:19]
    ds_add_rtn_u64 v[24:25], v22, v[14:15] offset:7392
    ds_add_rtn_u64 v[46:47], v22, v[18:19] offset:57400
    v_pk_mul_f32 v[8:9], v[22:23], s[16:17] op_sel:[1,0] op_sel_hi:[1,1]
    v_and_b32 v22, 0xfff8, v45
    v_fma_f32 v9, v8, v9, v5
    s_waitcnt vmcnt(8)
    v_lshlrev_b32 v10, 16, v26
    v_and_b32 v11, 0xffff0000, v26
    v_lshlrev_b32 v12, 16, v27
    v_and_b32 v13, 0xffff0000, v27
    v_pk_fma_f32 v[14:15], v[8:9], v[10:11], s[12:13] op_sel_hi:[1,0,1]
    v_pk_fma_f32 v[16:17], v[8:9], v[10:11], s[14:15] op_sel:[0,1,0]
    v_pk_fma_f32 v[18:19], v[8:9], v[12:13], s[12:13] op_sel_hi:[1,0,1]
    v_pk_fma_f32 v[20:21], v[8:9], v[12:13], s[14:15] op_sel:[0,1,0]
    v_lshl_add_u32 v15, v17, 16, v15
    v_lshl_add_u32 v19, v21, 16, v19
    v_mad_u64_u32 v[14:15], vcc, v16, s18, v[14:15]
    v_mad_u64_u32 v[18:19], vcc, v20, s18, v[18:19]
    ds_add_rtn_u64 v[26:27], v22, v[14:15] offset:7392
    ds_add_rtn_u64 v[44:45], v22, v[18:19] offset:57400
    s_waitcnt lgkmcnt(3)
    v_or3_b32 v7, v7, v24, v25
    s_waitcnt lgkmcnt(2)
    v_or3_b32 v7, v7, v46, v47
    s_waitcnt lgkmcnt(1)
    v_or3_b32 v7, v7, v26, v27
    s_waitcnt lgkmcnt(0)
    v_or3_b32 v7, v7, v44, v45
    v_lshlrev_b32 v58, 10, v58
    v_sub_u32 v24, v56, v58
    v_sub_u32 v26, v57, v58
    v_and_b32 v24, 0xff8, v24
    v_and_b32 v26, 0xff8, v26
    v_add_u32 v24, v24, v58
    v_add_u32 v26, v26, v58
    buffer_load_dwordx2 v[24:25], v24, s[8:11], 0 offen
    buffer_load_dwordx2 v[26:27], v26, s[8:11], 0 offen
    v_alignbit_b32 v48, v48, v48, 9
    v_alignbit_b32 v49, v49, v49, 9
    v_and_b32 v8, 0x3ff0000, v48
    v_and_b32 v9, 0x3ff0000, v49
    v_pk_mul_f32 v[8:9], v[8:9], s[20:21] op_sel_hi:[1,0]
    v_cos_f32 v8, v8
    v_cos_f32 v23, v9
    s_nop 0
    v_pk_mul_f32 v[8:9], v[8:9], s[16:17] op_sel_hi:[0,1]
    v_and_b32 v22, 0xfff8, v48
    v_fma_f32 v9, v8, v9, v5
    s_waitcnt vmcnt(9)
    v_lshlrev_b32 v10, 16, v28
    v_and_b32 v11, 0xffff0000, v28
    v_lshlrev_b32 v12, 16, v29
    v_and_b32 v13, 0xffff0000, v29
    v_pk_fma_f32 v[14:15], v[8:9], v[10:11], s[12:13] op_sel_hi:[1,0,1]
    v_pk_fma_f32 v[16:17], v[8:9], v[10:11], s[14:15] op_sel:[0,1,0]
    v_pk_fma_f32 v[18:19], v[8:9], v[12:13], s[12:13] op_sel_hi:[1,0,1]
    v_pk_fma_f32 v[20:21], v[8:9], v[12:13], s[14:15] op_sel:[0,1,0]
    v_lshl_add_u32 v15, v17, 16, v15
    v_lshl_add_u32 v19, v21, 16, v19
    v_mad_u64_u32 v[14:15], vcc, v16, s18, v[14:15]
    v_mad_u64_u32 v[18:19], vcc, v20, s18, v[18:19]
    ds_add_rtn_u64 v[28:29], v22, v[14:15] offset:7392
    ds_add_rtn_u64 v[50:51], v22, v[18:19] offset:57400
    v_pk_mul_f32 v[8:9], v[22:23], s[16:17] op_sel:[1,0] op_sel_hi:[1,1]
    v_and_b32 v22, 0xfff8, v49
    v_fma_f32 v9, v8, v9, v5
    s_waitcnt vmcnt(8)
    v_lshlrev_b32 v10, 16, v30
    v_and_b32 v11, 0xffff0000, v30
    v_lshlrev_b32 v12, 16, v31
    v_and_b32 v13, 0xffff0000, v31
    v_pk_fma_f32 v[14:15], v[8:9], v[10:11], s[12:13] op_sel_hi:[1,0,1]
    v_pk_fma_f32 v[16:17], v[8:9], v[10:11], s[14:15] op_sel:[0,1,0]
    v_pk_fma_f32 v[18:19], v[8:9], v[12:13], s[12:13] op_sel_hi:[1,0,1]
    v_pk_fma_f32 v[20:21], v[8:9], v[12:13], s[14:15] op_sel:[0,1,0]
    v_lshl_add_u32 v15, v17, 16, v15
    v_lshl_add_u32 v19, v21, 16, v19
    v_mad_u64_u32 v[14:15], vcc, v16, s18, v[14:15]
    v_mad_u64_u32 v[18:19], vcc, v20, s18, v[18:19]
    ds_add_rtn_u64 v[30:31], v22, v[14:15] offset:7392
    ds_add_rtn_u64 v[48:49], v22, v[18:19] offset:57400
    s_waitcnt lgkmcnt(3)
    v_or3_b32 v7, v7, v28, v29
    s_waitcnt lgkmcnt(2)
    v_or3_b32 v7, v7, v50, v51
    s_waitcnt lgkmcnt(1)
    v_or3_b32 v7, v7, v30, v31
    s_waitcnt lgkmcnt(0)
    v_or3_b32 v7, v7, v48, v49
    v_lshlrev_b32 v62, 10, v62
    v_sub_u32 v28, v60, v62
    v_sub_u32 v30, v61, v62
    v_and_b32 v28, 0xff8, v28
    v_and_b32 v30, 0xff8, v30
    v_add_u32 v28, v28, v62
    v_add_u32 v30, v30, v62
    buffer_load_dwordx2 v[28:29], v28, s[8:11], 0 offen
    buffer_load_dwordx2 v[30:31], v30, s[8:11], 0 offen
    v_alignbit_b32 v52, v52, v52, 9
    v_alignbit_b32 v53, v53, v53, 9
    v_and_b32 v8, 0x3ff0000, v52
    v_and_b32 v9, 0x3ff0000, v53
    v_pk_mul_f32 v[8:9], v[8:9], s[20:21] op_sel_hi:[1,0]
    v_cos_f32 v8, v8
    v_cos_f32 v23, v9
    s_nop 0
    v_pk_mul_f32 v[8:9], v[8:9], s[16:17] op_sel_hi:[0,1]
    v_and_b32 v22, 0xfff8, v52
    v_fma_f32 v9, v8, v9, v5
    s_waitcnt vmcnt(9)
    v_lshlrev_b32 v10, 16, v32
    v_and_b32 v11, 0xffff0000, v32
    v_lshlrev_b32 v12, 16, v33
    v_and_b32 v13, 0xffff0000, v33
    v_pk_fma_f32 v[14:15], v[8:9], v[10:11], s[12:13] op_sel_hi:[1,0,1]
    v_pk_fma_f32 v[16:17], v[8:9], v[10:11], s[14:15] op_sel:[0,1,0]
    v_pk_fma_f32 v[18:19], v[8:9], v[12:13], s[12:13] op_sel_hi:[1,0,1]
    v_pk_fma_f32 v[20:21], v[8:9], v[12:13], s[14:15] op_sel:[0,1,0]
    v_lshl_add_u32 v15, v17, 16, v15
    v_lshl_add_u32 v19, v21, 16, v19
    v_mad_u64_u32 v[14:15], vcc, v16, s18, v[14:15]
    v_mad_u64_u32 v[18:19], vcc, v20, s18, v[18:19]
    ds_add_rtn_u64 v[32:33], v22, v[14:15] offset:7392
    ds_add_rtn_u64 v[54:55], v22, v[18:19] offset:57400
    v_pk_mul_f32 v[8:9], v[22:23], s[16:17] op_sel:[1,0] op_sel_hi:[1,1]
    v_and_b32 v22, 0xfff8, v53
    v_fma_f32 v9, v8, v9, v5
    s_waitcnt vmcnt(8)
    v_lshlrev_b32 v10, 16, v34
    v_and_b32 v11, 0xffff0000, v34
    v_lshlrev_b32 v12, 16, v35
    v_and_b32 v13, 0xffff0000, v35
    v_pk_fma_f32 v[14:15], v[8:9], v[10:11], s[12:13] op_sel_hi:[1,0,1]
    v_pk_fma_f32 v[16:17], v[8:9], v[10:11], s[14:15] op_sel:[0,1,0]
    v_pk_fma_f32 v[18:19], v[8:9], v[12:13], s[12:13] op_sel_hi:[1,0,1]
    v_pk_fma_f32 v[20:21], v[8:9], v[12:13], s[14:15] op_sel:[0,1,0]
    v_lshl_add_u32 v15, v17, 16, v15
    v_lshl_add_u32 v19, v21, 16, v19
    v_mad_u64_u32 v[14:15], vcc, v16, s18, v[14:15]
    v_mad_u64_u32 v[18:19], vcc, v20, s18, v[18:19]
    ds_add_rtn_u64 v[34:35], v22, v[14:15] offset:7392
    ds_add_rtn_u64 v[52:53], v22, v[18:19] offset:57400
    s_waitcnt lgkmcnt(3)
    v_or3_b32 v7, v7, v32, v33
    s_waitcnt lgkmcnt(2)
    v_or3_b32 v7, v7, v54, v55
    s_waitcnt lgkmcnt(1)
    v_or3_b32 v7, v7, v34, v35
    s_waitcnt lgkmcnt(0)
    v_or3_b32 v7, v7, v52, v53
    v_lshlrev_b32 v66, 10, v66
    v_sub_u32 v32, v64, v66
    v_sub_u32 v34, v65, v66
    v_and_b32 v32, 0xff8, v32
    v_and_b32 v34, 0xff8, v34
    v_add_u32 v32, v32, v66
    v_add_u32 v34, v34, v66
    buffer_load_dwordx2 v[32:33], v32, s[8:11], 0 offen
    buffer_load_dwordx2 v[34:35], v34, s[8:11], 0 offen
    v_alignbit_b32 v56, v56, v56, 9
    v_alignbit_b32 v57, v57, v57, 9
    v_and_b32 v8, 0x3ff0000, v56
    v_and_b32 v9, 0x3ff0000, v57
    v_pk_mul_f32 v[8:9], v[8:9], s[20:21] op_sel_hi:[1,0]
    v_cos_f32 v8, v8
    v_cos_f32 v23, v9
    s_nop 0
    v_pk_mul_f32 v[8:9], v[8:9], s[16:17] op_sel_hi:[0,1]
    v_and_b32 v22, 0xfff8, v56
    v_fma_f32 v9, v8, v9, v5
    s_waitcnt vmcnt(5)
    v_lshlrev_b32 v10, 16, v24
    v_and_b32 v11, 0xffff0000, v24
    v_lshlrev_b32 v12, 16, v25
    v_and_b32 v13, 0xffff0000, v25
    v_pk_fma_f32 v[14:15], v[8:9], v[10:11], s[12:13] op_sel_hi:[1,0,1]
    v_pk_fma_f32 v[16:17], v[8:9], v[10:11], s[14:15] op_sel:[0,1,0]
    v_pk_fma_f32 v[18:19], v[8:9], v[12:13], s[12:13] op_sel_hi:[1,0,1]
    v_pk_fma_f32 v[20:21], v[8:9], v[12:13], s[14:15] op_sel:[0,1,0]
    v_lshl_add_u32 v15, v17, 16, v15
    v_lshl_add_u32 v19, v21, 16, v19
    v_mad_u64_u32 v[14:15], vcc, v16, s18, v[14:15]
    v_mad_u64_u32 v[18:19], vcc, v20, s18, v[18:19]
    ds_add_rtn_u64 v[24:25], v22, v[14:15] offset:7392
    ds_add_rtn_u64 v[58:59], v22, v[18:19] offset:57400
    v_pk_mul_f32 v[8:9], v[22:23], s[16:17] op_sel:[1,0] op_sel_hi:[1,1]
    v_and_b32 v22, 0xfff8, v57
    v_fma_f32 v9, v8, v9, v5
    s_waitcnt vmcnt(4)
    v_lshlrev_b32 v10, 16, v26
    v_and_b32 v11, 0xffff0000, v26
    v_lshlrev_b32 v12, 16, v27
    v_and_b32 v13, 0xffff0000, v27
    v_pk_fma_f32 v[14:15], v[8:9], v[10:11], s[12:13] op_sel_hi:[1,0,1]
    v_pk_fma_f32 v[16:17], v[8:9], v[10:11], s[14:15] op_sel:[0,1,0]
    v_pk_fma_f32 v[18:19], v[8:9], v[12:13], s[12:13] op_sel_hi:[1,0,1]
    v_pk_fma_f32 v[20:21], v[8:9], v[12:13], s[14:15] op_sel:[0,1,0]
    v_lshl_add_u32 v15, v17, 16, v15
    v_lshl_add_u32 v19, v21, 16, v19
    v_mad_u64_u32 v[14:15], vcc, v16, s18, v[14:15]
    v_mad_u64_u32 v[18:19], vcc, v20, s18, v[18:19]
    ds_add_rtn_u64 v[26:27], v22, v[14:15] offset:7392
    ds_add_rtn_u64 v[56:57], v22, v[18:19] offset:57400
    s_waitcnt lgkmcnt(3)
    v_or3_b32 v7, v7, v24, v25
    s_waitcnt lgkmcnt(2)
    v_or3_b32 v7, v7, v58, v59
    s_waitcnt lgkmcnt(1)
    v_or3_b32 v7, v7, v26, v27
    s_waitcnt lgkmcnt(0)
    v_or3_b32 v7, v7, v56, v57
    s_sub_u32 s100, s29, 12288
    v_lshlrev_b32 v70, 10, v70
    v_sub_u32 v24, v68, v70
    v_sub_u32 v26, v69, v70
    v_and_b32 v24, 0xff8, v24
    v_and_b32 v26, 0xff8, v26
    v_add_u32 v24, v24, v70
    v_add_u32 v26, v26, v70
    v_cmpx_gt_i32 vcc, s100, v0
    buffer_load_dwordx2 v[24:25], v24, s[8:11], 0 offen
    buffer_load_dwordx2 v[26:27], v26, s[8:11], 0 offen
    s_mov_b64 exec, -1
    v_lshlrev_b32 v39, 16, v39
    v_mul_f32 v39, 0x40731710, v39
    s_cmp_lg_u32 s24, 0
    s_cbranch_scc1 .Lp3f
    v_mov_b32 v14, v39
    v_add_f32 v15, 0xbf0aa327, v39
    v_add_f32 v16, 0xbf8aa327, v39
    v_add_f32 v17, 0xbfcff4ba, v39
    v_add_f32 v18, 0xc00aa327, v39
    v_add_f32 v19, 0xc02dc57c, v39
    v_add_f32 v20, 0xc04ff4ba, v39
    v_add_f32 v21, 0xc0731710, v39
    v_mul_f32 v14, v14, v14
    v_mul_f32 v15, v15, v15
    v_mul_f32 v16, v16, v16
    v_mul_f32 v17, v17, v17
    v_mul_f32 v18, v18, v18
    v_mul_f32 v19, v19, v19
    v_mul_f32 v20, v20, v20
    v_mul_f32 v21, v21, v21
    v_exp_f32_e64 v14, -v14
    v_exp_f32_e64 v15, -v15
    v_exp_f32_e64 v16, -v16
    v_exp_f32_e64 v17, -v17
    v_exp_f32_e64 v18, -v18
    v_exp_f32_e64 v19, -v19
    v_exp_f32_e64 v20, -v20
    v_exp_f32_e64 v21, -v21
    v_cvt_pk_bf16_f32 v10, v14, v15
    v_cvt_pk_bf16_f32 v11, v16, v17
    v_cvt_pk_bf16_f32 v12, v18, v19
    v_cvt_pk_bf16_f32 v13, v20, v21
    v_dot2_f32_bf16 v108, v10, s52, 0
    v_dot2_f32_bf16 v109, v10, s56, 0
    v_dot2_f32_bf16 v110, v10, s53, 0
    v_dot2_f32_bf16 v111, v10, s57, 0
    v_dot2_f32_bf16 v112, v10, s54, 0
    v_dot2_f32_bf16 v113, v10, s58, 0
    v_dot2_f32_bf16 v114, v10, s55, 0
    v_dot2_f32_bf16 v115, v10, s59, 0
    v_dot2_f32_bf16 v116, v10, s36, 0
    v_dot2_f32_bf16 v117, v10, s38, 0
    v_dot2_f32_bf16 v118, v10, s37, 0
    v_dot2_f32_bf16 v119, v10, s39, 0
    v_dot2_f32_bf16 v108, v11, s60, v108
    v_dot2_f32_bf16 v109, v11, s64, v109
    v_dot2_f32_bf16 v110, v11, s61, v110
    v_dot2_f32_bf16 v111, v11, s65, v111
    v_dot2_f32_bf16 v112, v11, s62, v112
    v_dot2_f32_bf16 v113, v11, s66, v113
    v_dot2_f32_bf16 v114, v11, s63, v114
    v_dot2_f32_bf16 v115, v11, s67, v115
    v_dot2_f32_bf16 v116, v11, s40, v116
    v_dot2_f32_bf16 v117, v11, s42, v117
    v_dot2_f32_bf16 v118, v11, s41, v118
    v_dot2_f32_bf16 v119, v11, s43, v119
    v_dot2_f32_bf16 v108, v12, s68, v108
    v_dot2_f32_bf16 v109, v12, s72, v109
    v_dot2_f32_bf16 v110, v12, s69, v110
    v_dot2_f32_bf16 v111, v12, s73, v111
    v_dot2_f32_bf16 v112, v12, s70, v112
    v_dot2_f32_bf16 v113, v12, s74, v113
    v_dot2_f32_bf16 v114, v12, s71, v114
    v_dot2_f32_bf16 v115, v12, s75, v115
    v_dot2_f32_bf16 v116, v12, s44, v116
    v_dot2_f32_bf16 v117, v12, s46, v117
    v_dot2_f32_bf16 v118, v12, s45, v118
    v_dot2_f32_bf16 v119, v12, s47, v119
    v_dot2_f32_bf16 v108, v13, s76, v108
    v_dot2_f32_bf16 v109, v13, s80, v109
    v_dot2_f32_bf16 v110, v13, s77, v110
    v_dot2_f32_bf16 v111, v13, s81, v111
    v_dot2_f32_bf16 v112, v13, s78, v112
    v_dot2_f32_bf16 v113, v13, s82, v113
    v_dot2_f32_bf16 v114, v13, s79, v114
    v_dot2_f32_bf16 v115, v13, s83, v115
    v_dot2_f32_bf16 v116, v13, s48, v116
    v_dot2_f32_bf16 v117, v13, s50, v117
    v_dot2_f32_bf16 v118, v13, s49, v118
    v_dot2_f32_bf16 v119, v13, s51, v119
.Lp3f:
    v_alignbit_b32 v60, v60, v60, 9
    v_alignbit_b32 v61, v61, v61, 9
    v_and_b32 v8, 0x3ff0000, v60
    v_and_b32 v9, 0x3ff0000, v61
    v_pk_mul_f32 v[8:9], v[8:9], s[20:21] op_sel_hi:[1,0]
    v_cos_f32 v8, v8
    v_cos_f32 v23, v9
    s_nop 0
    v_pk_mul_f32 v[8:9], v[8:9], s[16:17] op_sel_hi:[0,1]
    v_and_b32 v22, 0xfff8, v60
    v_fma_f32 v9, v8, v9, v5
    s_waitcnt vmcnt(5)
    v_lshlrev_b32 v10, 16, v28
    v_and_b32 v11, 0xffff0000, v28
    v_lshlrev_b32 v12, 16, v29
    v_and_b32 v13, 0xffff0000, v29
    v_pk_fma_f32 v[14:15], v[8:9], v[10:11], s[12:13] op_sel_hi:[1,0,1]
    v_pk_fma_f32 v[16:17], v[8:9], v[10:11], s[14:15] op_sel:[0,1,0]
    v_pk_fma_f32 v[18:19], v[8:9], v[12:13], s[12:13] op_sel_hi:[1,0,1]
    v_pk_fma_f32 v[20:21], v[8:9], v[12:13], s[14:15] op_sel:[0,1,0]
    v_lshl_add_u32 v15, v17, 16, v15
    v_lshl_add_u32 v19, v21, 16, v19
    v_mad_u64_u32 v[14:15], vcc, v16, s18, v[14:15]
    v_mad_u64_u32 v[18:19], vcc, v20, s18, v[18:19]
    ds_add_rtn_u64 v[28:29], v22, v[14:15] offset:7392
    ds_add_rtn_u64 v[62:63], v22, v[18:19] offset:57400
    v_pk_mul_f32 v[8:9], v[22:23], s[16:17] op_sel:[1,0] op_sel_hi:[1,1]
    v_and_b32 v22, 0xfff8, v61
    v_fma_f32 v9, v8, v9, v5
    s_waitcnt vmcnt(4)
    v_lshlrev_b32 v10, 16, v30
    v_and_b32 v11, 0xffff0000, v30
    v_lshlrev_b32 v12, 16, v31
    v_and_b32 v13, 0xffff0000, v31
    v_pk_fma_f32 v[14:15], v[8:9], v[10:11], s[12:13] op_sel_hi:[1,0,1]
    v_pk_fma_f32 v[16:17], v[8:9], v[10:11], s[14:15] op_sel:[0,1,0]
    v_pk_fma_f32 v[18:19], v[8:9], v[12:13], s[12:13] op_sel_hi:[1,0,1]
    v_pk_fma_f32 v[20:21], v[8:9], v[12:13], s[14:15] op_sel:[0,1,0]
    v_lshl_add_u32 v15, v17, 16, v15
    v_lshl_add_u32 v19, v21, 16, v19
    v_mad_u64_u32 v[14:15], vcc, v16, s18, v[14:15]
    v_mad_u64_u32 v[18:19], vcc, v20, s18, v[18:19]
    ds_add_rtn_u64 v[30:31], v22, v[14:15] offset:7392
    ds_add_rtn_u64 v[60:61], v22, v[18:19] offset:57400
    v_alignbit_b32 v64, v64, v64, 9
    v_alignbit_b32 v65, v65, v65, 9
    v_and_b32 v8, 0x3ff0000, v64
    v_and_b32 v9, 0x3ff0000, v65
    v_pk_mul_f32 v[8:9], v[8:9], s[20:21] op_sel_hi:[1,0]
    v_cos_f32 v8, v8
    v_cos_f32 v23, v9
    s_waitcnt lgkmcnt(3)
    v_or3_b32 v7, v7, v28, v29
    s_waitcnt lgkmcnt(2)
    v_or3_b32 v7, v7, v62, v63
    s_waitcnt lgkmcnt(1)
    v_or3_b32 v7, v7, v30, v31
    s_waitcnt lgkmcnt(0)
    v_or3_b32 v7, v7, v60, v61
    v_pk_mul_f32 v[8:9], v[8:9], s[16:17] op_sel_hi:[0,1]
    v_and_b32 v22, 0xfff8, v64
    v_fma_f32 v9, v8, v9, v5
    s_waitcnt vmcnt(3)
    v_lshlrev_b32 v10, 16, v32
    v_and_b32 v11, 0xffff0000, v32
    v_lshlrev_b32 v12, 16, v33
    v_and_b32 v13, 0xffff0000, v33
    v_pk_fma_f32 v[14:15], v[8:9], v[10:11], s[12:13] op_sel_hi:[1,0,1]
    v_pk_fma_f32 v[16:17], v[8:9], v[10:11], s[14:15] op_sel:[0,1,0]
    v_pk_fma_f32 v[18:19], v[8:9], v[12:13], s[12:13] op_sel_hi:[1,0,1]
    v_pk_fma_f32 v[20:21], v[8:9], v[12:13], s[14:15] op_sel:[0,1,0]
    v_lshl_add_u32 v15, v17, 16, v15
    v_lshl_add_u32 v19, v21, 16, v19
    v_mad_u64_u32 v[14:15], vcc, v16, s18, v[14:15]
    v_mad_u64_u32 v[18:19], vcc, v20, s18, v[18:19]
    ds_add_rtn_u64 v[32:33], v22, v[14:15] offset:7392
    ds_add_rtn_u64 v[66:67], v22, v[18:19] offset:57400
    v_pk_mul_f32 v[8:9], v[22:23], s[16:17] op_sel:[1,0] op_sel_hi:[1,1]
    v_and_b32 v22, 0xfff8, v65
    v_fma_f32 v9, v8, v9, v5
    s_waitcnt vmcnt(2)
    v_lshlrev_b32 v10, 16, v34
    v_and_b32 v11, 0xffff0000, v34
    v_lshlrev_b32 v12, 16, v35
    v_and_b32 v13, 0xffff0000, v35
    v_pk_fma_f32 v[14:15], v[8:9], v[10:11], s[12:13] op_sel_hi:[1,0,1]
    v_pk_fma_f32 v[16:17], v[8:9], v[10:11], s[14:15] op_sel:[0,1,0]
    v_pk_fma_f32 v[18:19], v[8:9], v[12:13], s[12:13] op_sel_hi:[1,0,1]
    v_pk_fma_f32 v[20:21], v[8:9], v[12:13], s[14:15] op_sel:[0,1,0]
    v_lshl_add_u32 v15, v17, 16, v15
    v_lshl_add_u32 v19, v21, 16, v19
    v_mad_u64_u32 v[14:15], vcc, v16, s18, v[14:15]
    v_mad_u64_u32 v[18:19], vcc, v20, s18, v[18:19]
    ds_add_rtn_u64 v[34:35], v22, v[14:15] offset:7392
    ds_add_rtn_u64 v[64:65], v22, v[18:19] offset:57400
    s_waitcnt lgkmcnt(3)
    v_or3_b32 v7, v7, v32, v33
    s_waitcnt lgkmcnt(2)
    v_or3_b32 v7, v7, v66, v67
    s_waitcnt lgkmcnt(1)
    v_or3_b32 v7, v7, v34, v35
    s_waitcnt lgkmcnt(0)
    v_or3_b32 v7, v7, v64, v65
    s_sub_u32 s100, s29, 12288
    v_cmpx_gt_i32 vcc, s100, v0
    s_waitcnt vmcnt(0)
    v_and_b32 v22, v69, v27
    s_cbranch_execz .Lk3a
    v_alignbit_b32 v68, v68, v68, 9
    v_alignbit_b32 v69, v69, v69, 9
    v_and_b32 v8, 0x3ff0000, v68
    v_and_b32 v9, 0x3ff0000, v69
    v_pk_mul_f32 v[8:9], v[8:9], s[20:21] op_sel_hi:[1,0]
    v_cos_f32 v8, v8
    v_cos_f32 v23, v9
    v_pk_mul_f32 v[8:9], v[8:9], s[16:17] op_sel_hi:[0,1]
    v_and_b32 v22, 0xfff8, v68
    v_fma_f32 v9, v8, v9, v5
    v_lshlrev_b32 v10, 16, v24
    v_and_b32 v11, 0xffff0000, v24
    v_lshlrev_b32 v12, 16, v25
    v_and_b32 v13, 0xffff0000, v25
    v_pk_fma_f32 v[14:15], v[8:9], v[10:11], s[12:13] op_sel_hi:[1,0,1]
    v_pk_fma_f32 v[16:17], v[8:9], v[10:11], s[14:15] op_sel:[0,1,0]
    v_pk_fma_f32 v[18:19], v[8:9], v[12:13], s[12:13] op_sel_hi:[1,0,1]
    v_pk_fma_f32 v[20:21], v[8:9], v[12:13], s[14:15] op_sel:[0,1,0]
    v_lshl_add_u32 v15, v17, 16, v15
    v_lshl_add_u32 v19, v21, 16, v19
    v_mad_u64_u32 v[14:15], vcc, v16, s18, v[14:15]
    v_mad_u64_u32 v[18:19], vcc, v20, s18, v[18:19]
.Lk3a:
    ds_add_rtn_u64 v[24:25], v22, v[14:15] offset:7392
    ds_add_rtn_u64 v[70:71], v22, v[18:19] offset:57400
    s_cbranch_execz .Lk3b
    v_pk_mul_f32 v[8:9], v[22:23], s[16:17] op_sel:[1,0] op_sel_hi:[1,1]
    v_and_b32 v22, 0xfff8, v69
    v_fma_f32 v9, v8, v9, v5
    v_lshlrev_b32 v10, 16, v26
    v_and_b32 v11, 0xffff0000, v26
    v_lshlrev_b32 v12, 16, v27
    v_and_b32 v13, 0xffff0000, v27
    v_pk_fma_f32 v[14:15], v[8:9], v[10:11], s[12:13] op_sel_hi:[1,0,1]
    v_pk_fma_f32 v[16:17], v[8:9], v[10:11], s[14:15] op_sel:[0,1,0]
    v_pk_fma_f32 v[18:19], v[8:9], v[12:13], s[12:13] op_sel_hi:[1,0,1]
    v_pk_fma_f32 v[20:21], v[8:9], v[12:13], s[14:15] op_sel:[0,1,0]
    v_lshl_add_u32 v15, v17, 16, v15
    v_lshl_add_u32 v19, v21, 16, v19
    v_mad_u64_u32 v[14:15], vcc, v16, s18, v[14:15]
    v_mad_u64_u32 v[18:19], vcc, v20, s18, v[18:19]
.Lk3b:
    ds_add_rtn_u64 v[26:27], v22, v[14:15] offset:7392
    ds_add_rtn_u64 v[68:69], v22, v[18:19] offset:57400
    s_mov_b64 exec, -1
    s_setprio 3
    s_sub_u32 s100, s29, 12288
    v_cmpx_gt_i32 vcc, s100, v0
    s_waitcnt lgkmcnt(3)
    v_or3_b32 v7, v7, v24, v25
    s_waitcnt lgkmcnt(2)
    v_or3_b32 v7, v7, v70, v71
    s_waitcnt lgkmcnt(1)
    v_or3_b32 v7, v7, v26, v27
    s_waitcnt lgkmcnt(0)
    v_or3_b32 v7, v7, v68, v69
    s_mov_b64 exec, -1
    v_and_b32 v23, 0x80008000, v7
    v_cmp_ne_u32 vcc, 0, v23
    s_nop 1
    s_cbranch_vccz .Ldg0
    ds_write_b32 v3, v3 offset:830
.Ldg0:
    s_xor_b32 s100, s25, 1
    s_mul_i32 s101, s100, 50176
    s_mul_i32 s3, s25, 50176
    s_add_u32 s8, s4, s101
    s_addc_u32 s9, s5, 0
    s_add_u32 s8, s8, 117440512
    s_addc_u32 s9, s9, 0
    s_mov_b32 s10, 50176
    s_mov_b32 s11, 0x00020000
    s_add_u32 s12, s4, s3
    s_addc_u32 s13, s5, 0
    s_add_u32 s12, s12, 117440512
    s_addc_u32 s13, s13, 0
    s_mov_b32 s14, 50000
    s_mov_b32 s15, 0x00020000
    s_add_u32 s16, s4, 86016000
    s_addc_u32 s17, s5, 0
    s_mov_b32 s18, 32768
    s_mov_b32 s19, 0x00020000
    s_and_b32 s100, s100, 1
    s_mul_i32 s100, s100, 25000
    s_add_u32 s100, s100, 7400
    v_lshl_add_u32 v40, v1, 1, s100
    v_add_u32 v41, 50008, v40
    v_lshlrev_b32 v43, 2, v1
    s_waitcnt lgkmcnt(0)
    s_barrier
    ds_read_b64 v[44:45], v40 offset:0
    ds_read_b64 v[46:47], v41 offset:0
    ds_read_b64 v[48:49], v40 offset:8192
    ds_read_b64 v[50:51], v41 offset:8192
    ds_read_b64 v[52:53], v40 offset:16384
    ds_read_b64 v[54:55], v41 offset:16384
    ds_read_b64 v[56:57], v40 offset:24576
    ds_read_b64 v[58:59], v41 offset:24576
    s_mov_b32 s100, 0
    s_waitcnt lgkmcnt(6)
    buffer_store_dwordx4 v[44:47], v43, s[8:11], s100 offen sc1
    s_mov_b32 s100, 16384
    s_waitcnt lgkmcnt(4)
    buffer_store_dwordx4 v[48:51], v43, s[8:11], s100 offen sc1
    s_mov_b32 s100, 32768
    s_waitcnt lgkmcnt(2)
    buffer_store_dwordx4 v[52:55], v43, s[8:11], s100 offen sc1
    s_waitcnt lgkmcnt(0)
    s_cmp_lg_u32 s24, 0
    s_cbranch_scc1 .Lxs3
    s_mov_b32 s100, 49152
    buffer_store_dwordx4 v[56:59], v43, s[8:11], s100 offen sc1
.Lxs3:
    ds_read_b32 v24, v3 offset:830
    s_and_b32 s100, s25, 1
    s_mul_i32 s100, s100, 25000
    s_add_u32 s100, s100, 7400
    v_lshl_add_u32 v40, v1, 1, s100
    v_add_u32 v41, 50008, v40
    ds_read_b64 v[60:61], v40 offset:0
    ds_read_b64 v[62:63], v41 offset:0
    ds_read_b64 v[64:65], v40 offset:8192
    ds_read_b64 v[66:67], v41 offset:8192
    ds_read_b64 v[68:69], v40 offset:16384
    ds_read_b64 v[70:71], v41 offset:16384
    v_or3_b32 v7, v7, v44, v45
    v_or3_b32 v7, v7, v46, v47
    v_or3_b32 v7, v7, v48, v49
    v_or3_b32 v7, v7, v50, v51
    v_or3_b32 v7, v7, v52, v53
    v_or3_b32 v7, v7, v54, v55
    v_cmpx_gt_u32 vcc, 212, v1
    v_or3_b32 v7, v7, v56, v57
    v_or3_b32 v7, v7, v58, v59
    s_mov_b64 exec, -1
    s_waitcnt lgkmcnt(5)
    v_or3_b32 v7, v7, v60, v61
    s_waitcnt lgkmcnt(4)
    v_or3_b32 v7, v7, v62, v63
    s_waitcnt lgkmcnt(3)
    v_or3_b32 v7, v7, v64, v65
    s_waitcnt lgkmcnt(2)
    v_or3_b32 v7, v7, v66, v67
    s_waitcnt lgkmcnt(1)
    v_or3_b32 v7, v7, v68, v69
    s_waitcnt lgkmcnt(0)
    v_or3_b32 v7, v7, v70, v71
    v_xor_b32 v60, 0x80008000, v60
    v_xor_b32 v61, 0x80008000, v61
    v_xor_b32 v62, 0x80008000, v62
    v_xor_b32 v63, 0x80008000, v63
    v_xor_b32 v64, 0x80008000, v64
    v_xor_b32 v65, 0x80008000, v65
    v_xor_b32 v66, 0x80008000, v66
    v_xor_b32 v67, 0x80008000, v67
    v_xor_b32 v68, 0x80008000, v68
    v_xor_b32 v69, 0x80008000, v69
    v_xor_b32 v70, 0x80008000, v70
    v_xor_b32 v71, 0x80008000, v71
    s_load_dwordx8 s[84:91], s[96:97], 0
    s_load_dwordx8 s[92:99], s[98:99], 0
    v_and_b32 v23, 0x80008000, v7
    v_cmp_ne_u32 vcc, 0, v23
    s_mul_i32 s26, s25, 128
    s_lshl2_add_u32 s26, s24, s26
    s_xor_b32 s28, s25, 1
    s_mul_i32 s28, s28, 128
    s_lshl2_add_u32 s28, s24, s28
    s_cmp_lg_u64 vcc, 0
    s_cselect_b32 s100, 3, 1
    v_or_b32 v24, s100, v24
    s_setprio 2
    v_lshlrev_b32 v36, 16, v36
    v_mul_f32 v36, 0x40731710, v36
    v_mov_b32 v14, v36
    v_add_f32 v15, 0xbf0aa327, v36
    v_add_f32 v16, 0xbf8aa327, v36
    v_add_f32 v17, 0xbfcff4ba, v36
    v_add_f32 v18, 0xc00aa327, v36
    v_add_f32 v19, 0xc02dc57c, v36
    v_add_f32 v20, 0xc04ff4ba, v36
    v_add_f32 v21, 0xc0731710, v36
    v_mul_f32 v14, v14, v14
    v_mul_f32 v15, v15, v15
    v_mul_f32 v16, v16, v16
    v_mul_f32 v17, v17, v17
    v_mul_f32 v18, v18, v18
    v_mul_f32 v19, v19, v19
    v_mul_f32 v20, v20, v20
    v_mul_f32 v21, v21, v21
    v_exp_f32_e64 v14, -v14
    v_exp_f32_e64 v15, -v15
    v_exp_f32_e64 v16, -v16
    v_exp_f32_e64 v17, -v17
    v_exp_f32_e64 v18, -v18
    v_exp_f32_e64 v19, -v19
    v_exp_f32_e64 v20, -v20
    v_exp_f32_e64 v21, -v21
    v_cvt_pk_bf16_f32 v10, v14, v15
    v_cvt_pk_bf16_f32 v11, v16, v17
    v_cvt_pk_bf16_f32 v12, v18, v19
    v_cvt_pk_bf16_f32 v13, v20, v21
    v_dot2_f32_bf16 v72, v10, s52, 0
    v_dot2_f32_bf16 v73, v10, s56, 0
    v_dot2_f32_bf16 v74, v10, s53, 0
    v_dot2_f32_bf16 v75, v10, s57, 0
    v_dot2_f32_bf16 v76, v10, s54, 0
    v_dot2_f32_bf16 v77, v10, s58, 0
    v_dot2_f32_bf16 v78, v10, s55, 0
    v_dot2_f32_bf16 v79, v10, s59, 0
    v_dot2_f32_bf16 v80, v10, s36, 0
    v_dot2_f32_bf16 v81, v10, s38, 0
    v_dot2_f32_bf16 v82, v10, s37, 0
    v_dot2_f32_bf16 v83, v10, s39, 0
    v_dot2_f32_bf16 v72, v11, s60, v72
    v_dot2_f32_bf16 v73, v11, s64, v73
    v_dot2_f32_bf16 v74, v11, s61, v74
    v_dot2_f32_bf16 v75, v11, s65, v75
    v_dot2_f32_bf16 v76, v11, s62, v76
    v_dot2_f32_bf16 v77, v11, s66, v77
    v_dot2_f32_bf16 v78, v11, s63, v78
    v_dot2_f32_bf16 v79, v11, s67, v79
    v_dot2_f32_bf16 v80, v11, s40, v80
    v_dot2_f32_bf16 v81, v11, s42, v81
    v_dot2_f32_bf16 v82, v11, s41, v82
    v_dot2_f32_bf16 v83, v11, s43, v83
    v_dot2_f32_bf16 v72, v12, s68, v72
    v_dot2_f32_bf16 v73, v12, s72, v73
    v_dot2_f32_bf16 v74, v12, s69, v74
    v_dot2_f32_bf16 v75, v12, s73, v75
    v_dot2_f32_bf16 v76, v12, s70, v76
    v_dot2_f32_bf16 v77, v12, s74, v77
    v_dot2_f32_bf16 v78, v12, s71, v78
    v_dot2_f32_bf16 v79, v12, s75, v79
    v_dot2_f32_bf16 v80, v12, s44, v80
    v_dot2_f32_bf16 v81, v12, s46, v81
    v_dot2_f32_bf16 v82, v12, s45, v82
    v_dot2_f32_bf16 v83, v12, s47, v83
    v_dot2_f32_bf16 v72, v13, s76, v72
    v_dot2_f32_bf16 v73, v13, s80, v73
    v_dot2_f32_bf16 v74, v13, s77, v74
    v_dot2_f32_bf16 v75, v13, s81, v75
    v_dot2_f32_bf16 v76, v13, s78, v76
    v_dot2_f32_bf16 v77, v13, s82, v77
    v_dot2_f32_bf16 v78, v13, s79, v78
    v_dot2_f32_bf16 v79, v13, s83, v79
    v_dot2_f32_bf16 v80, v13, s48, v80
    v_dot2_f32_bf16 v81, v13, s50, v81
    v_dot2_f32_bf16 v82, v13, s49, v82
    v_dot2_f32_bf16 v83, v13, s51, v83
    s_setprio 3
    s_waitcnt vmcnt(0)
    s_mov_b64 exec, 1
    buffer_store_dword v24, off, s[16:19], s26 sc1
    s_mov_b64 exec, -1
    global_load_dwordx2 v[120:121], v120, s[22:23]
    global_load_dwordx2 v[122:123], v122, s[22:23]
    global_load_dwordx2 v[124:125], v124, s[22:23]
    global_load_dwordx2 v[126:127], v126, s[22:23]
    s_setprio 1
    v_lshlrev_b32 v37, 16, v37
    v_mul_f32 v37, 0x40731710, v37
    v_mov_b32 v14, v37
    v_add_f32 v15, 0xbf0aa327, v37
    v_add_f32 v16, 0xbf8aa327, v37
    v_add_f32 v17, 0xbfcff4ba, v37
    v_add_f32 v18, 0xc00aa327, v37
    v_add_f32 v19, 0xc02dc57c, v37
    v_add_f32 v20, 0xc04ff4ba, v37
    v_add_f32 v21, 0xc0731710, v37
    v_mul_f32 v14, v14, v14
    v_mul_f32 v15, v15, v15
    v_mul_f32 v16, v16, v16
    v_mul_f32 v17, v17, v17
    v_mul_f32 v18, v18, v18
    v_mul_f32 v19, v19, v19
    v_mul_f32 v20, v20, v20
    v_mul_f32 v21, v21, v21
    v_exp_f32_e64 v14, -v14
    v_exp_f32_e64 v15, -v15
    v_exp_f32_e64 v16, -v16
    v_exp_f32_e64 v17, -v17
    v_exp_f32_e64 v18, -v18
    v_exp_f32_e64 v19, -v19
    v_exp_f32_e64 v20, -v20
    v_exp_f32_e64 v21, -v21
    v_cvt_pk_bf16_f32 v10, v14, v15
    v_cvt_pk_bf16_f32 v11, v16, v17
    v_cvt_pk_bf16_f32 v12, v18, v19
    v_cvt_pk_bf16_f32 v13, v20, v21
    v_dot2_f32_bf16 v84, v10, s52, 0
    v_dot2_f32_bf16 v85, v10, s56, 0
    v_dot2_f32_bf16 v86, v10, s53, 0
    v_dot2_f32_bf16 v87, v10, s57, 0
    v_dot2_f32_bf16 v88, v10, s54, 0
    v_dot2_f32_bf16 v89, v10, s58, 0
    v_dot2_f32_bf16 v90, v10, s55, 0
    v_dot2_f32_bf16 v91, v10, s59, 0
    v_dot2_f32_bf16 v92, v10, s36, 0
    v_dot2_f32_bf16 v93, v10, s38, 0
    v_dot2_f32_bf16 v94, v10, s37, 0
    v_dot2_f32_bf16 v95, v10, s39, 0
    v_dot2_f32_bf16 v84, v11, s60, v84
    v_dot2_f32_bf16 v85, v11, s64, v85
    v_dot2_f32_bf16 v86, v11, s61, v86
    v_dot2_f32_bf16 v87, v11, s65, v87
    v_dot2_f32_bf16 v88, v11, s62, v88
    v_dot2_f32_bf16 v89, v11, s66, v89
    v_dot2_f32_bf16 v90, v11, s63, v90
    v_dot2_f32_bf16 v91, v11, s67, v91
    v_dot2_f32_bf16 v92, v11, s40, v92
    v_dot2_f32_bf16 v93, v11, s42, v93
    v_dot2_f32_bf16 v94, v11, s41, v94
    v_dot2_f32_bf16 v95, v11, s43, v95
    v_dot2_f32_bf16 v84, v12, s68, v84
    v_dot2_f32_bf16 v85, v12, s72, v85
    v_dot2_f32_bf16 v86, v12, s69, v86
    v_dot2_f32_bf16 v87, v12, s73, v87
    v_dot2_f32_bf16 v88, v12, s70, v88
    v_dot2_f32_bf16 v89, v12, s74, v89
    v_dot2_f32_bf16 v90, v12, s71, v90
    v_dot2_f32_bf16 v91, v12, s75, v91
    v_dot2_f32_bf16 v92, v12, s44, v92
    v_dot2_f32_bf16 v93, v12, s46, v93
    v_dot2_f32_bf16 v94, v12, s45, v94
    v_dot2_f32_bf16 v95, v12, s47, v95
    v_dot2_f32_bf16 v84, v13, s76, v84
    v_dot2_f32_bf16 v85, v13, s80, v85
    v_dot2_f32_bf16 v86, v13, s77, v86
    v_dot2_f32_bf16 v87, v13, s81, v87
    v_dot2_f32_bf16 v88, v13, s78, v88
    v_dot2_f32_bf16 v89, v13, s82, v89
    v_dot2_f32_bf16 v90, v13, s79, v90
    v_dot2_f32_bf16 v91, v13, s83, v91
    v_dot2_f32_bf16 v92, v13, s48, v92
    v_dot2_f32_bf16 v93, v13, s50, v93
    v_dot2_f32_bf16 v94, v13, s49, v94
    v_dot2_f32_bf16 v95, v13, s51, v95
    s_setprio 0
    v_lshlrev_b32 v38, 16, v38
    v_mul_f32 v38, 0x40731710, v38
    v_mov_b32 v14, v38
    v_add_f32 v15, 0xbf0aa327, v38
    v_add_f32 v16, 0xbf8aa327, v38
    v_add_f32 v17, 0xbfcff4ba, v38
    v_add_f32 v18, 0xc00aa327, v38
    v_add_f32 v19, 0xc02dc57c, v38
    v_add_f32 v20, 0xc04ff4ba, v38
    v_add_f32 v21, 0xc0731710, v38
    v_mul_f32 v14, v14, v14
    v_mul_f32 v15, v15, v15
    v_mul_f32 v16, v16, v16
    v_mul_f32 v17, v17, v17
    v_mul_f32 v18, v18, v18
    v_mul_f32 v19, v19, v19
    v_mul_f32 v20, v20, v20
    v_mul_f32 v21, v21, v21
    v_exp_f32_e64 v14, -v14
    v_exp_f32_e64 v15, -v15
    v_exp_f32_e64 v16, -v16
    v_exp_f32_e64 v17, -v17
    v_exp_f32_e64 v18, -v18
    v_exp_f32_e64 v19, -v19
    v_exp_f32_e64 v20, -v20
    v_exp_f32_e64 v21, -v21
    v_cvt_pk_bf16_f32 v10, v14, v15
    v_cvt_pk_bf16_f32 v11, v16, v17
    v_cvt_pk_bf16_f32 v12, v18, v19
    v_cvt_pk_bf16_f32 v13, v20, v21
    v_dot2_f32_bf16 v96, v10, s52, 0
    v_dot2_f32_bf16 v97, v10, s56, 0
    v_dot2_f32_bf16 v98, v10, s53, 0
    v_dot2_f32_bf16 v99, v10, s57, 0
    v_dot2_f32_bf16 v100, v10, s54, 0
    v_dot2_f32_bf16 v101, v10, s58, 0
    v_dot2_f32_bf16 v102, v10, s55, 0
    v_dot2_f32_bf16 v103, v10, s59, 0
    v_dot2_f32_bf16 v104, v10, s36, 0
    v_dot2_f32_bf16 v105, v10, s38, 0
    v_dot2_f32_bf16 v106, v10, s37, 0
    v_dot2_f32_bf16 v107, v10, s39, 0
    v_dot2_f32_bf16 v96, v11, s60, v96
    v_dot2_f32_bf16 v97, v11, s64, v97
    v_dot2_f32_bf16 v98, v11, s61, v98
    v_dot2_f32_bf16 v99, v11, s65, v99
    v_dot2_f32_bf16 v100, v11, s62, v100
    v_dot2_f32_bf16 v101, v11, s66, v101
    v_dot2_f32_bf16 v102, v11, s63, v102
    v_dot2_f32_bf16 v103, v11, s67, v103
    v_dot2_f32_bf16 v104, v11, s40, v104
    v_dot2_f32_bf16 v105, v11, s42, v105
    v_dot2_f32_bf16 v106, v11, s41, v106
    v_dot2_f32_bf16 v107, v11, s43, v107
    v_dot2_f32_bf16 v96, v12, s68, v96
    v_dot2_f32_bf16 v97, v12, s72, v97
    v_dot2_f32_bf16 v98, v12, s69, v98
    v_dot2_f32_bf16 v99, v12, s73, v99
    v_dot2_f32_bf16 v100, v12, s70, v100
    v_dot2_f32_bf16 v101, v12, s74, v101
    v_dot2_f32_bf16 v102, v12, s71, v102
    v_dot2_f32_bf16 v103, v12, s75, v103
    v_dot2_f32_bf16 v104, v12, s44, v104
    v_dot2_f32_bf16 v105, v12, s46, v105
    v_dot2_f32_bf16 v106, v12, s45, v106
    v_dot2_f32_bf16 v107, v12, s47, v107
    v_dot2_f32_bf16 v96, v13, s76, v96
    v_dot2_f32_bf16 v97, v13, s80, v97
    v_dot2_f32_bf16 v98, v13, s77, v98
    v_dot2_f32_bf16 v99, v13, s81, v99
    v_dot2_f32_bf16 v100, v13, s78, v100
    v_dot2_f32_bf16 v101, v13, s82, v101
    v_dot2_f32_bf16 v102, v13, s79, v102
    v_dot2_f32_bf16 v103, v13, s83, v103
    v_dot2_f32_bf16 v104, v13, s48, v104
    v_dot2_f32_bf16 v105, v13, s50, v105
    v_dot2_f32_bf16 v106, v13, s49, v106
    v_dot2_f32_bf16 v107, v13, s51, v107
    s_setprio 3
    ds_read_b64 v[36:37], v40 offset:24576
    ds_read_b64 v[40:41], v41 offset:24576
    v_cmpx_gt_u32 vcc, 212, v1
    s_waitcnt lgkmcnt(0)
    v_or3_b32 v7, v7, v36, v37
    v_or3_b32 v7, v7, v40, v41
    s_mov_b64 exec, -1
    v_and_b32 v23, 0x80008000, v7
    v_cmp_ne_u32 vcc, 0, v23
    s_nop 1
    s_cbranch_vccz .Ldg1
    ds_write_b32 v3, v3 offset:830
.Ldg1:
    s_mov_b32 s101, s28
    s_mov_b64 exec, 1
    s_mov_b32 s3, 1048576
.Lpoll:
    buffer_load_dword v9, off, s[16:19], s101 sc1
    s_sub_u32 s3, s3, 1
    s_cbranch_scc1 .Lpolly
    s_waitcnt vmcnt(0)
    v_cmp_eq_u32 vcc, 0, v9
    s_nop 1
    s_cbranch_vccnz .Lpoll
.Lpolly:
    s_waitcnt vmcnt(0)
    s_mov_b64 exec, -1
    s_cmp_lg_u32 s24, 0
    s_cbranch_scc1 .Lxl3
    s_mov_b32 s100, 49152
    buffer_load_dwordx4 v[56:59], v43, s[12:15], s100 offen sc1
.Lxl3:
    s_mov_b32 s100, 0
    buffer_load_dwordx4 v[44:47], v43, s[12:15], s100 offen sc1
    s_mov_b32 s100, 16384
    buffer_load_dwordx4 v[48:51], v43, s[12:15], s100 offen sc1
    s_mov_b32 s100, 32768
    buffer_load_dwordx4 v[52:55], v43, s[12:15], s100 offen sc1
    s_mov_b64 exec, 1
    v_cmpx_ne_u32 vcc, 1, v9
    ds_write_b32 v3, v3 offset:830
    s_mov_b64 exec, -1
    v_mov_b32 v32, s84
    v_mov_b32 v33, s86
    v_mov_b32 v34, s88
    v_mov_b32 v35, s90
    v_mov_b32 v2, s92
    v_mov_b32 v4, s94
    v_mov_b32 v5, s96
    v_mov_b32 v6, s98
    v_and_b32 v23, 4, v1
    v_lshlrev_b32 v23, 2, v23
    v_xor_b32 v23, 16, v23
    s_mov_b32 exec_lo, 0xcccccccc
    s_mov_b32 exec_hi, 0xcccccccc
    v_mov_b32 v32, s85
    v_mov_b32 v33, s87
    v_mov_b32 v34, s89
    v_mov_b32 v35, s91
    v_mov_b32 v2, s93
    v_mov_b32 v4, s95
    v_mov_b32 v5, s97
    v_mov_b32 v6, s99
    s_mov_b64 exec, -1
    v_lshlrev_b32 v32, v23, v32
    v_lshlrev_b32 v33, v23, v33
    v_lshlrev_b32 v34, v23, v34
    v_lshlrev_b32 v35, v23, v35
    v_lshlrev_b32 v2, v23, v2
    v_lshlrev_b32 v4, v23, v4
    v_lshlrev_b32 v5, v23, v5
    v_lshlrev_b32 v6, v23, v6
    v_and_b32 v32, 0xffff0000, v32
    v_and_b32 v33, 0xffff0000, v33
    v_and_b32 v34, 0xffff0000, v34
    v_and_b32 v35, 0xffff0000, v35
    v_and_b32 v2, 0xffff0000, v2
    v_and_b32 v4, 0xffff0000, v4
    v_and_b32 v5, 0xffff0000, v5
    v_and_b32 v6, 0xffff0000, v6
    v_mul_f32 v32, s21, v32
    v_mul_f32 v33, s21, v33
    v_mul_f32 v34, s21, v34
    v_mul_f32 v35, s21, v35
    v_xor_b32 v36, 0x80008000, v36
    v_xor_b32 v37, 0x80008000, v37
    v_xor_b32 v40, 0x80008000, v40
    v_xor_b32 v41, 0x80008000, v41
    v_lshlrev_b32 v39, 1, v1
    s_add_u32 s12, s32, 0
    s_addc_u32 s13, s33, 0
    s_add_u32 s14, s32, 8192
    s_addc_u32 s15, s33, 0
    s_add_u32 s16, s32, 16384
    s_addc_u32 s17, s33, 0
    s_add_u32 s18, s32, 24576
    s_addc_u32 s19, s33, 0
    s_waitcnt vmcnt(2)
    v_pk_add_u16 v44, v60, v44
    v_pk_add_u16 v45, v61, v45
    v_pk_add_u16 v46, v62, v46
    v_pk_add_u16 v47, v63, v47
    v_cvt_f32_i32_sdwa v8, sext(v44) dst_sel:DWORD dst_unused:UNUSED_PAD src0_sel:WORD_0
    v_cvt_f32_i32_sdwa v12, sext(v45) dst_sel:DWORD dst_unused:UNUSED_PAD src0_sel:WORD_0
    v_cvt_f32_i32_sdwa v9, sext(v44) dst_sel:DWORD dst_unused:UNUSED_PAD src0_sel:WORD_1
    v_cvt_f32_i32_sdwa v13, sext(v45) dst_sel:DWORD dst_unused:UNUSED_PAD src0_sel:WORD_1
    v_mfma_f32_4x4x1_16b_f32 v[16:19], v32, v8, 0
    v_mfma_f32_4x4x1_16b_f32 v[20:23], v32, v12, 0
    v_cvt_f32_i32_sdwa v10, sext(v46) dst_sel:DWORD dst_unused:UNUSED_PAD src0_sel:WORD_0
    v_cvt_f32_i32_sdwa v14, sext(v47) dst_sel:DWORD dst_unused:UNUSED_PAD src0_sel:WORD_0
    v_mfma_f32_4x4x1_16b_f32 v[16:19], v33, v9, v[16:19]
    v_mfma_f32_4x4x1_16b_f32 v[20:23], v33, v13, v[20:23]
    v_cvt_f32_i32_sdwa v11, sext(v46) dst_sel:DWORD dst_unused:UNUSED_PAD src0_sel:WORD_1
    v_cvt_f32_i32_sdwa v15, sext(v47) dst_sel:DWORD dst_unused:UNUSED_PAD src0_sel:WORD_1
    v_mfma_f32_4x4x1_16b_f32 v[16:19], v34, v10, v[16:19]
    v_mfma_f32_4x4x1_16b_f32 v[20:23], v34, v14, v[20:23]
    v_lshlrev_b32 v44, 16, v120
    v_mfma_f32_4x4x1_16b_f32 v[16:19], v35, v11, v[16:19]
    v_mfma_f32_4x4x1_16b_f32 v[20:23], v35, v15, v[20:23]
    v_and_b32 v45, 0xffff0000, v120
    v_lshlrev_b32 v46, 16, v121
    v_and_b32 v47, 0xffff0000, v121
    v_mul_f32 v24, v72, v16
    v_mul_f32 v25, v73, v17
    v_mul_f32 v26, v74, v18
    v_mul_f32 v27, v75, v19
    v_fmac_f32 v24, v76, v20
    v_fmac_f32 v25, v77, v21
    v_fmac_f32 v26, v78, v22
    v_fmac_f32 v27, v79, v23
    v_mfma_f32_4x4x1_16b_f32 v[28:31], v2, v24, 0
    s_nop 1
    v_mfma_f32_4x4x1_16b_f32 v[28:31], v4, v25, v[28:31]
    s_nop 1
    v_mfma_f32_4x4x1_16b_f32 v[28:31], v5, v26, v[28:31]
    s_nop 1
    v_mfma_f32_4x4x1_16b_f32 v[28:31], v6, v27, v[28:31]
    s_nop 3
    v_fmac_f32 v44, v28, v80
    v_fmac_f32 v45, v29, v81
    v_fmac_f32 v46, v30, v82
    v_fmac_f32 v47, v31, v83
    v_cvt_pk_bf16_f32 v120, v44, v45
    v_cvt_pk_bf16_f32 v121, v46, v47
    global_store_dwordx2 v39, v[120:121], s[12:13]
    s_waitcnt vmcnt(2)
    v_pk_add_u16 v48, v64, v48
    v_pk_add_u16 v49, v65, v49
    v_pk_add_u16 v50, v66, v50
    v_pk_add_u16 v51, v67, v51
    v_cvt_f32_i32_sdwa v8, sext(v48) dst_sel:DWORD dst_unused:UNUSED_PAD src0_sel:WORD_0
    v_cvt_f32_i32_sdwa v12, sext(v49) dst_sel:DWORD dst_unused:UNUSED_PAD src0_sel:WORD_0
    v_cvt_f32_i32_sdwa v9, sext(v48) dst_sel:DWORD dst_unused:UNUSED_PAD src0_sel:WORD_1
    v_cvt_f32_i32_sdwa v13, sext(v49) dst_sel:DWORD dst_unused:UNUSED_PAD src0_sel:WORD_1
    v_mfma_f32_4x4x1_16b_f32 v[16:19], v32, v8, 0
    v_mfma_f32_4x4x1_16b_f32 v[20:23], v32, v12, 0
    v_cvt_f32_i32_sdwa v10, sext(v50) dst_sel:DWORD dst_unused:UNUSED_PAD src0_sel:WORD_0
    v_cvt_f32_i32_sdwa v14, sext(v51) dst_sel:DWORD dst_unused:UNUSED_PAD src0_sel:WORD_0
    v_mfma_f32_4x4x1_16b_f32 v[16:19], v33, v9, v[16:19]
    v_mfma_f32_4x4x1_16b_f32 v[20:23], v33, v13, v[20:23]
    v_cvt_f32_i32_sdwa v11, sext(v50) dst_sel:DWORD dst_unused:UNUSED_PAD src0_sel:WORD_1
    v_cvt_f32_i32_sdwa v15, sext(v51) dst_sel:DWORD dst_unused:UNUSED_PAD src0_sel:WORD_1
    v_mfma_f32_4x4x1_16b_f32 v[16:19], v34, v10, v[16:19]
    v_mfma_f32_4x4x1_16b_f32 v[20:23], v34, v14, v[20:23]
    v_lshlrev_b32 v48, 16, v122
    v_mfma_f32_4x4x1_16b_f32 v[16:19], v35, v11, v[16:19]
    v_mfma_f32_4x4x1_16b_f32 v[20:23], v35, v15, v[20:23]
    v_and_b32 v49, 0xffff0000, v122
    v_lshlrev_b32 v50, 16, v123
    v_and_b32 v51, 0xffff0000, v123
    v_mul_f32 v24, v84, v16
    v_mul_f32 v25, v85, v17
    v_mul_f32 v26, v86, v18
    v_mul_f32 v27, v87, v19
    v_fmac_f32 v24, v88, v20
    v_fmac_f32 v25, v89, v21
    v_fmac_f32 v26, v90, v22
    v_fmac_f32 v27, v91, v23
    v_mfma_f32_4x4x1_16b_f32 v[28:31], v2, v24, 0
    s_nop 1
    v_mfma_f32_4x4x1_16b_f32 v[28:31], v4, v25, v[28:31]
    s_nop 1
    v_mfma_f32_4x4x1_16b_f32 v[28:31], v5, v26, v[28:31]
    s_nop 1
    v_mfma_f32_4x4x1_16b_f32 v[28:31], v6, v27, v[28:31]
    s_nop 3
    v_fmac_f32 v48, v28, v92
    v_fmac_f32 v49, v29, v93
    v_fmac_f32 v50, v30, v94
    v_fmac_f32 v51, v31, v95
    v_cvt_pk_bf16_f32 v122, v48, v49
    v_cvt_pk_bf16_f32 v123, v50, v51
    global_store_dwordx2 v39, v[122:123], s[14:15]
    s_waitcnt vmcnt(2)
    v_pk_add_u16 v52, v68, v52
    v_pk_add_u16 v53, v69, v53
    v_pk_add_u16 v54, v70, v54
    v_pk_add_u16 v55, v71, v55
    v_cvt_f32_i32_sdwa v8, sext(v52) dst_sel:DWORD dst_unused:UNUSED_PAD src0_sel:WORD_0
    v_cvt_f32_i32_sdwa v12, sext(v53) dst_sel:DWORD dst_unused:UNUSED_PAD src0_sel:WORD_0
    v_cvt_f32_i32_sdwa v9, sext(v52) dst_sel:DWORD dst_unused:UNUSED_PAD src0_sel:WORD_1
    v_cvt_f32_i32_sdwa v13, sext(v53) dst_sel:DWORD dst_unused:UNUSED_PAD src0_sel:WORD_1
    v_mfma_f32_4x4x1_16b_f32 v[16:19], v32, v8, 0
    v_mfma_f32_4x4x1_16b_f32 v[20:23], v32, v12, 0
    v_cvt_f32_i32_sdwa v10, sext(v54) dst_sel:DWORD dst_unused:UNUSED_PAD src0_sel:WORD_0
    v_cvt_f32_i32_sdwa v14, sext(v55) dst_sel:DWORD dst_unused:UNUSED_PAD src0_sel:WORD_0
    v_mfma_f32_4x4x1_16b_f32 v[16:19], v33, v9, v[16:19]
    v_mfma_f32_4x4x1_16b_f32 v[20:23], v33, v13, v[20:23]
    v_cvt_f32_i32_sdwa v11, sext(v54) dst_sel:DWORD dst_unused:UNUSED_PAD src0_sel:WORD_1
    v_cvt_f32_i32_sdwa v15, sext(v55) dst_sel:DWORD dst_unused:UNUSED_PAD src0_sel:WORD_1
    v_mfma_f32_4x4x1_16b_f32 v[16:19], v34, v10, v[16:19]
    v_mfma_f32_4x4x1_16b_f32 v[20:23], v34, v14, v[20:23]
    v_lshlrev_b32 v52, 16, v124
    v_mfma_f32_4x4x1_16b_f32 v[16:19], v35, v11, v[16:19]
    v_mfma_f32_4x4x1_16b_f32 v[20:23], v35, v15, v[20:23]
    v_and_b32 v53, 0xffff0000, v124
    v_lshlrev_b32 v54, 16, v125
    v_and_b32 v55, 0xffff0000, v125
    v_mul_f32 v24, v96, v16
    v_mul_f32 v25, v97, v17
    v_mul_f32 v26, v98, v18
    v_mul_f32 v27, v99, v19
    v_fmac_f32 v24, v100, v20
    v_fmac_f32 v25, v101, v21
    v_fmac_f32 v26, v102, v22
    v_fmac_f32 v27, v103, v23
    v_mfma_f32_4x4x1_16b_f32 v[28:31], v2, v24, 0
    s_nop 1
    v_mfma_f32_4x4x1_16b_f32 v[28:31], v4, v25, v[28:31]
    s_nop 1
    v_mfma_f32_4x4x1_16b_f32 v[28:31], v5, v26, v[28:31]
    s_nop 1
    v_mfma_f32_4x4x1_16b_f32 v[28:31], v6, v27, v[28:31]
    s_nop 3
    v_fmac_f32 v52, v28, v104
    v_fmac_f32 v53, v29, v105
    v_fmac_f32 v54, v30, v106
    v_fmac_f32 v55, v31, v107
    v_cvt_pk_bf16_f32 v124, v52, v53
    v_cvt_pk_bf16_f32 v125, v54, v55
    global_store_dwordx2 v39, v[124:125], s[16:17]
    s_cmp_lg_u32 s24, 0
    s_cbranch_scc1 .Lt3f
    s_bfm_b64 exec, 53, 0
    v_pk_add_u16 v56, v36, v56
    v_pk_add_u16 v57, v37, v57
    v_pk_add_u16 v58, v40, v58
    v_pk_add_u16 v59, v41, v59
    v_cvt_f32_i32_sdwa v8, sext(v56) dst_sel:DWORD dst_unused:UNUSED_PAD src0_sel:WORD_0
    v_cvt_f32_i32_sdwa v12, sext(v57) dst_sel:DWORD dst_unused:UNUSED_PAD src0_sel:WORD_0
    v_cvt_f32_i32_sdwa v9, sext(v56) dst_sel:DWORD dst_unused:UNUSED_PAD src0_sel:WORD_1
    v_cvt_f32_i32_sdwa v13, sext(v57) dst_sel:DWORD dst_unused:UNUSED_PAD src0_sel:WORD_1
    v_mfma_f32_4x4x1_16b_f32 v[16:19], v32, v8, 0
    v_mfma_f32_4x4x1_16b_f32 v[20:23], v32, v12, 0
    v_cvt_f32_i32_sdwa v10, sext(v58) dst_sel:DWORD dst_unused:UNUSED_PAD src0_sel:WORD_0
    v_cvt_f32_i32_sdwa v14, sext(v59) dst_sel:DWORD dst_unused:UNUSED_PAD src0_sel:WORD_0
    v_mfma_f32_4x4x1_16b_f32 v[16:19], v33, v9, v[16:19]
    v_mfma_f32_4x4x1_16b_f32 v[20:23], v33, v13, v[20:23]
    v_cvt_f32_i32_sdwa v11, sext(v58) dst_sel:DWORD dst_unused:UNUSED_PAD src0_sel:WORD_1
    v_cvt_f32_i32_sdwa v15, sext(v59) dst_sel:DWORD dst_unused:UNUSED_PAD src0_sel:WORD_1
    v_mfma_f32_4x4x1_16b_f32 v[16:19], v34, v10, v[16:19]
    v_mfma_f32_4x4x1_16b_f32 v[20:23], v34, v14, v[20:23]
    v_lshlrev_b32 v56, 16, v126
    v_mfma_f32_4x4x1_16b_f32 v[16:19], v35, v11, v[16:19]
    v_mfma_f32_4x4x1_16b_f32 v[20:23], v35, v15, v[20:23]
    v_and_b32 v57, 0xffff0000, v126
    v_lshlrev_b32 v58, 16, v127
    v_and_b32 v59, 0xffff0000, v127
    v_mul_f32 v24, v108, v16
    v_mul_f32 v25, v109, v17
    v_mul_f32 v26, v110, v18
    v_mul_f32 v27, v111, v19
    v_fmac_f32 v24, v112, v20
    v_fmac_f32 v25, v113, v21
    v_fmac_f32 v26, v114, v22
    v_fmac_f32 v27, v115, v23
    v_mfma_f32_4x4x1_16b_f32 v[28:31], v2, v24, 0
    s_nop 1
    v_mfma_f32_4x4x1_16b_f32 v[28:31], v4, v25, v[28:31]
    s_nop 1
    v_mfma_f32_4x4x1_16b_f32 v[28:31], v5, v26, v[28:31]
    s_nop 1
    v_mfma_f32_4x4x1_16b_f32 v[28:31], v6, v27, v[28:31]
    s_nop 3
    v_fmac_f32 v56, v28, v116
    v_fmac_f32 v57, v29, v117
    v_fmac_f32 v58, v30, v118
    v_fmac_f32 v59, v31, v119
    v_cvt_pk_bf16_f32 v126, v56, v57
    v_cvt_pk_bf16_f32 v127, v58, v59
    global_store_dwordx2 v39, v[126:127], s[18:19]
    s_mov_b64 exec, -1
.Lt3f:
    s_waitcnt lgkmcnt(0)
    s_barrier
    ds_read_b32 v8, v3 offset:830
    s_waitcnt lgkmcnt(0)
    v_readfirstlane_b32 s27, v8
    s_nop 1
    s_cmp_lg_u32 s27, 0
    s_cbranch_scc1 .Lslow
.Lk2_end:
    s_endpgm
.Lslow0:
    s_waitcnt vmcnt(0) lgkmcnt(0)
    s_add_u32 s16, s4, 86016000
    s_addc_u32 s17, s5, 0
    s_mov_b32 s18, 32768
    s_mov_b32 s19, 0x00020000
    s_mul_i32 s100, s25, 128
    v_mov_b32 v8, 3
    s_mov_b64 exec, 1
    s_lshl2_add_u32 s100, s24, s100
    buffer_store_dword v8, off, s[16:19], s100 sc1
    s_mov_b64 exec, -1
.Lslow:
    s_waitcnt vmcnt(0) lgkmcnt(0)
    s_barrier
    v_mov_b32 v14, 0
    v_mov_b32 v15, 0
    v_mov_b32 v16, 0
    v_mov_b32 v17, 0
    v_lshlrev_b32 v22, 2, v1
    ds_write_b128 v22, v[14:17] offset:0
    ds_write_b128 v22, v[14:17] offset:16384
    ds_write_b128 v22, v[14:17] offset:32768
    ds_write_b128 v22, v[14:17] offset:49152
    v_add_u32 v22, 65536, v22
    ds_write_b128 v22, v[14:17] offset:0
    ds_write_b128 v22, v[14:17] offset:16384
    ds_write_b128 v22, v[14:17] offset:32768
    s_load_dwordx8 s[12:19], s[0:1], 56
    s_load_dwordx2 s[8:9], s[0:1], 0
    s_waitcnt lgkmcnt(0)
    s_load_dwordx16 s[36:51], s[12:13], 0
    s_load_dwordx16 s[52:67], s[14:15], 0
    s_load_dwordx16 s[68:83], s[14:15], 64
    s_load_dwordx8 s[84:91], s[16:17], 0
    s_load_dwordx8 s[92:99], s[18:19], 0
    s_or_b32 s9, s9, 0x80000
    s_mov_b32 s10, 800000
    s_mov_b32 s11, 0x00020000
    s_waitcnt lgkmcnt(0)
    s_pack_ll_b32_b16 s100, s52, s56
    s_pack_hh_b32_b16 s56, s52, s56
    s_mov_b32 s52, s100
    s_pack_ll_b32_b16 s100, s53, s57
    s_pack_hh_b32_b16 s57, s53, s57
    s_mov_b32 s53, s100
    s_pack_ll_b32_b16 s100, s54, s58
    s_pack_hh_b32_b16 s58, s54, s58
    s_mov_b32 s54, s100
    s_pack_ll_b32_b16 s100, s55, s59
    s_pack_hh_b32_b16 s59, s55, s59
    s_mov_b32 s55, s100
    s_pack_ll_b32_b16 s100, s36, s38
    s_pack_hh_b32_b16 s38, s36, s38
    s_mov_b32 s36, s100
    s_pack_ll_b32_b16 s100, s37, s39
    s_pack_hh_b32_b16 s39, s37, s39
    s_mov_b32 s37, s100
    s_pack_ll_b32_b16 s100, s60, s64
    s_pack_hh_b32_b16 s64, s60, s64
    s_mov_b32 s60, s100
    s_pack_ll_b32_b16 s100, s61, s65
    s_pack_hh_b32_b16 s65, s61, s65
    s_mov_b32 s61, s100
    s_pack_ll_b32_b16 s100, s62, s66
    s_pack_hh_b32_b16 s66, s62, s66
    s_mov_b32 s62, s100
    s_pack_ll_b32_b16 s100, s63, s67
    s_pack_hh_b32_b16 s67, s63, s67
    s_mov_b32 s63, s100
    s_pack_ll_b32_b16 s100, s40, s42
    s_pack_hh_b32_b16 s42, s40, s42
    s_mov_b32 s40, s100
    s_pack_ll_b32_b16 s100, s41, s43
    s_pack_hh_b32_b16 s43, s41, s43
    s_mov_b32 s41, s100
    s_pack_ll_b32_b16 s100, s68, s72
    s_pack_hh_b32_b16 s72, s68, s72
    s_mov_b32 s68, s100
    s_pack_ll_b32_b16 s100, s69, s73
    s_pack_hh_b32_b16 s73, s69, s73
    s_mov_b32 s69, s100
    s_pack_ll_b32_b16 s100, s70, s74
    s_pack_hh_b32_b16 s74, s70, s74
    s_mov_b32 s70, s100
    s_pack_ll_b32_b16 s100, s71, s75
    s_pack_hh_b32_b16 s75, s71, s75
    s_mov_b32 s71, s100
    s_pack_ll_b32_b16 s100, s44, s46
    s_pack_hh_b32_b16 s46, s44, s46
    s_mov_b32 s44, s100
    s_pack_ll_b32_b16 s100, s45, s47
    s_pack_hh_b32_b16 s47, s45, s47
    s_mov_b32 s45, s100
    s_pack_ll_b32_b16 s100, s76, s80
    s_pack_hh_b32_b16 s80, s76, s80
    s_mov_b32 s76, s100
    s_pack_ll_b32_b16 s100, s77, s81
    s_pack_hh_b32_b16 s81, s77, s81
    s_mov_b32 s77, s100
    s_pack_ll_b32_b16 s100, s78, s82
    s_pack_hh_b32_b16 s82, s78, s82
    s_mov_b32 s78, s100
    s_pack_ll_b32_b16 s100, s79, s83
    s_pack_hh_b32_b16 s83, s79, s83
    s_mov_b32 s79, s100
    s_pack_ll_b32_b16 s100, s48, s50
    s_pack_hh_b32_b16 s50, s48, s50
    s_mov_b32 s48, s100
    s_pack_ll_b32_b16 s100, s49, s51
    s_pack_hh_b32_b16 s51, s49, s51
    s_mov_b32 s49, s100
    v_add_u32 v36, 0, v0
    v_lshlrev_b32 v120, 2, v36
    global_load_dwordx2 v[120:121], v120, s[22:23]
    global_load_ushort v36, v36, s[30:31]
    v_add_u32 v37, 2048, v0
    v_lshlrev_b32 v122, 2, v37
    global_load_dwordx2 v[122:123], v122, s[22:23]
    global_load_ushort v37, v37, s[30:31]
    v_add_u32 v38, 4096, v0
    v_lshlrev_b32 v124, 2, v38
    global_load_dwordx2 v[124:125], v124, s[22:23]
    global_load_ushort v38, v38, s[30:31]
    v_add_u32 v39, 6144, v0
    v_min_u32 v39, 6248, v39
    v_lshlrev_b32 v126, 2, v39
    global_load_dwordx2 v[126:127], v126, s[22:23]
    global_load_ushort v39, v39, s[30:31]
    s_waitcnt vmcnt(6)
    v_lshlrev_b32 v36, 16, v36
    v_mul_f32 v36, 0x40731710, v36
    v_mov_b32 v14, v36
    v_add_f32 v15, 0xbf0aa327, v36
    v_add_f32 v16, 0xbf8aa327, v36
    v_add_f32 v17, 0xbfcff4ba, v36
    v_add_f32 v18, 0xc00aa327, v36
    v_add_f32 v19, 0xc02dc57c, v36
    v_add_f32 v20, 0xc04ff4ba, v36
    v_add_f32 v21, 0xc0731710, v36
    v_mul_f32 v14, v14, v14
    v_mul_f32 v15, v15, v15
    v_mul_f32 v16, v16, v16
    v_mul_f32 v17, v17, v17
    v_mul_f32 v18, v18, v18
    v_mul_f32 v19, v19, v19
    v_mul_f32 v20, v20, v20
    v_mul_f32 v21, v21, v21
    v_exp_f32_e64 v14, -v14
    v_exp_f32_e64 v15, -v15
    v_exp_f32_e64 v16, -v16
    v_exp_f32_e64 v17, -v17
    v_exp_f32_e64 v18, -v18
    v_exp_f32_e64 v19, -v19
    v_exp_f32_e64 v20, -v20
    v_exp_f32_e64 v21, -v21
    v_cvt_pk_bf16_f32 v10, v14, v15
    v_cvt_pk_bf16_f32 v11, v16, v17
    v_cvt_pk_bf16_f32 v12, v18, v19
    v_cvt_pk_bf16_f32 v13, v20, v21
    v_dot2_f32_bf16 v72, v10, s52, 0
    v_dot2_f32_bf16 v73, v10, s56, 0
    v_dot2_f32_bf16 v74, v10, s53, 0
    v_dot2_f32_bf16 v75, v10, s57, 0
    v_dot2_f32_bf16 v76, v10, s54, 0
    v_dot2_f32_bf16 v77, v10, s58, 0
    v_dot2_f32_bf16 v78, v10, s55, 0
    v_dot2_f32_bf16 v79, v10, s59, 0
    v_dot2_f32_bf16 v80, v10, s36, 0
    v_dot2_f32_bf16 v81, v10, s38, 0
    v_dot2_f32_bf16 v82, v10, s37, 0
    v_dot2_f32_bf16 v83, v10, s39, 0
    v_dot2_f32_bf16 v72, v11, s60, v72
    v_dot2_f32_bf16 v73, v11, s64, v73
    v_dot2_f32_bf16 v74, v11, s61, v74
    v_dot2_f32_bf16 v75, v11, s65, v75
    v_dot2_f32_bf16 v76, v11, s62, v76
    v_dot2_f32_bf16 v77, v11, s66, v77
    v_dot2_f32_bf16 v78, v11, s63, v78
    v_dot2_f32_bf16 v79, v11, s67, v79
    v_dot2_f32_bf16 v80, v11, s40, v80
    v_dot2_f32_bf16 v81, v11, s42, v81
    v_dot2_f32_bf16 v82, v11, s41, v82
    v_dot2_f32_bf16 v83, v11, s43, v83
    v_dot2_f32_bf16 v72, v12, s68, v72
    v_dot2_f32_bf16 v73, v12, s72, v73
    v_dot2_f32_bf16 v74, v12, s69, v74
    v_dot2_f32_bf16 v75, v12, s73, v75
    v_dot2_f32_bf16 v76, v12, s70, v76
    v_dot2_f32_bf16 v77, v12, s74, v77
    v_dot2_f32_bf16 v78, v12, s71, v78
    v_dot2_f32_bf16 v79, v12, s75, v79
    v_dot2_f32_bf16 v80, v12, s44, v80
    v_dot2_f32_bf16 v81, v12, s46, v81
    v_dot2_f32_bf16 v82, v12, s45, v82
    v_dot2_f32_bf16 v83, v12, s47, v83
    v_dot2_f32_bf16 v72, v13, s76, v72
    v_dot2_f32_bf16 v73, v13, s80, v73
    v_dot2_f32_bf16 v74, v13, s77, v74
    v_dot2_f32_bf16 v75, v13, s81, v75
    v_dot2_f32_bf16 v76, v13, s78, v76
    v_dot2_f32_bf16 v77, v13, s82, v77
    v_dot2_f32_bf16 v78, v13, s79, v78
    v_dot2_f32_bf16 v79, v13, s83, v79
    v_dot2_f32_bf16 v80, v13, s48, v80
    v_dot2_f32_bf16 v81, v13, s50, v81
    v_dot2_f32_bf16 v82, v13, s49, v82
    v_dot2_f32_bf16 v83, v13, s51, v83
    s_waitcnt vmcnt(4)
    v_lshlrev_b32 v37, 16, v37
    v_mul_f32 v37, 0x40731710, v37
    v_mov_b32 v14, v37
    v_add_f32 v15, 0xbf0aa327, v37
    v_add_f32 v16, 0xbf8aa327, v37
    v_add_f32 v17, 0xbfcff4ba, v37
    v_add_f32 v18, 0xc00aa327, v37
    v_add_f32 v19, 0xc02dc57c, v37
    v_add_f32 v20, 0xc04ff4ba, v37
    v_add_f32 v21, 0xc0731710, v37
    v_mul_f32 v14, v14, v14
    v_mul_f32 v15, v15, v15
    v_mul_f32 v16, v16, v16
    v_mul_f32 v17, v17, v17
    v_mul_f32 v18, v18, v18
    v_mul_f32 v19, v19, v19
    v_mul_f32 v20, v20, v20
    v_mul_f32 v21, v21, v21
    v_exp_f32_e64 v14, -v14
    v_exp_f32_e64 v15, -v15
    v_exp_f32_e64 v16, -v16
    v_exp_f32_e64 v17, -v17
    v_exp_f32_e64 v18, -v18
    v_exp_f32_e64 v19, -v19
    v_exp_f32_e64 v20, -v20
    v_exp_f32_e64 v21, -v21
    v_cvt_pk_bf16_f32 v10, v14, v15
    v_cvt_pk_bf16_f32 v11, v16, v17
    v_cvt_pk_bf16_f32 v12, v18, v19
    v_cvt_pk_bf16_f32 v13, v20, v21
    v_dot2_f32_bf16 v84, v10, s52, 0
    v_dot2_f32_bf16 v85, v10, s56, 0
    v_dot2_f32_bf16 v86, v10, s53, 0
    v_dot2_f32_bf16 v87, v10, s57, 0
    v_dot2_f32_bf16 v88, v10, s54, 0
    v_dot2_f32_bf16 v89, v10, s58, 0
    v_dot2_f32_bf16 v90, v10, s55, 0
    v_dot2_f32_bf16 v91, v10, s59, 0
    v_dot2_f32_bf16 v92, v10, s36, 0
    v_dot2_f32_bf16 v93, v10, s38, 0
    v_dot2_f32_bf16 v94, v10, s37, 0
    v_dot2_f32_bf16 v95, v10, s39, 0
    v_dot2_f32_bf16 v84, v11, s60, v84
    v_dot2_f32_bf16 v85, v11, s64, v85
    v_dot2_f32_bf16 v86, v11, s61, v86
    v_dot2_f32_bf16 v87, v11, s65, v87
    v_dot2_f32_bf16 v88, v11, s62, v88
    v_dot2_f32_bf16 v89, v11, s66, v89
    v_dot2_f32_bf16 v90, v11, s63, v90
    v_dot2_f32_bf16 v91, v11, s67, v91
    v_dot2_f32_bf16 v92, v11, s40, v92
    v_dot2_f32_bf16 v93, v11, s42, v93
    v_dot2_f32_bf16 v94, v11, s41, v94
    v_dot2_f32_bf16 v95, v11, s43, v95
    v_dot2_f32_bf16 v84, v12, s68, v84
    v_dot2_f32_bf16 v85, v12, s72, v85
    v_dot2_f32_bf16 v86, v12, s69, v86
    v_dot2_f32_bf16 v87, v12, s73, v87
    v_dot2_f32_bf16 v88, v12, s70, v88
    v_dot2_f32_bf16 v89, v12, s74, v89
    v_dot2_f32_bf16 v90, v12, s71, v90
    v_dot2_f32_bf16 v91, v12, s75, v91
    v_dot2_f32_bf16 v92, v12, s44, v92
    v_dot2_f32_bf16 v93, v12, s46, v93
    v_dot2_f32_bf16 v94, v12, s45, v94
    v_dot2_f32_bf16 v95, v12, s47, v95
    v_dot2_f32_bf16 v84, v13, s76, v84
    v_dot2_f32_bf16 v85, v13, s80, v85
    v_dot2_f32_bf16 v86, v13, s77, v86
    v_dot2_f32_bf16 v87, v13, s81, v87
    v_dot2_f32_bf16 v88, v13, s78, v88
    v_dot2_f32_bf16 v89, v13, s82, v89
    v_dot2_f32_bf16 v90, v13, s79, v90
    v_dot2_f32_bf16 v91, v13, s83, v91
    v_dot2_f32_bf16 v92, v13, s48, v92
    v_dot2_f32_bf16 v93, v13, s50, v93
    v_dot2_f32_bf16 v94, v13, s49, v94
    v_dot2_f32_bf16 v95, v13, s51, v95
    s_waitcnt vmcnt(2)
    v_lshlrev_b32 v38, 16, v38
    v_mul_f32 v38, 0x40731710, v38
    v_mov_b32 v14, v38
    v_add_f32 v15, 0xbf0aa327, v38
    v_add_f32 v16, 0xbf8aa327, v38
    v_add_f32 v17, 0xbfcff4ba, v38
    v_add_f32 v18, 0xc00aa327, v38
    v_add_f32 v19, 0xc02dc57c, v38
    v_add_f32 v20, 0xc04ff4ba, v38
    v_add_f32 v21, 0xc0731710, v38
    v_mul_f32 v14, v14, v14
    v_mul_f32 v15, v15, v15
    v_mul_f32 v16, v16, v16
    v_mul_f32 v17, v17, v17
    v_mul_f32 v18, v18, v18
    v_mul_f32 v19, v19, v19
    v_mul_f32 v20, v20, v20
    v_mul_f32 v21, v21, v21
    v_exp_f32_e64 v14, -v14
    v_exp_f32_e64 v15, -v15
    v_exp_f32_e64 v16, -v16
    v_exp_f32_e64 v17, -v17
    v_exp_f32_e64 v18, -v18
    v_exp_f32_e64 v19, -v19
    v_exp_f32_e64 v20, -v20
    v_exp_f32_e64 v21, -v21
    v_cvt_pk_bf16_f32 v10, v14, v15
    v_cvt_pk_bf16_f32 v11, v16, v17
    v_cvt_pk_bf16_f32 v12, v18, v19
    v_cvt_pk_bf16_f32 v13, v20, v21
    v_dot2_f32_bf16 v96, v10, s52, 0
    v_dot2_f32_bf16 v97, v10, s56, 0
    v_dot2_f32_bf16 v98, v10, s53, 0
    v_dot2_f32_bf16 v99, v10, s57, 0
    v_dot2_f32_bf16 v100, v10, s54, 0
    v_dot2_f32_bf16 v101, v10, s58, 0
    v_dot2_f32_bf16 v102, v10, s55, 0
    v_dot2_f32_bf16 v103, v10, s59, 0
    v_dot2_f32_bf16 v104, v10, s36, 0
    v_dot2_f32_bf16 v105, v10, s38, 0
    v_dot2_f32_bf16 v106, v10, s37, 0
    v_dot2_f32_bf16 v107, v10, s39, 0
    v_dot2_f32_bf16 v96, v11, s60, v96
    v_dot2_f32_bf16 v97, v11, s64, v97
    v_dot2_f32_bf16 v98, v11, s61, v98
    v_dot2_f32_bf16 v99, v11, s65, v99
    v_dot2_f32_bf16 v100, v11, s62, v100
    v_dot2_f32_bf16 v101, v11, s66, v101
    v_dot2_f32_bf16 v102, v11, s63, v102
    v_dot2_f32_bf16 v103, v11, s67, v103
    v_dot2_f32_bf16 v104, v11, s40, v104
    v_dot2_f32_bf16 v105, v11, s42, v105
    v_dot2_f32_bf16 v106, v11, s41, v106
    v_dot2_f32_bf16 v107, v11, s43, v107
    v_dot2_f32_bf16 v96, v12, s68, v96
    v_dot2_f32_bf16 v97, v12, s72, v97
    v_dot2_f32_bf16 v98, v12, s69, v98
    v_dot2_f32_bf16 v99, v12, s73, v99
    v_dot2_f32_bf16 v100, v12, s70, v100
    v_dot2_f32_bf16 v101, v12, s74, v101
    v_dot2_f32_bf16 v102, v12, s71, v102
    v_dot2_f32_bf16 v103, v12, s75, v103
    v_dot2_f32_bf16 v104, v12, s44, v104
    v_dot2_f32_bf16 v105, v12, s46, v105
    v_dot2_f32_bf16 v106, v12, s45, v106
    v_dot2_f32_bf16 v107, v12, s47, v107
    v_dot2_f32_bf16 v96, v13, s76, v96
    v_dot2_f32_bf16 v97, v13, s80, v97
    v_dot2_f32_bf16 v98, v13, s77, v98
    v_dot2_f32_bf16 v99, v13, s81, v99
    v_dot2_f32_bf16 v100, v13, s78, v100
    v_dot2_f32_bf16 v101, v13, s82, v101
    v_dot2_f32_bf16 v102, v13, s79, v102
    v_dot2_f32_bf16 v103, v13, s83, v103
    v_dot2_f32_bf16 v104, v13, s48, v104
    v_dot2_f32_bf16 v105, v13, s50, v105
    v_dot2_f32_bf16 v106, v13, s49, v106
    v_dot2_f32_bf16 v107, v13, s51, v107
    s_waitcnt vmcnt(0)
    s_cmp_lg_u32 s24, 0
    s_cbranch_scc1 .Lp3s
    v_lshlrev_b32 v39, 16, v39
    v_mul_f32 v39, 0x40731710, v39
    v_mov_b32 v14, v39
    v_add_f32 v15, 0xbf0aa327, v39
    v_add_f32 v16, 0xbf8aa327, v39
    v_add_f32 v17, 0xbfcff4ba, v39
    v_add_f32 v18, 0xc00aa327, v39
    v_add_f32 v19, 0xc02dc57c, v39
    v_add_f32 v20, 0xc04ff4ba, v39
    v_add_f32 v21, 0xc0731710, v39
    v_mul_f32 v14, v14, v14
    v_mul_f32 v15, v15, v15
    v_mul_f32 v16, v16, v16
    v_mul_f32 v17, v17, v17
    v_mul_f32 v18, v18, v18
    v_mul_f32 v19, v19, v19
    v_mul_f32 v20, v20, v20
    v_mul_f32 v21, v21, v21
    v_exp_f32_e64 v14, -v14
    v_exp_f32_e64 v15, -v15
    v_exp_f32_e64 v16, -v16
    v_exp_f32_e64 v17, -v17
    v_exp_f32_e64 v18, -v18
    v_exp_f32_e64 v19, -v19
    v_exp_f32_e64 v20, -v20
    v_exp_f32_e64 v21, -v21
    v_cvt_pk_bf16_f32 v10, v14, v15
    v_cvt_pk_bf16_f32 v11, v16, v17
    v_cvt_pk_bf16_f32 v12, v18, v19
    v_cvt_pk_bf16_f32 v13, v20, v21
    v_dot2_f32_bf16 v108, v10, s52, 0
    v_dot2_f32_bf16 v109, v10, s56, 0
    v_dot2_f32_bf16 v110, v10, s53, 0
    v_dot2_f32_bf16 v111, v10, s57, 0
    v_dot2_f32_bf16 v112, v10, s54, 0
    v_dot2_f32_bf16 v113, v10, s58, 0
    v_dot2_f32_bf16 v114, v10, s55, 0
    v_dot2_f32_bf16 v115, v10, s59, 0
    v_dot2_f32_bf16 v116, v10, s36, 0
    v_dot2_f32_bf16 v117, v10, s38, 0
    v_dot2_f32_bf16 v118, v10, s37, 0
    v_dot2_f32_bf16 v119, v10, s39, 0
    v_dot2_f32_bf16 v108, v11, s60, v108
    v_dot2_f32_bf16 v109, v11, s64, v109
    v_dot2_f32_bf16 v110, v11, s61, v110
    v_dot2_f32_bf16 v111, v11, s65, v111
    v_dot2_f32_bf16 v112, v11, s62, v112
    v_dot2_f32_bf16 v113, v11, s66, v113
    v_dot2_f32_bf16 v114, v11, s63, v114
    v_dot2_f32_bf16 v115, v11, s67, v115
    v_dot2_f32_bf16 v116, v11, s40, v116
    v_dot2_f32_bf16 v117, v11, s42, v117
    v_dot2_f32_bf16 v118, v11, s41, v118
    v_dot2_f32_bf16 v119, v11, s43, v119
    v_dot2_f32_bf16 v108, v12, s68, v108
    v_dot2_f32_bf16 v109, v12, s72, v109
    v_dot2_f32_bf16 v110, v12, s69, v110
    v_dot2_f32_bf16 v111, v12, s73, v111
    v_dot2_f32_bf16 v112, v12, s70, v112
    v_dot2_f32_bf16 v113, v12, s74, v113
    v_dot2_f32_bf16 v114, v12, s71, v114
    v_dot2_f32_bf16 v115, v12, s75, v115
    v_dot2_f32_bf16 v116, v12, s44, v116
    v_dot2_f32_bf16 v117, v12, s46, v117
    v_dot2_f32_bf16 v118, v12, s45, v118
    v_dot2_f32_bf16 v119, v12, s47, v119
    v_dot2_f32_bf16 v108, v13, s76, v108
    v_dot2_f32_bf16 v109, v13, s80, v109
    v_dot2_f32_bf16 v110, v13, s77, v110
    v_dot2_f32_bf16 v111, v13, s81, v111
    v_dot2_f32_bf16 v112, v13, s78, v112
    v_dot2_f32_bf16 v113, v13, s82, v113
    v_dot2_f32_bf16 v114, v13, s79, v114
    v_dot2_f32_bf16 v115, v13, s83, v115
    v_dot2_f32_bf16 v116, v13, s48, v116
    v_dot2_f32_bf16 v117, v13, s50, v117
    v_dot2_f32_bf16 v118, v13, s49, v118
    v_dot2_f32_bf16 v119, v13, s51, v119
.Lp3s:
    s_lshl_b32 s52, s84, 16
    s_and_b32 s53, s84, 0xffff0000
    s_lshl_b32 s68, s92, 16
    s_and_b32 s69, s92, 0xffff0000
    s_lshl_b32 s54, s85, 16
    s_and_b32 s55, s85, 0xffff0000
    s_lshl_b32 s70, s93, 16
    s_and_b32 s71, s93, 0xffff0000
    s_lshl_b32 s56, s86, 16
    s_and_b32 s57, s86, 0xffff0000
    s_lshl_b32 s72, s94, 16
    s_and_b32 s73, s94, 0xffff0000
    s_lshl_b32 s58, s87, 16
    s_and_b32 s59, s87, 0xffff0000
    s_lshl_b32 s74, s95, 16
    s_and_b32 s75, s95, 0xffff0000
    s_lshl_b32 s60, s88, 16
    s_and_b32 s61, s88, 0xffff0000
    s_lshl_b32 s76, s96, 16
    s_and_b32 s77, s96, 0xffff0000
    s_lshl_b32 s62, s89, 16
    s_and_b32 s63, s89, 0xffff0000
    s_lshl_b32 s78, s97, 16
    s_and_b32 s79, s97, 0xffff0000
    s_lshl_b32 s64, s90, 16
    s_and_b32 s65, s90, 0xffff0000
    s_lshl_b32 s80, s98, 16
    s_and_b32 s81, s98, 0xffff0000
    s_lshl_b32 s66, s91, 16
    s_and_b32 s67, s91, 0xffff0000
    s_lshl_b32 s82, s99, 16
    s_and_b32 s83, s99, 0xffff0000
    s_waitcnt vmcnt(0) lgkmcnt(0)
    s_barrier
    s_load_dwordx4 s[44:47], s[0:1], 8
    s_load_dwordx2 s[48:49], s[0:1], 32
    s_waitcnt lgkmcnt(0)
    s_add_u32 s36, s44, 0
    s_addc_u32 s37, s45, 0
    s_mov_b32 s38, 51200000
    s_mov_b32 s39, 0x00020000
    s_add_u32 s40, s46, 0
    s_addc_u32 s41, s47, 0
    s_mov_b32 s42, 51200000
    s_mov_b32 s43, 0x00020000
    s_add_u32 s44, s48, 0
    s_addc_u32 s45, s49, 0
    s_mov_b32 s46, 25600000
    s_mov_b32 s47, 0x00020000
    s_mul_i32 s49, s25, 3125
    s_mov_b32 s48, 0
    v_lshlrev_b32 v34, 2, v1
    v_lshlrev_b32 v35, 1, v1
.Lsl_c:
    s_lshr_b32 s50, s48, 1
    buffer_load_dwordx4 v[24:27], v34, s[40:43], s48 offen
    buffer_load_dwordx4 v[28:31], v34, s[36:39], s48 offen
    buffer_load_dwordx2 v[32:33], v35, s[44:47], s50 offen
    s_waitcnt vmcnt(0)
    v_subrev_u32 v24, s49, v24
    v_cmpx_gt_u32 vcc, 3125, v24
    buffer_load_dwordx2 v[44:45], v28, s[8:11], 0 idxen
    s_mov_b64 exec, -1
    v_subrev_u32 v25, s49, v25
    v_cmpx_gt_u32 vcc, 3125, v25
    buffer_load_dwordx2 v[46:47], v29, s[8:11], 0 idxen
    s_mov_b64 exec, -1
    v_subrev_u32 v26, s49, v26
    v_cmpx_gt_u32 vcc, 3125, v26
    buffer_load_dwordx2 v[48:49], v30, s[8:11], 0 idxen
    s_mov_b64 exec, -1
    v_subrev_u32 v27, s49, v27
    v_cmpx_gt_u32 vcc, 3125, v27
    buffer_load_dwordx2 v[50:51], v31, s[8:11], 0 idxen
    s_mov_b64 exec, -1
    s_waitcnt vmcnt(0)
    v_cmpx_gt_u32 vcc, 3125, v24
    s_nop 1
    s_cbranch_execz .Lsl_n0
    v_lshlrev_b32 v8, 16, v32
    v_mul_f32 v8, 0.15915494, v8
    v_fract_f32 v8, v8
    v_cos_f32 v8, v8
    v_lshlrev_b32 v22, 5, v24
    v_add_f32 v9, v8, v8
    v_fma_f32 v9, v9, v8, -1.0
    v_lshlrev_b32 v10, 16, v44
    v_and_b32 v11, 0xffff0000, v44
    v_lshlrev_b32 v12, 16, v45
    v_and_b32 v13, 0xffff0000, v45
    v_mul_f32 v14, v8, v10
    ds_add_f32 v22, v14 offset:0
    v_mul_f32 v15, v8, v11
    ds_add_f32 v22, v15 offset:4
    v_mul_f32 v16, v8, v12
    ds_add_f32 v22, v16 offset:8
    v_mul_f32 v17, v8, v13
    ds_add_f32 v22, v17 offset:12
    v_mul_f32 v18, v9, v10
    ds_add_f32 v22, v18 offset:16
    v_mul_f32 v19, v9, v11
    ds_add_f32 v22, v19 offset:20
    v_mul_f32 v20, v9, v12
    ds_add_f32 v22, v20 offset:24
    v_mul_f32 v21, v9, v13
    ds_add_f32 v22, v21 offset:28
.Lsl_n0:
    s_mov_b64 exec, -1
    v_cmpx_gt_u32 vcc, 3125, v25
    s_nop 1
    s_cbranch_execz .Lsl_n1
    v_and_b32 v8, 0xffff0000, v32
    v_mul_f32 v8, 0.15915494, v8
    v_fract_f32 v8, v8
    v_cos_f32 v8, v8
    v_lshlrev_b32 v22, 5, v25
    v_add_f32 v9, v8, v8
    v_fma_f32 v9, v9, v8, -1.0
    v_lshlrev_b32 v10, 16, v46
    v_and_b32 v11, 0xffff0000, v46
    v_lshlrev_b32 v12, 16, v47
    v_and_b32 v13, 0xffff0000, v47
    v_mul_f32 v14, v8, v10
    ds_add_f32 v22, v14 offset:0
    v_mul_f32 v15, v8, v11
    ds_add_f32 v22, v15 offset:4
    v_mul_f32 v16, v8, v12
    ds_add_f32 v22, v16 offset:8
    v_mul_f32 v17, v8, v13
    ds_add_f32 v22, v17 offset:12
    v_mul_f32 v18, v9, v10
    ds_add_f32 v22, v18 offset:16
    v_mul_f32 v19, v9, v11
    ds_add_f32 v22, v19 offset:20
    v_mul_f32 v20, v9, v12
    ds_add_f32 v22, v20 offset:24
    v_mul_f32 v21, v9, v13
    ds_add_f32 v22, v21 offset:28
.Lsl_n1:
    s_mov_b64 exec, -1
    v_cmpx_gt_u32 vcc, 3125, v26
    s_nop 1
    s_cbranch_execz .Lsl_n2
    v_lshlrev_b32 v8, 16, v33
    v_mul_f32 v8, 0.15915494, v8
    v_fract_f32 v8, v8
    v_cos_f32 v8, v8
    v_lshlrev_b32 v22, 5, v26
    v_add_f32 v9, v8, v8
    v_fma_f32 v9, v9, v8, -1.0
    v_lshlrev_b32 v10, 16, v48
    v_and_b32 v11, 0xffff0000, v48
    v_lshlrev_b32 v12, 16, v49
    v_and_b32 v13, 0xffff0000, v49
    v_mul_f32 v14, v8, v10
    ds_add_f32 v22, v14 offset:0
    v_mul_f32 v15, v8, v11
    ds_add_f32 v22, v15 offset:4
    v_mul_f32 v16, v8, v12
    ds_add_f32 v22, v16 offset:8
    v_mul_f32 v17, v8, v13
    ds_add_f32 v22, v17 offset:12
    v_mul_f32 v18, v9, v10
    ds_add_f32 v22, v18 offset:16
    v_mul_f32 v19, v9, v11
    ds_add_f32 v22, v19 offset:20
    v_mul_f32 v20, v9, v12
    ds_add_f32 v22, v20 offset:24
    v_mul_f32 v21, v9, v13
    ds_add_f32 v22, v21 offset:28
.Lsl_n2:
    s_mov_b64 exec, -1
    v_cmpx_gt_u32 vcc, 3125, v27
    s_nop 1
    s_cbranch_execz .Lsl_n3
    v_and_b32 v8, 0xffff0000, v33
    v_mul_f32 v8, 0.15915494, v8
    v_fract_f32 v8, v8
    v_cos_f32 v8, v8
    v_lshlrev_b32 v22, 5, v27
    v_add_f32 v9, v8, v8
    v_fma_f32 v9, v9, v8, -1.0
    v_lshlrev_b32 v10, 16, v50
    v_and_b32 v11, 0xffff0000, v50
    v_lshlrev_b32 v12, 16, v51
    v_and_b32 v13, 0xffff0000, v51
    v_mul_f32 v14, v8, v10
    ds_add_f32 v22, v14 offset:0
    v_mul_f32 v15, v8, v11
    ds_add_f32 v22, v15 offset:4
    v_mul_f32 v16, v8, v12
    ds_add_f32 v22, v16 offset:8
    v_mul_f32 v17, v8, v13
    ds_add_f32 v22, v17 offset:12
    v_mul_f32 v18, v9, v10
    ds_add_f32 v22, v18 offset:16
    v_mul_f32 v19, v9, v11
    ds_add_f32 v22, v19 offset:20
    v_mul_f32 v20, v9, v12
    ds_add_f32 v22, v20 offset:24
    v_mul_f32 v21, v9, v13
    ds_add_f32 v22, v21 offset:28
.Lsl_n3:
    s_mov_b64 exec, -1
    s_add_u32 s48, s48, 16384
    s_cmp_lt_u32 s48, 51200000
    s_cbranch_scc1 .Lsl_c
    v_lshlrev_b32 v40, 3, v1
    s_waitcnt vmcnt(0) lgkmcnt(0)
    s_barrier
    ds_read_b128 v[8:11], v40 offset:0
    ds_read_b128 v[12:15], v40 offset:16
    s_waitcnt lgkmcnt(1)
    v_pk_mul_f32 v[16:17], v[8:9], s[52:53] op_sel_hi:[0,1]
    v_pk_mul_f32 v[18:19], v[8:9], s[54:55] op_sel_hi:[0,1]
    s_waitcnt lgkmcnt(0)
    v_pk_mul_f32 v[20:21], v[12:13], s[52:53] op_sel_hi:[0,1]
    v_pk_mul_f32 v[22:23], v[12:13], s[54:55] op_sel_hi:[0,1]
    v_pk_fma_f32 v[16:17], v[8:9], s[56:57], v[16:17] op_sel:[1,0,0]
    v_pk_fma_f32 v[18:19], v[8:9], s[58:59], v[18:19] op_sel:[1,0,0]
    v_pk_fma_f32 v[20:21], v[12:13], s[56:57], v[20:21] op_sel:[1,0,0]
    v_pk_fma_f32 v[22:23], v[12:13], s[58:59], v[22:23] op_sel:[1,0,0]
    v_pk_fma_f32 v[16:17], v[10:11], s[60:61], v[16:17] op_sel_hi:[0,1,1]
    v_pk_fma_f32 v[18:19], v[10:11], s[62:63], v[18:19] op_sel_hi:[0,1,1]
    v_pk_fma_f32 v[20:21], v[14:15], s[60:61], v[20:21] op_sel_hi:[0,1,1]
    v_pk_fma_f32 v[22:23], v[14:15], s[62:63], v[22:23] op_sel_hi:[0,1,1]
    v_pk_fma_f32 v[16:17], v[10:11], s[64:65], v[16:17] op_sel:[1,0,0]
    v_pk_fma_f32 v[18:19], v[10:11], s[66:67], v[18:19] op_sel:[1,0,0]
    v_pk_fma_f32 v[20:21], v[14:15], s[64:65], v[20:21] op_sel:[1,0,0]
    v_pk_fma_f32 v[22:23], v[14:15], s[66:67], v[22:23] op_sel:[1,0,0]
    v_mul_f32 v24, v72, v16
    v_mul_f32 v25, v73, v17
    v_mul_f32 v26, v74, v18
    v_mul_f32 v27, v75, v19
    v_fmac_f32 v24, v76, v20
    v_fmac_f32 v25, v77, v21
    v_fmac_f32 v26, v78, v22
    v_fmac_f32 v27, v79, v23
    v_lshlrev_b32 v8, 16, v120
    v_and_b32 v9, 0xffff0000, v120
    v_lshlrev_b32 v10, 16, v121
    v_and_b32 v11, 0xffff0000, v121
    v_pk_mul_f32 v[28:29], v[24:25], s[68:69] op_sel_hi:[0,1]
    v_pk_mul_f32 v[30:31], v[24:25], s[70:71] op_sel_hi:[0,1]
    v_pk_fma_f32 v[28:29], v[24:25], s[72:73], v[28:29] op_sel:[1,0,0]
    v_pk_fma_f32 v[30:31], v[24:25], s[74:75], v[30:31] op_sel:[1,0,0]
    v_pk_fma_f32 v[28:29], v[26:27], s[76:77], v[28:29] op_sel_hi:[0,1,1]
    v_pk_fma_f32 v[30:31], v[26:27], s[78:79], v[30:31] op_sel_hi:[0,1,1]
    v_pk_fma_f32 v[28:29], v[26:27], s[80:81], v[28:29] op_sel:[1,0,0]
    v_pk_fma_f32 v[30:31], v[26:27], s[82:83], v[30:31] op_sel:[1,0,0]
    v_fmac_f32 v8, v28, v80
    v_fmac_f32 v9, v29, v81
    v_fmac_f32 v10, v30, v82
    v_fmac_f32 v11, v31, v83
    v_cvt_pk_bf16_f32 v120, v8, v9
    v_cvt_pk_bf16_f32 v121, v10, v11
    v_lshlrev_b32 v16, 1, v1
    v_add_u32 v16, 0, v16
    global_store_dwordx2 v16, v[120:121], s[32:33]
    ds_read_b128 v[8:11], v40 offset:32768
    ds_read_b128 v[12:15], v40 offset:32784
    s_waitcnt lgkmcnt(1)
    v_pk_mul_f32 v[16:17], v[8:9], s[52:53] op_sel_hi:[0,1]
    v_pk_mul_f32 v[18:19], v[8:9], s[54:55] op_sel_hi:[0,1]
    s_waitcnt lgkmcnt(0)
    v_pk_mul_f32 v[20:21], v[12:13], s[52:53] op_sel_hi:[0,1]
    v_pk_mul_f32 v[22:23], v[12:13], s[54:55] op_sel_hi:[0,1]
    v_pk_fma_f32 v[16:17], v[8:9], s[56:57], v[16:17] op_sel:[1,0,0]
    v_pk_fma_f32 v[18:19], v[8:9], s[58:59], v[18:19] op_sel:[1,0,0]
    v_pk_fma_f32 v[20:21], v[12:13], s[56:57], v[20:21] op_sel:[1,0,0]
    v_pk_fma_f32 v[22:23], v[12:13], s[58:59], v[22:23] op_sel:[1,0,0]
    v_pk_fma_f32 v[16:17], v[10:11], s[60:61], v[16:17] op_sel_hi:[0,1,1]
    v_pk_fma_f32 v[18:19], v[10:11], s[62:63], v[18:19] op_sel_hi:[0,1,1]
    v_pk_fma_f32 v[20:21], v[14:15], s[60:61], v[20:21] op_sel_hi:[0,1,1]
    v_pk_fma_f32 v[22:23], v[14:15], s[62:63], v[22:23] op_sel_hi:[0,1,1]
    v_pk_fma_f32 v[16:17], v[10:11], s[64:65], v[16:17] op_sel:[1,0,0]
    v_pk_fma_f32 v[18:19], v[10:11], s[66:67], v[18:19] op_sel:[1,0,0]
    v_pk_fma_f32 v[20:21], v[14:15], s[64:65], v[20:21] op_sel:[1,0,0]
    v_pk_fma_f32 v[22:23], v[14:15], s[66:67], v[22:23] op_sel:[1,0,0]
    v_mul_f32 v24, v84, v16
    v_mul_f32 v25, v85, v17
    v_mul_f32 v26, v86, v18
    v_mul_f32 v27, v87, v19
    v_fmac_f32 v24, v88, v20
    v_fmac_f32 v25, v89, v21
    v_fmac_f32 v26, v90, v22
    v_fmac_f32 v27, v91, v23
    v_lshlrev_b32 v8, 16, v122
    v_and_b32 v9, 0xffff0000, v122
    v_lshlrev_b32 v10, 16, v123
    v_and_b32 v11, 0xffff0000, v123
    v_pk_mul_f32 v[28:29], v[24:25], s[68:69] op_sel_hi:[0,1]
    v_pk_mul_f32 v[30:31], v[24:25], s[70:71] op_sel_hi:[0,1]
    v_pk_fma_f32 v[28:29], v[24:25], s[72:73], v[28:29] op_sel:[1,0,0]
    v_pk_fma_f32 v[30:31], v[24:25], s[74:75], v[30:31] op_sel:[1,0,0]
    v_pk_fma_f32 v[28:29], v[26:27], s[76:77], v[28:29] op_sel_hi:[0,1,1]
    v_pk_fma_f32 v[30:31], v[26:27], s[78:79], v[30:31] op_sel_hi:[0,1,1]
    v_pk_fma_f32 v[28:29], v[26:27], s[80:81], v[28:29] op_sel:[1,0,0]
    v_pk_fma_f32 v[30:31], v[26:27], s[82:83], v[30:31] op_sel:[1,0,0]
    v_fmac_f32 v8, v28, v92
    v_fmac_f32 v9, v29, v93
    v_fmac_f32 v10, v30, v94
    v_fmac_f32 v11, v31, v95
    v_cvt_pk_bf16_f32 v122, v8, v9
    v_cvt_pk_bf16_f32 v123, v10, v11
    v_lshlrev_b32 v16, 1, v1
    v_add_u32 v16, 8192, v16
    global_store_dwordx2 v16, v[122:123], s[32:33]
    v_add_u32 v40, 65536, v40
    ds_read_b128 v[8:11], v40 offset:0
    ds_read_b128 v[12:15], v40 offset:16
    s_waitcnt lgkmcnt(1)
    v_pk_mul_f32 v[16:17], v[8:9], s[52:53] op_sel_hi:[0,1]
    v_pk_mul_f32 v[18:19], v[8:9], s[54:55] op_sel_hi:[0,1]
    s_waitcnt lgkmcnt(0)
    v_pk_mul_f32 v[20:21], v[12:13], s[52:53] op_sel_hi:[0,1]
    v_pk_mul_f32 v[22:23], v[12:13], s[54:55] op_sel_hi:[0,1]
    v_pk_fma_f32 v[16:17], v[8:9], s[56:57], v[16:17] op_sel:[1,0,0]
    v_pk_fma_f32 v[18:19], v[8:9], s[58:59], v[18:19] op_sel:[1,0,0]
    v_pk_fma_f32 v[20:21], v[12:13], s[56:57], v[20:21] op_sel:[1,0,0]
    v_pk_fma_f32 v[22:23], v[12:13], s[58:59], v[22:23] op_sel:[1,0,0]
    v_pk_fma_f32 v[16:17], v[10:11], s[60:61], v[16:17] op_sel_hi:[0,1,1]
    v_pk_fma_f32 v[18:19], v[10:11], s[62:63], v[18:19] op_sel_hi:[0,1,1]
    v_pk_fma_f32 v[20:21], v[14:15], s[60:61], v[20:21] op_sel_hi:[0,1,1]
    v_pk_fma_f32 v[22:23], v[14:15], s[62:63], v[22:23] op_sel_hi:[0,1,1]
    v_pk_fma_f32 v[16:17], v[10:11], s[64:65], v[16:17] op_sel:[1,0,0]
    v_pk_fma_f32 v[18:19], v[10:11], s[66:67], v[18:19] op_sel:[1,0,0]
    v_pk_fma_f32 v[20:21], v[14:15], s[64:65], v[20:21] op_sel:[1,0,0]
    v_pk_fma_f32 v[22:23], v[14:15], s[66:67], v[22:23] op_sel:[1,0,0]
    v_mul_f32 v24, v96, v16
    v_mul_f32 v25, v97, v17
    v_mul_f32 v26, v98, v18
    v_mul_f32 v27, v99, v19
    v_fmac_f32 v24, v100, v20
    v_fmac_f32 v25, v101, v21
    v_fmac_f32 v26, v102, v22
    v_fmac_f32 v27, v103, v23
    v_lshlrev_b32 v8, 16, v124
    v_and_b32 v9, 0xffff0000, v124
    v_lshlrev_b32 v10, 16, v125
    v_and_b32 v11, 0xffff0000, v125
    v_pk_mul_f32 v[28:29], v[24:25], s[68:69] op_sel_hi:[0,1]
    v_pk_mul_f32 v[30:31], v[24:25], s[70:71] op_sel_hi:[0,1]
    v_pk_fma_f32 v[28:29], v[24:25], s[72:73], v[28:29] op_sel:[1,0,0]
    v_pk_fma_f32 v[30:31], v[24:25], s[74:75], v[30:31] op_sel:[1,0,0]
    v_pk_fma_f32 v[28:29], v[26:27], s[76:77], v[28:29] op_sel_hi:[0,1,1]
    v_pk_fma_f32 v[30:31], v[26:27], s[78:79], v[30:31] op_sel_hi:[0,1,1]
    v_pk_fma_f32 v[28:29], v[26:27], s[80:81], v[28:29] op_sel:[1,0,0]
    v_pk_fma_f32 v[30:31], v[26:27], s[82:83], v[30:31] op_sel:[1,0,0]
    v_fmac_f32 v8, v28, v104
    v_fmac_f32 v9, v29, v105
    v_fmac_f32 v10, v30, v106
    v_fmac_f32 v11, v31, v107
    v_cvt_pk_bf16_f32 v124, v8, v9
    v_cvt_pk_bf16_f32 v125, v10, v11
    v_lshlrev_b32 v16, 1, v1
    v_add_u32 v16, 16384, v16
    global_store_dwordx2 v16, v[124:125], s[32:33]
    s_cmp_lg_u32 s24, 0
    s_cbranch_scc1 .Lt3s
    s_bfm_b64 exec, 53, 0
    ds_read_b128 v[8:11], v40 offset:32768
    ds_read_b128 v[12:15], v40 offset:32784
    s_waitcnt lgkmcnt(1)
    v_pk_mul_f32 v[16:17], v[8:9], s[52:53] op_sel_hi:[0,1]
    v_pk_mul_f32 v[18:19], v[8:9], s[54:55] op_sel_hi:[0,1]
    s_waitcnt lgkmcnt(0)
    v_pk_mul_f32 v[20:21], v[12:13], s[52:53] op_sel_hi:[0,1]
    v_pk_mul_f32 v[22:23], v[12:13], s[54:55] op_sel_hi:[0,1]
    v_pk_fma_f32 v[16:17], v[8:9], s[56:57], v[16:17] op_sel:[1,0,0]
    v_pk_fma_f32 v[18:19], v[8:9], s[58:59], v[18:19] op_sel:[1,0,0]
    v_pk_fma_f32 v[20:21], v[12:13], s[56:57], v[20:21] op_sel:[1,0,0]
    v_pk_fma_f32 v[22:23], v[12:13], s[58:59], v[22:23] op_sel:[1,0,0]
    v_pk_fma_f32 v[16:17], v[10:11], s[60:61], v[16:17] op_sel_hi:[0,1,1]
    v_pk_fma_f32 v[18:19], v[10:11], s[62:63], v[18:19] op_sel_hi:[0,1,1]
    v_pk_fma_f32 v[20:21], v[14:15], s[60:61], v[20:21] op_sel_hi:[0,1,1]
    v_pk_fma_f32 v[22:23], v[14:15], s[62:63], v[22:23] op_sel_hi:[0,1,1]
    v_pk_fma_f32 v[16:17], v[10:11], s[64:65], v[16:17] op_sel:[1,0,0]
    v_pk_fma_f32 v[18:19], v[10:11], s[66:67], v[18:19] op_sel:[1,0,0]
    v_pk_fma_f32 v[20:21], v[14:15], s[64:65], v[20:21] op_sel:[1,0,0]
    v_pk_fma_f32 v[22:23], v[14:15], s[66:67], v[22:23] op_sel:[1,0,0]
    v_mul_f32 v24, v108, v16
    v_mul_f32 v25, v109, v17
    v_mul_f32 v26, v110, v18
    v_mul_f32 v27, v111, v19
    v_fmac_f32 v24, v112, v20
    v_fmac_f32 v25, v113, v21
    v_fmac_f32 v26, v114, v22
    v_fmac_f32 v27, v115, v23
    v_lshlrev_b32 v8, 16, v126
    v_and_b32 v9, 0xffff0000, v126
    v_lshlrev_b32 v10, 16, v127
    v_and_b32 v11, 0xffff0000, v127
    v_pk_mul_f32 v[28:29], v[24:25], s[68:69] op_sel_hi:[0,1]
    v_pk_mul_f32 v[30:31], v[24:25], s[70:71] op_sel_hi:[0,1]
    v_pk_fma_f32 v[28:29], v[24:25], s[72:73], v[28:29] op_sel:[1,0,0]
    v_pk_fma_f32 v[30:31], v[24:25], s[74:75], v[30:31] op_sel:[1,0,0]
    v_pk_fma_f32 v[28:29], v[26:27], s[76:77], v[28:29] op_sel_hi:[0,1,1]
    v_pk_fma_f32 v[30:31], v[26:27], s[78:79], v[30:31] op_sel_hi:[0,1,1]
    v_pk_fma_f32 v[28:29], v[26:27], s[80:81], v[28:29] op_sel:[1,0,0]
    v_pk_fma_f32 v[30:31], v[26:27], s[82:83], v[30:31] op_sel:[1,0,0]
    v_fmac_f32 v8, v28, v116
    v_fmac_f32 v9, v29, v117
    v_fmac_f32 v10, v30, v118
    v_fmac_f32 v11, v31, v119
    v_cvt_pk_bf16_f32 v126, v8, v9
    v_cvt_pk_bf16_f32 v127, v10, v11
    v_lshlrev_b32 v16, 1, v1
    v_add_u32 v16, 24576, v16
    global_store_dwordx2 v16, v[126:127], s[32:33]
    s_mov_b64 exec, -1
    s_waitcnt lgkmcnt(0)
.Lt3s:
    s_endpgm
    s_waitcnt vmcnt(0) lgkmcnt(0)
.Lzw:
    s_mov_b32 s24, s46
    v_mov_b32 v6, 0
    s_cmp_lg_u32 s24, 15
    s_cbranch_scc1 .Lsp0x
    s_mov_b64 exec, 1
    s_mov_b32 s3, 1048576
.Lsp0:
    global_load_dword v63, v6, s[94:95] sc1
    s_waitcnt vmcnt(0)
    v_readfirstlane_b32 s100, v63
    s_sub_u32 s3, s3, 1
    s_cbranch_scc1 .Lsp0y
    s_cmp_eq_u32 s100, 1
    s_cbranch_scc1 .Lsp0y
    s_branch .Lsp0
.Lsp0y:
    s_mov_b64 exec, -1
.Lsp0x:
    s_branch .Lzwx
.Lidle:
    s_cmp_ge_u32 s2, 256
    s_cbranch_scc1 .Lk2_end
    s_load_dwordx2 s[94:95], s[0:1], 96
    s_load_dwordx2 s[40:41], s[0:1], 104
    v_lshlrev_b32 v1, 4, v0
    v_lshlrev_b32 v2, 3, v0
    v_lshlrev_b32 v3, 2, v0
    v_lshrrev_b32 v6, 6, v0
    v_lshlrev_b32 v7, 7, v0
    v_mov_b32 v5, 0
    v_readfirstlane_b32 s46, v6
    s_waitcnt lgkmcnt(0)
    s_nop 0
    s_mov_b32 s24, s46
    s_and_b32 s25, s2, 6
    s_lshl_b32 s25, s25, 5
    s_lshr_b32 s100, s2, 3
    s_lshl1_add_u32 s25, s100, s25
    s_and_b32 s100, s2, 1
    s_add_u32 s25, s25, s100
    s_add_u32 s4, s40, 0
    s_addc_u32 s5, s41, 0
    s_mov_b32 s6, 75497472
    s_mov_b32 s7, 0x00020000
    s_add_u32 s12, s40, 83886080
    s_addc_u32 s13, s41, 0
    s_mov_b32 s14, 2048000
    s_mov_b32 s15, 0x00020000
    s_add_u32 s16, s40, 86052864
    s_addc_u32 s17, s41, 0
    s_mov_b32 s18, 1000
    s_mov_b32 s19, 0x00020000
    s_and_b32 s28, s25, 1
    s_mul_i32 s28, s28, 255
    s_add_u32 s28, s28, s25
    s_lshl_b32 s28, s28, 4
    v_lshrrev_b32 v115, 4, v3
    v_and_b32 v123, 24, v2
    v_lshl_or_b32 v115, v115, 13, v123
    v_and_b32 v123, 0x3ff, v1
    v_mov_b32 v118, 0
    v_lshlrev_b32 v121, 5, v3
    v_and_b32 v121, 0x7ff, v121
    v_add_u32 v121, 86048768, v121
    s_and_b32 s100, s2, 15
    s_lshl_b32 s100, s100, 7
    s_add_u32 s100, s100, 86048768
    v_mov_b32 v122, s100
    s_add_u32 s8, s40, 86016000
    s_addc_u32 s9, s41, 0
    s_mov_b32 s10, 37888
    s_mov_b32 s11, 0x00020000
    s_load_dwordx2 s[84:85], s[0:1], 24
    s_mul_i32 s89, s25, 6250
    s_waitcnt lgkmcnt(0)
    s_add_u32 s84, s84, s89
    s_addc_u32 s85, s85, 0
    s_and_b32 s84, s84, -4
    v_min_u32 v62, 6244, v2
    global_load_dword v62, v62, s[84:85]
    v_mov_b32 v8, 0
    v_mov_b32 v9, 0
    v_mov_b32 v10, 0
    v_mov_b32 v11, 0
    s_movk_i32 s58, 0x4000
    s_mov_b32 s59, 0x8000
    s_cmp_eq_u32 s2, 255
    s_cselect_b64 exec, -1, 0
    buffer_store_dwordx4 v[8:11], v1, s[8:11], 0 offen sc1
    buffer_store_dwordx4 v[8:11], v1, s[8:11], s58 offen sc1
    buffer_store_dwordx4 v[8:11], v1, s[8:11], s59 offen sc1
    s_mov_b64 exec, -1
    s_waitcnt vmcnt(0)
    s_barrier
    v_mov_b32 v119, 1
    s_add_u32 s58, s24, s2
    s_cmp_eq_u32 s58, 270
    s_cselect_b64 exec, 1, 0
    global_store_dword v118, v119, s[94:95] sc1
    s_mov_b64 exec, -1
    s_cmp_lg_u32 s24, 15
    s_cbranch_scc1 .Lsp0ix
    s_mov_b64 exec, 1
    s_mov_b32 s3, 1048576
.Lsp0i:
    global_load_dword v63, v118, s[94:95] sc1
    s_waitcnt vmcnt(0)
    v_readfirstlane_b32 s100, v63
    s_sub_u32 s3, s3, 1
    s_cbranch_scc1 .Lsp0iy
    s_cmp_eq_u32 s100, 1
    s_cbranch_scc1 .Lsp0iy
    s_branch .Lsp0i
.Lsp0iy:
    s_mov_b64 exec, -1
.Lsp0ix:
    s_branch .Lp2i
.Lfl0:
    s_lshl_b32 s100, s26, 2
    v_add_u32 v19, s100, v1
    v_mov_b32 v43, -1
.Lfl0a:
    v_cmpx_gt_u32 vcc, 49152, v19
    s_nop 1
    s_cbranch_execz .Lfl0b
    v_lshlrev_b32 v22, 1, v19
    v_and_b32 v22, 0xff8, v22
    v_add_u32 v23, s19, v19
    ds_write_b32 v23, v22
    v_add_u32 v22, 28, v19
    v_lshrrev_b32 v22, 4, v22
    v_and_b32 v22, -2, v22
    ds_write_b16 v22, v43 offset:3872
    v_add_u32 v19, 4096, v19
    s_branch .Lfl0a
.Lfl0b:
    s_mov_b64 exec, -1
    s_waitcnt lgkmcnt(0)
    s_branch .Lflx0
.Lfl1:
    s_lshl_b32 s100, s27, 2
    v_add_u32 v41, s100, v1
    v_mov_b32 v43, -1
.Lfl1a:
    v_cmpx_gt_u32 vcc, 49152, v41
    s_nop 1
    s_cbranch_execz .Lfl1b
    v_lshlrev_b32 v22, 1, v41
    v_and_b32 v22, 0xff8, v22
    v_add_u32 v23, s19, v41
    ds_write_b32 v23, v22
    v_add_u32 v22, 28, v41
    v_lshrrev_b32 v22, 4, v22
    v_and_b32 v22, -2, v22
    ds_write_b16 v22, v43 offset:3872
    v_add_u32 v41, 4096, v41
    s_branch .Lfl1a
.Lfl1b:
    s_mov_b64 exec, -1
    s_waitcnt lgkmcnt(0)
    s_branch .Lflx1
.Lfl2:
    s_lshl_b32 s100, s28, 2
    v_add_u32 v41, s100, v1
    v_mov_b32 v43, -1
.Lfl2a:
    v_cmpx_gt_u32 vcc, 49152, v41
    s_nop 1
    s_cbranch_execz .Lfl2b
    v_lshlrev_b32 v22, 1, v41
    v_and_b32 v22, 0xff8, v22
    v_add_u32 v23, s19, v41
    ds_write_b32 v23, v22
    v_add_u32 v22, 28, v41
    v_lshrrev_b32 v22, 4, v22
    v_and_b32 v22, -2, v22
    ds_write_b16 v22, v43 offset:3872
    v_add_u32 v41, 4096, v41
    s_branch .Lfl2a
.Lfl2b:
    s_mov_b64 exec, -1
    s_waitcnt lgkmcnt(0)
    s_branch .Lflx2
.Lfl3:
    s_lshl_b32 s100, s29, 2
    v_add_u32 v41, s100, v1
    v_mov_b32 v43, -1
.Lfl3a:
    v_cmpx_gt_u32 vcc, 49152, v41
    s_nop 1
    s_cbranch_execz .Lfl3b
    v_lshlrev_b32 v22, 1, v41
    v_and_b32 v22, 0xff8, v22
    v_add_u32 v23, s19, v41
    ds_write_b32 v23, v22
    v_add_u32 v22, 28, v41
    v_lshrrev_b32 v22, 4, v22
    v_and_b32 v22, -2, v22
    ds_write_b16 v22, v43 offset:3872
    v_add_u32 v41, 4096, v41
    s_branch .Lfl3a
.Lfl3b:
    s_mov_b64 exec, -1
    s_waitcnt lgkmcnt(0)
    s_branch .Lflx3
.section .rodata,"a"
.p2align 6
.amdhsa_kernel standalone__molecular_angular_gemnet__graph_kernel
  .amdhsa_next_free_vgpr 128
  .amdhsa_next_free_sgpr 102
  .amdhsa_accum_offset 128
  .amdhsa_group_segment_fixed_size 0
  .amdhsa_kernarg_size 112
  .amdhsa_user_sgpr_count 2
  .amdhsa_user_sgpr_kernarg_segment_ptr 1
  .amdhsa_system_sgpr_workgroup_id_x 1
  .amdhsa_float_denorm_mode_32 3
.end_amdhsa_kernel
```
